```python
import torch

def _softmax(x, axis=-1):
    return torch.softmax(x, dim=axis)

def _gelu(x):
    return torch.nn.functional.gelu(x, approximate='tanh')

def _silu(x):
    return torch.nn.functional.silu(x)

def _sigmoid(x):
    return torch.sigmoid(x)

def _layernorm(x, axis=-1, eps=1e-05):
    m = x.mean(dim=axis, keepdim=True)
    v = x.var(dim=axis, keepdim=True, unbiased=False)
    return (x - m) / torch.sqrt(v + eps)

def _scatter_add(tgt, idx, src, axis=0):
    return tgt.clone().index_add_(axis, idx, src)

def _segment_sum(src, seg, n):
    out = torch.zeros((n,) + src.shape[1:], dtype=src.dtype)
    return out.index_add_(0, seg, src)

def _pad(x, pw):
    flat = tuple((v for pair in reversed(pw) for v in pair))
    return torch.nn.functional.pad(x, flat)
kernel_name = 'adaLN_cond__grouped_kv_mqa__glu_gated_glu__prompt'

def setup_inputs():

    _w = lambda a: (lambda t: t.to(torch.bfloat16) if t.is_floating_point() else t)(torch.as_tensor(a))

    def _A_setup():
        B, S, D, H = (1, 2048, 512, 32)
        Dh = D // H
        return {'x': _w((lambda *s: torch.randn(*s, dtype=torch.bfloat16) * 0.05)(B, S, D)), 'wq': _w((lambda *s: torch.randn(*s, dtype=torch.bfloat16) * 0.05)(D, H * Dh)), 'wk': _w((lambda *s: torch.randn(*s, dtype=torch.bfloat16) * 0.05)(D, Dh)), 'wv': _w((lambda *s: torch.randn(*s, dtype=torch.bfloat16) * 0.05)(D, Dh)), 'wo': _w((lambda *s: torch.randn(*s, dtype=torch.bfloat16) * 0.05)(H * Dh, D))}
    _A_in = _A_setup()

    def _B_setup():
        B, S, D, F = (1, 2048, 512, 1792)
        return {'x': _w((lambda *s: torch.randn(*s, dtype=torch.bfloat16) * 0.05)(B, S, D)), 'w_gate': _w((lambda *s: torch.randn(*s, dtype=torch.bfloat16) * 0.05)(D, F)), 'w_up': _w((lambda *s: torch.randn(*s, dtype=torch.bfloat16) * 0.05)(D, F)), 'w_down': _w((lambda *s: torch.randn(*s, dtype=torch.bfloat16) * 0.05)(F, D))}
    _B_in = _B_setup()
    return {'A_x': _A_in['x'], 'A_wq': _A_in['wq'], 'A_wk': _A_in['wk'], 'A_wv': _A_in['wv'], 'A_wo': _A_in['wo'], 'B_x': _B_in['x'], 'B_w_gate': _B_in['w_gate'], 'B_w_up': _B_in['w_up'], 'B_w_down': _B_in['w_down'], 'c': _w((lambda *s: torch.randn(*s, dtype=torch.bfloat16) * 0.1)(1, 512) * 8.0), 'w_mod': _w((lambda *s: torch.randn(*s, dtype=torch.bfloat16) * 0.1)(512, 6 * 512) * 512 ** (-0.5) * 8.0)}

def reference(A_x, A_wq, A_wk, A_wv, A_wo, B_x, B_w_gate, B_w_up, B_w_down, c, w_mod):

    def _A_ref(x, wq, wk, wv, wo):
        B, S, D = x.shape
        H = 32
        Dh = D // H
        q = (lambda x, *d: x.permute(*d))((x @ wq).reshape(B, S, H, Dh), 0, 2, 1, 3)
        k = x @ wk
        v = x @ wv
        scores = torch.einsum('bhqd,bkd->bhqk', q, k) * Dh ** (-0.5)
        p = _softmax(scores, axis=-1)
        o = torch.einsum('bhqk,bkd->bhqd', p, v)
        return (lambda x, *d: x.permute(*d))(o, 0, 2, 1, 3).reshape(B, S, H * Dh) @ wo

    def _B_ref(x, w_gate, w_up, w_down):
        g = torch.einsum('bsd,df->bsf', x, w_gate)
        u = torch.einsum('bsd,df->bsf', x, w_up)
        h = _sigmoid(g) * u
        return torch.einsum('bsf,fd->bsd', h, w_down)
    x = A_x
    mod = (_silu(c) @ w_mod).reshape(c.shape[0], 6, 1, -1)
    sa, ca, ga, sb, cb, gb = (mod[:, 0].clone(), mod[:, 1].clone(), mod[:, 2].clone(), mod[:, 3].clone(), mod[:, 4].clone(), mod[:, 5].clone())
    h = _layernorm(x, axis=-1) * (1 + ca) + sa
    x = x + ga * _A_ref(h, A_wq, A_wk, A_wv, A_wo)
    h = _layernorm(x, axis=-1) * (1 + cb) + sb
    x = x + gb * _B_ref(h, B_w_gate, B_w_up, B_w_down)
    return x
```

```asm
; @launch grid=(256,1,1) block=(256,1,1) lds=163840
.amdgcn_target "amdgcn-amd-amdhsa--gfx950"
.text
.p2align 12
.fill 832, 4, 0xbf810000
.globl adaLN_cond__grouped_kv_mqa__glu_gated_glu__prompt_kernel
.p2align 8
.type adaLN_cond__grouped_kv_mqa__glu_gated_glu__prompt_kernel,@function
adaLN_cond__grouped_kv_mqa__glu_gated_glu__prompt_kernel:
    s_cmp_ge_u32 s2, 256
    s_cbranch_scc1 L_end_adaLN_cond__grouped_kv_mqa__glu_gated_glu__prompt_kernel
    s_load_dwordx8 s[52:59], s[0:1], 64
    s_load_dwordx4 s[60:63], s[0:1], 96
    s_load_dwordx16 s[36:51], s[0:1], 0
    v_lshrrev_b32 v1, 6, v0
    v_and_b32 v2, 63, v0
    v_readfirstlane_b32 s3, v1
    s_getpc_b64 s[24:25]
L_pc:
    s_mov_b32 s26, L_code_end-L_pc
    s_mov_b32 s27, 0x00020000
    s_lshr_b32 s12, s2, 3
    s_lshl_b32 s33, s12, 12
    v_lshl_add_u32 v252, v0, 4, s33
    buffer_load_dwordx4 a[252:255], v252, s[24:27], 0 offen
    s_lshr_b32 s13, s2, 6
    s_and_b32 s34, s12, 7
    s_cmp_eq_u32 s3, 3
    s_cbranch_scc0 L_pre_n3
    s_and_b32 s35, s2, 7
    s_lshl3_add_u32 s33, s35, s34
    s_mul_i32 s15, s13, 24576
    s_add_u32 s15, s33, s15
    s_lshl_b32 s15, s15, 5
    s_add_u32 s15, s15, 3072
    v_lshrrev_b32 v3, 1, v2
    v_and_b32 v4, 1, v2
    v_mul_u32_u24 v5, 24576, v3
    v_lshl_add_u32 v5, v4, 4, v5
    v_add_u32 v5, s15, v5
    v_add_u32 v6, 12288, v5
    s_lshl_b32 s15, s13, 8
    v_lshl_add_u32 v3, v3, 3, s15
    s_waitcnt lgkmcnt(0)
    global_load_dwordx2 v[200:201], v3, s[54:55]
    global_load_dwordx4 v[184:187], v5, s[56:57] offset:-3072
    global_load_dwordx4 v[188:191], v5, s[56:57] offset:3072
    global_load_dwordx4 v[192:195], v6, s[56:57] offset:-3072
    global_load_dwordx4 v[196:199], v6, s[56:57] offset:3072
    s_add_u32 s62, s62, 33554431
    s_addc_u32 s63, s63, 0
    s_and_b32 s62, s62, 0xfe000000
    s_lshl_b32 s33, s2, 10
    s_add_u32 s33, s33, 1048576
    v_lshl_add_u32 v48, v2, 4, s33
    s_and_b32 s33, s2, 3
    s_cselect_b32 s33, 0x3f803f80, -1
    s_cselect_b32 s15, 0, -1
    v_mov_b32 v216, -1
    s_mov_b32 exec_lo, 0
    v_mov_b32 v216, s33
    s_mov_b32 exec_hi, 0xffff0000
    v_mov_b32 v216, s15
    s_mov_b64 exec, -1
    v_mov_b32 v217, v216
    v_mov_b32 v218, v216
    v_mov_b32 v219, v216
    global_store_dwordx4 v48, v[216:219], s[62:63] sc1
L_pre_n3:
    s_and_b32 s32, s2, 7
    s_lshl_b32 s32, s32, 5
    s_add_u32 s32, s32, s12
    s_and_b32 s14, s32, 3
    v_and_b32 v212, 15, v2
    v_bfe_u32 v213, v2, 4, 2
    v_lshlrev_b32 v214, 4, v212
    s_lshr_b32 s19, s32, 2
    s_lshl_b32 s19, s19, 15
    s_lshl3_add_u32 s33, s14, s3
    s_lshl_b32 s33, s33, 8
    s_add_u32 s33, s33, s19
    s_waitcnt lgkmcnt(0)
    v_lshl_add_u32 v23, v213, 13, v214
    v_add_u32 v23, s33, v23
    v_xor_b32 v31, 2048, v23
    v_xor_b32 v39, 4096, v23
    v_xor_b32 v47, 6144, v23
    s_waitcnt lgkmcnt(0)
    global_load_dwordx4 v[16:19], v23, s[36:37] offset:0
    global_load_dwordx4 v[20:23], v23, s[36:37] offset:1024
    global_load_dwordx4 v[24:27], v31, s[36:37] offset:0
    global_load_dwordx4 v[28:31], v31, s[36:37] offset:1024
    global_load_dwordx4 v[32:35], v39, s[36:37] offset:0
    global_load_dwordx4 v[36:39], v39, s[36:37] offset:1024
    global_load_dwordx4 v[40:43], v47, s[36:37] offset:0
    global_load_dwordx4 v[44:47], v47, s[36:37] offset:1024
    s_add_u32 s62, s62, 33554431
    s_addc_u32 s63, s63, 0
    s_and_b32 s62, s62, 0xfe000000
    s_load_dword s5, s[62:63], 18432
    s_and_b32 s33, s2, 3
    s_lshl2_add_u32 s33, s33, s13
    s_bfe_u32 s35, s2, 0x10002
    s_lshl1_add_u32 s33, s33, s35
    s_lshl3_add_u32 s33, s33, s34
    s_lshl_b32 s33, s33, 7
    s_add_u32 s33, s33, 32768
    v_and_b32 v48, 1, v2
    v_lshl_add_u32 v48, v48, 2, v213
    v_lshl_add_u32 v48, v48, 4, s33
    v_lshlrev_b32 v7, 4, v2
    v_mov_b32 v146, 0
    v_mov_b32 v250, 0
    s_mov_b32 s24, s38
    s_mov_b32 s25, s39
    s_mov_b32 s26, 524288
    s_lshl_b32 s15, s3, 12
    s_lshr_b32 s33, s2, 5
    s_and_b32 s30, s33, 4
    s_lshl2_add_u32 s33, s30, s3
    s_lshl_b32 s18, s33, 12
    s_lshl_b32 s33, s14, 8
    s_lshl2_add_u32 s4, s18, s33
    s_lshr_b32 s31, s3, 1
    s_xor_b32 s30, s30, s31
    s_lshl_b32 s30, s30, 14
    s_lshl2_add_u32 s31, s30, s33
    v_lshlrev_b32 v215, 6, v213
    v_xor_b32 v215, v215, v214
    v_lshl_add_u32 v11, v213, 10, v215
    v_add_u32 v12, 3072, v11
    v_add_u32 v13, 6144, v11
    v_add_u32 v8, 9216, v11
    s_mov_b32 s16, 0x05040100
    s_mov_b32 s17, 0x07060302
    s_mov_b32 s61, 0x3f803f80
    s_lshl_b32 s33, s3, 8
    v_lshl_add_u32 v134, v2, 2, s33
    s_add_u32 s33, s33, 151552
    v_and_b32 v215, -4, v2
    v_lshl_add_u32 v147, v215, 2, s33
    v_and_b32 v215, 7, v2
    v_lshl_add_u32 v10, v213, 3, v215
    v_lshlrev_b32 v10, 3, v10
    v_add_u32 v148, 151552, v10
    s_lshl1_add_u32 s33, s15, 36864
    s_add_u32 s28, s62, s33
    s_mov_b32 s29, s63
    s_mov_b32 s74, 65536
    v_and_b32 v252, 31, v2
    v_lshrrev_b32 v254, 5, v2
    v_lshlrev_b32 v10, 9, v212
    v_lshl_add_u32 v10, v213, 7, v10
    v_lshl_add_u32 v10, v215, 4, v10
    s_lshl1_add_u32 s35, s15, 131072
    v_add_u32 v10, s35, v10
    v_lshl_add_u32 v142, v2, 3, s35
    v_lshl_add_u32 v143, v212, 5, s35
    s_lshl_b32 s33, s14, 5
    v_xor_b32 v240, s33, v10
    v_xor_b32 v241, 16, v240
    v_xor_b32 v242, 32, v240
    v_xor_b32 v243, 48, v240
    v_xor_b32 v244, 64, v240
    v_xor_b32 v245, 80, v240
    v_xor_b32 v246, 96, v240
    v_xor_b32 v247, 112, v240
    v_bfe_u32 v3, v2, 2, 2
    v_and_b32 v4, 3, v2
    v_xor_b32 v0, s3, v3
    v_lshlrev_b32 v0, 6, v0
    v_lshl_add_u32 v149, v4, 4, v0
    v_lshrrev_b32 v1, 2, v2
    v_lshl_add_u32 v149, v1, 8, v149
    v_lshl_add_u32 v0, v4, 3, v0
    v_and_b32 v1, 16, v2
    v_lshl_add_u32 v0, v1, 1, v0
    v_lshl_add_u32 v0, v3, 8, v0
    v_lshl_add_u32 v136, v254, 11, v0
    v_add_u32 v137, 0x10000, v136
    v_add_u32 v0, 0, v254
    v_xor_b32 v1, v252, v0
    v_lshlrev_b32 v0, 9, v0
    v_lshl_add_u32 v0, v1, 4, v0
    v_add_u32 v138, 131072, v0
    v_add_u32 v0, 2, v254
    v_xor_b32 v1, v252, v0
    v_lshlrev_b32 v0, 9, v0
    s_cmp_eq_u32 s3, 3
    s_cbranch_scc0 L_pre_e
    s_waitcnt vmcnt(13)
    v_lshlrev_b32 v204, 16, v200
    v_and_b32 v205, 0xffff0000, v200
    v_lshlrev_b32 v206, 16, v201
    v_and_b32 v207, 0xffff0000, v201
    v_mul_f32 v208, 0xbfb8aa3b, v204
    v_mul_f32 v209, 0xbfb8aa3b, v205
    v_mul_f32 v210, 0xbfb8aa3b, v206
    v_mul_f32 v211, 0xbfb8aa3b, v207
    v_exp_f32 v208, v208
    v_exp_f32 v209, v209
    v_exp_f32 v210, v210
    v_exp_f32 v211, v211
    v_add_f32 v208, 1.0, v208
    v_add_f32 v209, 1.0, v209
    v_add_f32 v210, 1.0, v210
    v_add_f32 v211, 1.0, v211
    v_rcp_f32 v208, v208
    v_rcp_f32 v209, v209
    v_rcp_f32 v210, v210
    v_rcp_f32 v211, v211
    v_mul_f32 v204, v204, v208
    v_mul_f32 v205, v205, v209
    v_mul_f32 v206, v206, v210
    v_mul_f32 v207, v207, v211
    v_cvt_pk_bf16_f32 v202, v204, v205
    v_cvt_pk_bf16_f32 v203, v206, v207
    s_waitcnt vmcnt(9) lgkmcnt(0)
    v_perm_b32 v216, v188, v184, s16
    v_perm_b32 v217, v188, v184, s17
    v_perm_b32 v218, v189, v185, s16
    v_perm_b32 v219, v189, v185, s17
    v_perm_b32 v220, v190, v186, s16
    v_perm_b32 v221, v190, v186, s17
    v_perm_b32 v222, v191, v187, s16
    v_perm_b32 v223, v191, v187, s17
    v_perm_b32 v224, v196, v192, s16
    v_perm_b32 v225, v196, v192, s17
    v_perm_b32 v226, v197, v193, s16
    v_perm_b32 v227, v197, v193, s17
    v_perm_b32 v228, v198, v194, s16
    v_perm_b32 v229, v198, v194, s17
    v_perm_b32 v230, v199, v195, s16
    v_perm_b32 v231, v199, v195, s17
    v_dot2_f32_bf16 v232, v216, v202, 0
    v_dot2_f32_bf16 v233, v217, v202, 0
    v_dot2_f32_bf16 v234, v218, v202, 0
    v_dot2_f32_bf16 v235, v219, v202, 0
    v_dot2_f32_bf16 v236, v220, v202, 0
    v_dot2_f32_bf16 v237, v221, v202, 0
    v_dot2_f32_bf16 v238, v222, v202, 0
    v_dot2_f32_bf16 v239, v223, v202, 0
    v_dot2_f32_bf16 v232, v224, v203, v232
    v_dot2_f32_bf16 v233, v225, v203, v233
    v_dot2_f32_bf16 v234, v226, v203, v234
    v_dot2_f32_bf16 v235, v227, v203, v235
    v_dot2_f32_bf16 v236, v228, v203, v236
    v_dot2_f32_bf16 v237, v229, v203, v237
    v_dot2_f32_bf16 v238, v230, v203, v238
    v_dot2_f32_bf16 v239, v231, v203, v239
    s_mul_i32 s75, s5, 0x9e3779b1
    s_add_u32 s75, s75, 0x7f4a7c15
    v_permlane32_swap_b32 v232, v236
    v_permlane32_swap_b32 v233, v237
    v_permlane32_swap_b32 v234, v238
    v_permlane32_swap_b32 v235, v239
    v_add_f32 v232, v232, v236
    v_add_f32 v233, v233, v237
    v_add_f32 v234, v234, v238
    v_add_f32 v235, v235, v239
    v_mov_b32 v217, s75
    v_permlane16_swap_b32 v232, v234
    v_permlane16_swap_b32 v233, v235
    v_add_f32 v216, v232, v234
    v_add_f32 v218, v233, v235
    v_mov_b32 v219, s75
    v_add_f32_dpp v216, v216, v216 row_ror:2 row_mask:0xf bank_mask:0xf
    v_add_f32_dpp v218, v218, v218 row_ror:2 row_mask:0xf bank_mask:0xf
    s_nop 0
    v_add_f32_dpp v216, v216, v216 row_ror:4 row_mask:0xf bank_mask:0xf
    v_add_f32_dpp v218, v218, v218 row_ror:4 row_mask:0xf bank_mask:0xf
    s_nop 0
    v_add_f32_dpp v216, v216, v216 row_ror:8 row_mask:0xf bank_mask:0xf
    v_add_f32_dpp v218, v218, v218 row_ror:8 row_mask:0xf bank_mask:0xf
    s_mov_b32 exec_lo, 0x00030003
    s_mov_b32 exec_hi, 0x00030003
    s_waitcnt vmcnt(8)
    global_store_dwordx4 v48, v[216:219], s[62:63] sc1
    s_mov_b64 exec, -1
    s_waitcnt vmcnt(1)
    s_branch L_pre_x
L_pre_e:
    s_cmp_eq_u32 s3, 0
    s_cbranch_scc1 L_e1_0
    s_cmp_eq_u32 s3, 2
    s_cselect_b64 s[64:65], s[44:45], s[38:39]
    s_lshl_b32 s13, s2, 11
    v_lshl_add_u32 v112, v212, 7, s13
    global_load_dword a0, v112, s[64:65]
    s_add_u32 m0, s30, 0
    s_add_u32 s13, s31, 0
    buffer_load_dwordx4 v11, s[24:27], s13 offen offset:0 lds
    buffer_load_dwordx4 v12, s[24:27], s13 offen offset:1024 lds
    buffer_load_dwordx4 v13, s[24:27], s13 offen offset:2048 lds
    buffer_load_dwordx4 v8, s[24:27], s13 offen offset:3072 lds
    s_add_u32 m0, s30, 4096
    s_add_u32 s13, s31, 16384
    buffer_load_dwordx4 v11, s[24:27], s13 offen offset:0 lds
    buffer_load_dwordx4 v12, s[24:27], s13 offen offset:1024 lds
    buffer_load_dwordx4 v13, s[24:27], s13 offen offset:2048 lds
    buffer_load_dwordx4 v8, s[24:27], s13 offen offset:3072 lds
    s_add_u32 m0, s30, 8192
    s_add_u32 s13, s31, 32768
    buffer_load_dwordx4 v11, s[24:27], s13 offen offset:0 lds
    buffer_load_dwordx4 v12, s[24:27], s13 offen offset:1024 lds
    buffer_load_dwordx4 v13, s[24:27], s13 offen offset:2048 lds
    buffer_load_dwordx4 v8, s[24:27], s13 offen offset:3072 lds
    s_add_u32 m0, s30, 12288
    s_add_u32 s13, s31, 49152
    buffer_load_dwordx4 v11, s[24:27], s13 offen offset:0 lds
    buffer_load_dwordx4 v12, s[24:27], s13 offen offset:1024 lds
    buffer_load_dwordx4 v13, s[24:27], s13 offen offset:2048 lds
    buffer_load_dwordx4 v8, s[24:27], s13 offen offset:3072 lds
    s_cmp_eq_u32 s3, 1
    s_cbranch_scc0 L_e1_2
    s_mov_b64 exec, 0
    s_branch L_w1
L_wb_A1:
    s_mov_b64 exec, -1
    s_branch L_e1_e
L_e1_2:
    s_mov_b64 exec, 0
    s_branch L_w2
L_wb_A2:
    s_mov_b64 exec, -1
    s_branch L_e1_e
L_e1_0:
    v_lshrrev_b32 v5, 1, v212
    v_xor_b32 v5, v5, v212
    s_lshl_b32 s33, s14, 1
    v_and_b32 v5, s33, v5
    v_and_b32 v5, 4, v5
    v_lshl_add_u32 v5, v5, 1, v5
    v_xor_b32 v5, v5, v212
    s_and_b32 s33, s14, 1
    v_lshl_add_u32 v5, s33, 4, v5
    v_add_u32 v6, 0, v213
    v_xor_b32 v9, v5, v6
    v_lshlrev_b32 v6, 9, v6
    v_lshl_add_u32 v6, v9, 4, v6
    v_add_u32 v144, 131072, v6
    v_add_u32 v6, 4, v213
    v_xor_b32 v9, v5, v6
    v_lshlrev_b32 v6, 9, v6
    v_lshl_add_u32 v6, v9, 4, v6
    v_add_u32 v145, 131072, v6
    s_lshr_b32 s34, s14, 1
    s_sub_u32 s33, 9, s34
    v_lshl_add_u32 v146, v213, s33, v214
    s_lshl_b32 s33, s14, 8
    s_lshl_b32 s34, s14, 10
    s_sub_u32 s34, s34, 1024
    s_cmp_lt_u32 s14, 2
    s_cselect_b32 s33, s33, s34
    s_lshr_b32 s34, s2, 6
    s_and_b32 s35, s2, 7
    s_lshl3_add_u32 s34, s34, s35
    s_bfe_u32 s35, s2, 0x10005
    s_lshl1_add_u32 s34, s34, s35
    s_lshl_b32 s34, s34, 12
    s_add_u32 s33, s33, s34
    s_add_u32 s33, s33, 1048576
    v_add_u32 v146, s33, v146
    v_lshlrev_b32 v15, 3, v212
    v_lshl_add_u32 v15, v213, 8, v15
    v_add_u32 v15, 131072, v15
    s_cmp_lt_u32 s14, 2
    s_cselect_b32 s68, s40, s42
    s_cselect_b32 s69, s41, s43
    s_mov_b32 s70, 16384
    s_mov_b32 s71, s27
    s_mov_b32 m0, 131072
    s_mov_b32 s13, 0
    buffer_load_dwordx4 v7, s[68:71], s13 offen offset:0 lds
    buffer_load_dwordx4 v7, s[68:71], s13 offen offset:1024 lds
    buffer_load_dwordx4 v7, s[68:71], s13 offen offset:2048 lds
    buffer_load_dwordx4 v7, s[68:71], s13 offen offset:3072 lds
    s_mov_b32 m0, 135168
    s_mov_b32 s13, 4096
    buffer_load_dwordx4 v7, s[68:71], s13 offen offset:0 lds
    buffer_load_dwordx4 v7, s[68:71], s13 offen offset:1024 lds
    buffer_load_dwordx4 v7, s[68:71], s13 offen offset:2048 lds
    buffer_load_dwordx4 v7, s[68:71], s13 offen offset:3072 lds
    s_mov_b32 m0, 139264
    s_mov_b32 s13, 8192
    buffer_load_dwordx4 v7, s[68:71], s13 offen offset:0 lds
    buffer_load_dwordx4 v7, s[68:71], s13 offen offset:1024 lds
    buffer_load_dwordx4 v7, s[68:71], s13 offen offset:2048 lds
    buffer_load_dwordx4 v7, s[68:71], s13 offen offset:3072 lds
    s_mov_b32 m0, 143360
    s_mov_b32 s13, 12288
    buffer_load_dwordx4 v7, s[68:71], s13 offen offset:0 lds
    buffer_load_dwordx4 v7, s[68:71], s13 offen offset:1024 lds
    buffer_load_dwordx4 v7, s[68:71], s13 offen offset:2048 lds
    buffer_load_dwordx4 v7, s[68:71], s13 offen offset:3072 lds
L_e1_e:
    s_waitcnt vmcnt(16)
L_pre_x:
    s_cmp_lt_u32 s2, 224
    s_cbranch_scc1 L_pre_nwl
    s_and_b32 s33, s2, 1
    s_lshl2_add_u32 s35, s33, s3
    s_bfe_u32 s34, s2, 0x40001
    s_lshl_b32 s33, s34, 8
    s_add_u32 s33, s33, s35
    s_lshl_b32 s33, s33, 7
    s_add_u32 s33, s33, 4096
    v_lshl_add_u32 v248, v213, 10, v212
    v_lshl_add_u32 v248, v248, 3, s33
    global_load_dwordx2 v[216:217], v248, s[44:45] offset:-4096
    global_load_dwordx2 v[218:219], v248, s[44:45] offset:-3072
    global_load_dwordx2 v[224:225], v248, s[44:45] offset:-2048
    global_load_dwordx2 v[226:227], v248, s[44:45] offset:-1024
    global_load_dwordx2 v[220:221], v248, s[44:45] offset:0
    global_load_dwordx2 v[222:223], v248, s[44:45] offset:1024
    global_load_dwordx2 v[228:229], v248, s[44:45] offset:2048
    global_load_dwordx2 v[230:231], v248, s[44:45] offset:3072
    s_lshr_b32 s33, s35, 1
    s_lshr_b32 s13, s34, 1
    s_lshl3_add_u32 s33, s33, s13
    s_and_b32 s13, s34, 1
    s_lshl4_add_u32 s33, s33, s13
    s_and_b32 s13, s35, 1
    s_lshl3_add_u32 s33, s33, s13
    s_lshl_b32 s33, s33, 7
    s_add_u32 s33, s33, 528384
    v_and_b32 v250, 1, v2
    v_lshl_add_u32 v250, v250, 5, v213
    v_lshl_add_u32 v250, v250, 8, s33
    v_and_b32 v249, 14, v2
    v_lshl_add_u32 v250, v249, 3, v250
L_pre_nwl:
    s_xor_b32 m0, s18, 32768
    s_xor_b32 s13, s4, 131072
    buffer_load_dwordx4 v11, s[24:27], s13 offen offset:0 lds
    v_dot2_f32_bf16 v112, v16, s61, 0
    v_dot2_f32_bf16 v113, v16, v16, 0
    v_dot2_f32_bf16 v114, v20, s61, 0
    v_dot2_f32_bf16 v115, v20, v20, 0
    v_dot2_f32_bf16 v116, v24, s61, 0
    v_dot2_f32_bf16 v117, v24, v24, 0
    v_dot2_f32_bf16 v118, v28, s61, 0
    v_dot2_f32_bf16 v119, v28, v28, 0
    v_dot2_f32_bf16 v120, v32, s61, 0
    v_dot2_f32_bf16 v121, v32, v32, 0
    v_dot2_f32_bf16 v122, v36, s61, 0
    v_dot2_f32_bf16 v123, v36, v36, 0
    v_dot2_f32_bf16 v124, v40, s61, 0
    v_dot2_f32_bf16 v125, v40, v40, 0
    v_dot2_f32_bf16 v126, v44, s61, 0
    v_dot2_f32_bf16 v127, v44, v44, 0
    v_dot2_f32_bf16 v112, v17, s61, v112
    v_dot2_f32_bf16 v113, v17, v17, v113
    v_dot2_f32_bf16 v114, v21, s61, v114
    v_dot2_f32_bf16 v115, v21, v21, v115
    v_dot2_f32_bf16 v116, v25, s61, v116
    v_dot2_f32_bf16 v117, v25, v25, v117
    v_dot2_f32_bf16 v118, v29, s61, v118
    v_dot2_f32_bf16 v119, v29, v29, v119
    v_dot2_f32_bf16 v120, v33, s61, v120
    v_dot2_f32_bf16 v121, v33, v33, v121
    v_dot2_f32_bf16 v122, v37, s61, v122
    v_dot2_f32_bf16 v123, v37, v37, v123
    v_dot2_f32_bf16 v124, v41, s61, v124
    buffer_load_dwordx4 v12, s[24:27], s13 offen offset:1024 lds
    v_dot2_f32_bf16 v125, v41, v41, v125
    v_dot2_f32_bf16 v126, v45, s61, v126
    v_dot2_f32_bf16 v127, v45, v45, v127
    v_dot2_f32_bf16 v112, v18, s61, v112
    v_dot2_f32_bf16 v113, v18, v18, v113
    v_dot2_f32_bf16 v114, v22, s61, v114
    v_dot2_f32_bf16 v115, v22, v22, v115
    v_dot2_f32_bf16 v116, v26, s61, v116
    v_dot2_f32_bf16 v117, v26, v26, v117
    v_dot2_f32_bf16 v118, v30, s61, v118
    v_dot2_f32_bf16 v119, v30, v30, v119
    v_dot2_f32_bf16 v120, v34, s61, v120
    v_dot2_f32_bf16 v121, v34, v34, v121
    v_dot2_f32_bf16 v122, v38, s61, v122
    v_dot2_f32_bf16 v123, v38, v38, v123
    v_dot2_f32_bf16 v124, v42, s61, v124
    v_dot2_f32_bf16 v125, v42, v42, v125
    v_dot2_f32_bf16 v126, v46, s61, v126
    v_dot2_f32_bf16 v127, v46, v46, v127
    v_dot2_f32_bf16 v112, v19, s61, v112
    v_dot2_f32_bf16 v113, v19, v19, v113
    v_dot2_f32_bf16 v114, v23, s61, v114
    v_dot2_f32_bf16 v115, v23, v23, v115
    v_dot2_f32_bf16 v116, v27, s61, v116
    v_dot2_f32_bf16 v117, v27, v27, v117
    v_dot2_f32_bf16 v118, v31, s61, v118
    v_dot2_f32_bf16 v119, v31, v31, v119
    v_dot2_f32_bf16 v120, v35, s61, v120
    buffer_load_dwordx4 v13, s[24:27], s13 offen offset:2048 lds
    v_dot2_f32_bf16 v121, v35, v35, v121
    v_dot2_f32_bf16 v122, v39, s61, v122
    v_dot2_f32_bf16 v123, v39, v39, v123
    v_dot2_f32_bf16 v124, v43, s61, v124
    v_dot2_f32_bf16 v125, v43, v43, v125
    v_dot2_f32_bf16 v126, v47, s61, v126
    v_dot2_f32_bf16 v127, v47, v47, v127
    v_add_f32_dpp v112, v112, v112 row_ror:8 row_mask:0xf bank_mask:0x3
    v_add_f32_dpp v113, v113, v113 row_ror:8 row_mask:0xf bank_mask:0x3
    v_add_f32_dpp v114, v114, v114 row_ror:8 row_mask:0xf bank_mask:0x3
    v_add_f32_dpp v115, v115, v115 row_ror:8 row_mask:0xf bank_mask:0x3
    v_add_f32_dpp v116, v116, v116 row_ror:8 row_mask:0xf bank_mask:0x3
    v_add_f32_dpp v117, v117, v117 row_ror:8 row_mask:0xf bank_mask:0x3
    v_add_f32_dpp v118, v118, v118 row_ror:8 row_mask:0xf bank_mask:0x3
    v_add_f32_dpp v119, v119, v119 row_ror:8 row_mask:0xf bank_mask:0x3
    v_add_f32_dpp v112, v120, v120 row_ror:8 row_mask:0xf bank_mask:0xc
    v_add_f32_dpp v113, v121, v121 row_ror:8 row_mask:0xf bank_mask:0xc
    v_add_f32_dpp v114, v122, v122 row_ror:8 row_mask:0xf bank_mask:0xc
    v_add_f32_dpp v115, v123, v123 row_ror:8 row_mask:0xf bank_mask:0xc
    v_add_f32_dpp v116, v124, v124 row_ror:8 row_mask:0xf bank_mask:0xc
    v_add_f32_dpp v117, v125, v125 row_ror:8 row_mask:0xf bank_mask:0xc
    v_add_f32_dpp v118, v126, v126 row_ror:8 row_mask:0xf bank_mask:0xc
    v_add_f32_dpp v119, v127, v127 row_ror:8 row_mask:0xf bank_mask:0xc
    v_add_f32_dpp v112, v112, v112 row_shl:4 row_mask:0xf bank_mask:0x5
    v_add_f32_dpp v113, v113, v113 row_shl:4 row_mask:0xf bank_mask:0x5
    v_add_f32_dpp v114, v114, v114 row_shl:4 row_mask:0xf bank_mask:0x5
    v_add_f32_dpp v115, v115, v115 row_shl:4 row_mask:0xf bank_mask:0x5
    v_add_f32_dpp v112, v116, v116 row_shr:4 row_mask:0xf bank_mask:0xa
    buffer_load_dwordx4 v8, s[24:27], s13 offen offset:3072 lds
    v_add_f32_dpp v113, v117, v117 row_shr:4 row_mask:0xf bank_mask:0xa
    v_add_f32_dpp v114, v118, v118 row_shr:4 row_mask:0xf bank_mask:0xa
    v_add_f32_dpp v115, v119, v119 row_shr:4 row_mask:0xf bank_mask:0xa
    v_add_f32_dpp v112, v112, v112 quad_perm:[1,0,3,2] row_mask:0xf bank_mask:0xf
    v_add_f32_dpp v113, v113, v113 quad_perm:[1,0,3,2] row_mask:0xf bank_mask:0xf
    v_add_f32_dpp v114, v114, v114 quad_perm:[1,0,3,2] row_mask:0xf bank_mask:0xf
    v_add_f32_dpp v115, v115, v115 quad_perm:[1,0,3,2] row_mask:0xf bank_mask:0xf
    v_add_f32_dpp v112, v112, v112 quad_perm:[2,3,0,1] row_mask:0xf bank_mask:0xf
    v_add_f32_dpp v113, v113, v113 quad_perm:[2,3,0,1] row_mask:0xf bank_mask:0xf
    v_add_f32_dpp v114, v114, v114 quad_perm:[2,3,0,1] row_mask:0xf bank_mask:0xf
    v_add_f32_dpp v115, v115, v115 quad_perm:[2,3,0,1] row_mask:0xf bank_mask:0xf
    ds_write_b128 v147, v[112:115]
    v_lshlrev_b32 v48, 16, v16
    v_and_b32 v49, 0xffff0000, v16
    v_lshlrev_b32 v50, 16, v17
    v_and_b32 v51, 0xffff0000, v17
    v_lshlrev_b32 v52, 16, v18
    v_and_b32 v53, 0xffff0000, v18
    v_lshlrev_b32 v54, 16, v19
    v_and_b32 v55, 0xffff0000, v19
    v_lshlrev_b32 v56, 16, v20
    v_and_b32 v57, 0xffff0000, v20
    v_lshlrev_b32 v58, 16, v21
    v_and_b32 v59, 0xffff0000, v21
    v_lshlrev_b32 v60, 16, v22
    v_and_b32 v61, 0xffff0000, v22
    v_lshlrev_b32 v62, 16, v23
    v_and_b32 v63, 0xffff0000, v23
    s_waitcnt lgkmcnt(0)
    s_barrier
    ds_read2_b64 v[112:115], v148 offset0:0 offset1:32
    ds_read2_b64 v[116:119], v148 offset0:64 offset1:96
    global_load_dword v134, v134, s[54:55]
    s_and_b32 s33, s2, 7
    s_cbranch_scc1 L_pre_s0
    global_load_dwordx4 v[152:155], v7, s[28:29] offset:-4096 sc1
    global_load_dwordx4 v[156:159], v7, s[28:29] offset:-3072 sc1
    global_load_dwordx4 v[160:163], v7, s[28:29] offset:-2048 sc1
    global_load_dwordx4 v[164:167], v7, s[28:29] offset:-1024 sc1
    global_load_dwordx4 v[168:171], v7, s[28:29] offset:0 sc1
    global_load_dwordx4 v[172:175], v7, s[28:29] offset:1024 sc1
    global_load_dwordx4 v[176:179], v7, s[28:29] offset:2048 sc1
    global_load_dwordx4 v[180:183], v7, s[28:29] offset:3072 sc1
L_pre_s0:
    v_lshlrev_b32 v64, 16, v24
    v_and_b32 v65, 0xffff0000, v24
    v_lshlrev_b32 v66, 16, v25
    v_and_b32 v67, 0xffff0000, v25
    v_lshlrev_b32 v68, 16, v26
    v_and_b32 v69, 0xffff0000, v26
    v_lshlrev_b32 v70, 16, v27
    v_and_b32 v71, 0xffff0000, v27
    v_lshlrev_b32 v72, 16, v28
    v_and_b32 v73, 0xffff0000, v28
    v_lshlrev_b32 v74, 16, v29
    v_and_b32 v75, 0xffff0000, v29
    s_xor_b32 m0, s18, 49152
    s_xor_b32 s13, s4, 196608
    buffer_load_dwordx4 v11, s[24:27], s13 offen offset:0 lds
    v_lshlrev_b32 v76, 16, v30
    v_and_b32 v77, 0xffff0000, v30
    v_lshlrev_b32 v78, 16, v31
    v_and_b32 v79, 0xffff0000, v31
    v_lshlrev_b32 v80, 16, v32
    v_and_b32 v81, 0xffff0000, v32
    v_lshlrev_b32 v82, 16, v33
    v_and_b32 v83, 0xffff0000, v33
    v_lshlrev_b32 v84, 16, v34
    v_and_b32 v85, 0xffff0000, v34
    v_lshlrev_b32 v86, 16, v35
    v_and_b32 v87, 0xffff0000, v35
    v_lshlrev_b32 v88, 16, v36
    buffer_load_dwordx4 v12, s[24:27], s13 offen offset:1024 lds
    v_and_b32 v89, 0xffff0000, v36
    v_lshlrev_b32 v90, 16, v37
    v_and_b32 v91, 0xffff0000, v37
    v_lshlrev_b32 v92, 16, v38
    v_and_b32 v93, 0xffff0000, v38
    v_lshlrev_b32 v94, 16, v39
    v_and_b32 v95, 0xffff0000, v39
    v_lshlrev_b32 v96, 16, v40
    v_and_b32 v97, 0xffff0000, v40
    v_lshlrev_b32 v98, 16, v41
    v_and_b32 v99, 0xffff0000, v41
    v_lshlrev_b32 v100, 16, v42
    v_and_b32 v101, 0xffff0000, v42
    buffer_load_dwordx4 v13, s[24:27], s13 offen offset:2048 lds
    v_lshlrev_b32 v102, 16, v43
    v_and_b32 v103, 0xffff0000, v43
    v_lshlrev_b32 v104, 16, v44
    v_and_b32 v105, 0xffff0000, v44
    v_lshlrev_b32 v106, 16, v45
    v_and_b32 v107, 0xffff0000, v45
    v_lshlrev_b32 v108, 16, v46
    v_and_b32 v109, 0xffff0000, v46
    v_lshlrev_b32 v110, 16, v47
    v_and_b32 v111, 0xffff0000, v47
    s_mul_i32 s5, s5, 0x9e3779b1
    s_add_u32 s5, s5, 0x7f4a7c15
    s_waitcnt lgkmcnt(0)
    buffer_load_dwordx4 v8, s[24:27], s13 offen offset:3072 lds
    v_pk_add_f32 v[112:113], v[112:113], v[114:115]
    v_pk_add_f32 v[116:117], v[116:117], v[118:119]
    v_pk_add_f32 v[112:113], v[112:113], v[116:117]
    v_mul_f32 v112, 0x3b000000, v112
    v_mul_f32 v113, 0x3b000000, v113
    v_fma_f32 v113, -v112, v112, v113
    v_max_f32 v113, 0, v113
    v_add_f32 v113, 0x3727c5ac, v113
    v_rsq_f32 v114, v113
    s_lshl_b32 s75, s5, 4
    v_mul_f32 v115, -v112, v114
    s_nop 1
    v_mov_b64_dpp v[16:17], v[114:115] row_newbcast:0 row_mask:0xf bank_mask:0xf
    v_mov_b64_dpp v[18:19], v[114:115] row_newbcast:1 row_mask:0xf bank_mask:0xf
    s_xor_b32 m0, s18, 65536
    s_xor_b32 s13, s4, 262144
    buffer_load_dwordx4 v11, s[24:27], s13 offen offset:0 lds
    v_mov_b64_dpp v[20:21], v[114:115] row_newbcast:2 row_mask:0xf bank_mask:0xf
    v_mov_b64_dpp v[22:23], v[114:115] row_newbcast:3 row_mask:0xf bank_mask:0xf
    v_mov_b64_dpp v[24:25], v[114:115] row_newbcast:4 row_mask:0xf bank_mask:0xf
    v_mov_b64_dpp v[26:27], v[114:115] row_newbcast:5 row_mask:0xf bank_mask:0xf
    v_mov_b64_dpp v[28:29], v[114:115] row_newbcast:6 row_mask:0xf bank_mask:0xf
    v_mov_b64_dpp v[30:31], v[114:115] row_newbcast:7 row_mask:0xf bank_mask:0xf
    v_pk_fma_f32 v[48:49], v[48:49], v[16:17], v[16:17] op_sel:[0,0,1] op_sel_hi:[1,0,1]
    v_pk_fma_f32 v[50:51], v[50:51], v[16:17], v[16:17] op_sel:[0,0,1] op_sel_hi:[1,0,1]
    v_pk_fma_f32 v[52:53], v[52:53], v[16:17], v[16:17] op_sel:[0,0,1] op_sel_hi:[1,0,1]
    v_pk_fma_f32 v[54:55], v[54:55], v[16:17], v[16:17] op_sel:[0,0,1] op_sel_hi:[1,0,1]
    v_pk_fma_f32 v[56:57], v[56:57], v[18:19], v[18:19] op_sel:[0,0,1] op_sel_hi:[1,0,1]
    v_pk_fma_f32 v[58:59], v[58:59], v[18:19], v[18:19] op_sel:[0,0,1] op_sel_hi:[1,0,1]
    v_pk_fma_f32 v[60:61], v[60:61], v[18:19], v[18:19] op_sel:[0,0,1] op_sel_hi:[1,0,1]
    buffer_load_dwordx4 v12, s[24:27], s13 offen offset:1024 lds
    v_pk_fma_f32 v[62:63], v[62:63], v[18:19], v[18:19] op_sel:[0,0,1] op_sel_hi:[1,0,1]
L_w1:
    s_cbranch_execz L_wb_A1
    v_pk_fma_f32 v[64:65], v[64:65], v[20:21], v[20:21] op_sel:[0,0,1] op_sel_hi:[1,0,1]
    v_pk_fma_f32 v[66:67], v[66:67], v[20:21], v[20:21] op_sel:[0,0,1] op_sel_hi:[1,0,1]
    v_pk_fma_f32 v[68:69], v[68:69], v[20:21], v[20:21] op_sel:[0,0,1] op_sel_hi:[1,0,1]
    v_pk_fma_f32 v[70:71], v[70:71], v[20:21], v[20:21] op_sel:[0,0,1] op_sel_hi:[1,0,1]
    v_pk_fma_f32 v[72:73], v[72:73], v[22:23], v[22:23] op_sel:[0,0,1] op_sel_hi:[1,0,1]
    v_pk_fma_f32 v[74:75], v[74:75], v[22:23], v[22:23] op_sel:[0,0,1] op_sel_hi:[1,0,1]
    v_pk_fma_f32 v[76:77], v[76:77], v[22:23], v[22:23] op_sel:[0,0,1] op_sel_hi:[1,0,1]
    v_pk_fma_f32 v[78:79], v[78:79], v[22:23], v[22:23] op_sel:[0,0,1] op_sel_hi:[1,0,1]
    v_pk_fma_f32 v[80:81], v[80:81], v[24:25], v[24:25] op_sel:[0,0,1] op_sel_hi:[1,0,1]
    v_pk_fma_f32 v[82:83], v[82:83], v[24:25], v[24:25] op_sel:[0,0,1] op_sel_hi:[1,0,1]
    v_pk_fma_f32 v[84:85], v[84:85], v[24:25], v[24:25] op_sel:[0,0,1] op_sel_hi:[1,0,1]
    v_pk_fma_f32 v[86:87], v[86:87], v[24:25], v[24:25] op_sel:[0,0,1] op_sel_hi:[1,0,1]
    buffer_load_dwordx4 v13, s[24:27], s13 offen offset:2048 lds
    v_pk_fma_f32 v[88:89], v[88:89], v[26:27], v[26:27] op_sel:[0,0,1] op_sel_hi:[1,0,1]
    v_pk_fma_f32 v[90:91], v[90:91], v[26:27], v[26:27] op_sel:[0,0,1] op_sel_hi:[1,0,1]
    v_pk_fma_f32 v[92:93], v[92:93], v[26:27], v[26:27] op_sel:[0,0,1] op_sel_hi:[1,0,1]
    v_pk_fma_f32 v[94:95], v[94:95], v[26:27], v[26:27] op_sel:[0,0,1] op_sel_hi:[1,0,1]
    v_pk_fma_f32 v[96:97], v[96:97], v[28:29], v[28:29] op_sel:[0,0,1] op_sel_hi:[1,0,1]
    v_pk_fma_f32 v[98:99], v[98:99], v[28:29], v[28:29] op_sel:[0,0,1] op_sel_hi:[1,0,1]
    v_pk_fma_f32 v[100:101], v[100:101], v[28:29], v[28:29] op_sel:[0,0,1] op_sel_hi:[1,0,1]
    v_pk_fma_f32 v[102:103], v[102:103], v[28:29], v[28:29] op_sel:[0,0,1] op_sel_hi:[1,0,1]
    v_pk_fma_f32 v[104:105], v[104:105], v[30:31], v[30:31] op_sel:[0,0,1] op_sel_hi:[1,0,1]
    v_pk_fma_f32 v[106:107], v[106:107], v[30:31], v[30:31] op_sel:[0,0,1] op_sel_hi:[1,0,1]
    v_pk_fma_f32 v[108:109], v[108:109], v[30:31], v[30:31] op_sel:[0,0,1] op_sel_hi:[1,0,1]
    v_pk_fma_f32 v[110:111], v[110:111], v[30:31], v[30:31] op_sel:[0,0,1] op_sel_hi:[1,0,1]
    s_and_b32 s33, s2, 7
    s_cbranch_scc0 L_pre_s1
    global_load_dwordx4 v[152:155], v7, s[28:29] offset:-4096 sc1
    global_load_dwordx4 v[156:159], v7, s[28:29] offset:-3072 sc1
    global_load_dwordx4 v[160:163], v7, s[28:29] offset:-2048 sc1
    global_load_dwordx4 v[164:167], v7, s[28:29] offset:-1024 sc1
    global_load_dwordx4 v[168:171], v7, s[28:29] offset:0 sc1
    global_load_dwordx4 v[172:175], v7, s[28:29] offset:1024 sc1
    global_load_dwordx4 v[176:179], v7, s[28:29] offset:2048 sc1
    global_load_dwordx4 v[180:183], v7, s[28:29] offset:3072 sc1
L_pre_s1:
    s_cmp_eq_u32 s3, 0
    s_cbranch_scc0 L_pre_nokv
    s_waitcnt vmcnt(12)
    ds_read_b64_tr_b16 a[128:129], v15 offset:0
    ds_read_b64_tr_b16 a[130:131], v15 offset:128
    ds_read_b64_tr_b16 a[132:133], v15 offset:1024
    ds_read_b64_tr_b16 a[134:135], v15 offset:1152
    ds_read_b64_tr_b16 a[136:137], v15 offset:2048
    ds_read_b64_tr_b16 a[138:139], v15 offset:2176
    ds_read_b64_tr_b16 a[140:141], v15 offset:3072
    ds_read_b64_tr_b16 a[142:143], v15 offset:3200
    ds_read_b64_tr_b16 a[144:145], v15 offset:4096
    ds_read_b64_tr_b16 a[146:147], v15 offset:4224
    ds_read_b64_tr_b16 a[148:149], v15 offset:5120
    ds_read_b64_tr_b16 a[150:151], v15 offset:5248
    s_waitcnt lgkmcnt(4)
    ds_read_b64_tr_b16 a[152:153], v15 offset:6144
    ds_read_b64_tr_b16 a[154:155], v15 offset:6272
    ds_read_b64_tr_b16 a[156:157], v15 offset:7168
    ds_read_b64_tr_b16 a[158:159], v15 offset:7296
    ds_read_b64_tr_b16 a[160:161], v15 offset:8192
    ds_read_b64_tr_b16 a[162:163], v15 offset:8320
    ds_read_b64_tr_b16 a[164:165], v15 offset:9216
    ds_read_b64_tr_b16 a[166:167], v15 offset:9344
    s_waitcnt lgkmcnt(4)
    ds_read_b64_tr_b16 a[168:169], v15 offset:10240
    ds_read_b64_tr_b16 a[170:171], v15 offset:10368
    ds_read_b64_tr_b16 a[172:173], v15 offset:11264
    ds_read_b64_tr_b16 a[174:175], v15 offset:11392
    ds_read_b64_tr_b16 a[176:177], v15 offset:12288
    ds_read_b64_tr_b16 a[178:179], v15 offset:12416
    ds_read_b64_tr_b16 a[180:181], v15 offset:13312
    ds_read_b64_tr_b16 a[182:183], v15 offset:13440
    s_waitcnt lgkmcnt(4)
    ds_read_b64_tr_b16 a[184:185], v15 offset:14336
    ds_read_b64_tr_b16 a[186:187], v15 offset:14464
    ds_read_b64_tr_b16 a[188:189], v15 offset:15360
    ds_read_b64_tr_b16 a[190:191], v15 offset:15488
L_pre_nokv:
    buffer_load_dwordx4 v8, s[24:27], s13 offen offset:3072 lds
    v_lshl_add_u32 v0, v1, 4, v0
    v_add_u32 v139, 131072, v0
    v_add_u32 v0, 4, v254
    v_xor_b32 v1, v252, v0
    v_lshlrev_b32 v0, 9, v0
    v_lshl_add_u32 v0, v1, 4, v0
    v_add_u32 v140, 131072, v0
    v_add_u32 v0, 6, v254
    v_xor_b32 v1, v252, v0
    v_lshlrev_b32 v0, 9, v0
    v_lshl_add_u32 v0, v1, 4, v0
    v_add_u32 v141, 131072, v0
    s_xor_b32 m0, s18, 81920
    s_xor_b32 s13, s4, 327680
    buffer_load_dwordx4 v11, s[24:27], s13 offen offset:0 lds
    s_mov_b32 s20, s62
    s_mov_b32 s21, s63
    s_mov_b32 s22, 25165824
    s_mov_b32 s23, s27
    s_and_b32 s34, s2, 7
    s_lshl_b32 s34, s34, 5
    v_and_b32 v5, -4, v2
    v_lshlrev_b32 v5, 2, v5
    v_xor_b32 v5, s34, v5
    v_lshlrev_b32 v6, v4, 1
    buffer_load_dwordx4 v12, s[24:27], s13 offen offset:1024 lds
    v_add_u32 v5, v6, v5
    s_lshl4_add_u32 s33, s15, 1048576
    v_lshl_add_u32 v253, v5, 8, s33
    s_lshl_b32 s34, s34, 8
    s_add_u32 s33, s33, s34
    s_add_u32 s33, s33, s62
    s_add_u32 s60, s33, 4096
    s_mov_b32 s41, s63
    v_lshl_add_u32 v9, v254, 8, v214
    v_and_b32 v5, 16, v2
    v_cmp_eq_u32 vcc, 0, v5
    v_and_b32 v5, 11, v2
    v_min_u32 v5, 1, v5
    v_add_lshl_u32 v5, v5, 2, 8
    v_cndmask_b32 v9, v5, v9, vcc
    buffer_load_dwordx4 v13, s[24:27], s13 offen offset:2048 lds
    v_lshrrev_b32 v14, 3, v252
    v_lshlrev_b32 v14, 13, v14
    v_lshl_add_u32 v14, v254, 7, v14
    v_lshl_add_u32 v14, v215, 4, v14
    s_lshl2_add_u32 s33, s14, s3
    s_lshl_b32 s33, s33, 9
    s_add_u32 s33, s33, s19
    buffer_load_dwordx4 v8, s[24:27], s13 offen offset:3072 lds
    s_add_u32 s33, s33, 2097152
    v_add_u32 v14, s33, v14
    v_bfe_u32 v3, v2, 2, 1
    v_lshl_add_u32 v3, s14, 1, v3
    v_lshl_add_u32 v3, v254, 3, v3
    v_and_b32 v5, 3, v3
    v_bfe_u32 v6, v2, 4, 1
    v_xor_b32 v5, v5, v6
    v_lshlrev_b32 v5, 6, v5
    v_lshl_add_u32 v5, v4, 4, v5
    v_lshl_add_u32 v5, v3, 8, v5
    v_and_b32 v3, 8, v2
    s_waitcnt lgkmcnt(0)
    s_barrier
    s_waitcnt vmcnt(12)
    s_and_b32 s13, s2, 7
    s_cbranch_scc0 L_pre_s3
    s_waitcnt vmcnt(5)
L_pre_s3:
    v_add_f32 v152, v152, v160
    v_add3_u32 v153, v153, v161, v169
    v_add_f32 v154, v154, v162
    v_add3_u32 v155, v155, v163, v171
    v_add_f32 v156, v156, v164
    v_add3_u32 v157, v157, v165, v173
    v_add_f32 v158, v158, v166
    v_add3_u32 v159, v159, v167, v175
    v_add_f32 v168, v168, v176
    v_add_f32 v170, v170, v178
    v_add_f32 v172, v172, v180
    v_add_f32 v174, v174, v182
    v_add3_u32 v153, v153, v155, v177
    v_add3_u32 v157, v157, v159, v179
    v_add_f32 v152, v152, v168
    v_add_f32 v154, v154, v170
    v_add_f32 v156, v156, v172
    v_add_f32 v158, v158, v174
    v_add3_u32 v153, v153, v181, v183
    v_cvt_pk_bf16_f32 v161, v156, v158
    v_add_u32 v153, v153, v157
    v_cvt_pk_bf16_f32 v160, v152, v154
    v_cmp_ne_u32 vcc, s75, v153
    s_cbranch_vccnz L_s1_r
L_s1_ok:
    v_lshlrev_b32 v154, 16, v161
    v_and_b32 v155, 0xffff0000, v161
    v_lshlrev_b32 v152, 16, v160
    v_pk_add_f32 v[154:155], v[154:155], 1.0 op_sel_hi:[1,0]
    v_and_b32 v153, 0xffff0000, v160
    v_cvt_pk_bf16_f32 v161, v154, v155
    v_lshlrev_b32 v154, 16, v161
    v_and_b32 v155, 0xffff0000, v161
    ds_write2st64_b64 v142, v[152:153], v[154:155] offset0:0 offset1:1
    ds_read_b128 v[112:115], v143 offset:0
    ds_read_b128 v[120:123], v143 offset:512
    ds_read_b128 v[116:119], v143 offset:16
    ds_read_b128 v[124:127], v143 offset:528
    s_waitcnt lgkmcnt(2)
    v_pk_fma_f32 v[48:49], v[48:49], v[120:121], v[112:113]
    v_pk_fma_f32 v[50:51], v[50:51], v[122:123], v[114:115]
    s_waitcnt lgkmcnt(0)
    v_pk_fma_f32 v[52:53], v[52:53], v[124:125], v[116:117]
    v_pk_fma_f32 v[54:55], v[54:55], v[126:127], v[118:119]
    v_cvt_pk_bf16_f32 v16, v48, v49
    v_cvt_pk_bf16_f32 v17, v50, v51
    v_cvt_pk_bf16_f32 v18, v52, v53
    v_cvt_pk_bf16_f32 v19, v54, v55
    v_pk_fma_f32 v[56:57], v[56:57], v[120:121], v[112:113]
    v_pk_fma_f32 v[58:59], v[58:59], v[122:123], v[114:115]
    v_pk_fma_f32 v[60:61], v[60:61], v[124:125], v[116:117]
    v_pk_fma_f32 v[62:63], v[62:63], v[126:127], v[118:119]
    v_cvt_pk_bf16_f32 v20, v56, v57
    v_cvt_pk_bf16_f32 v21, v58, v59
    v_cvt_pk_bf16_f32 v22, v60, v61
    v_cvt_pk_bf16_f32 v23, v62, v63
    ds_write_b128 v240, v[16:19]
    ds_write_b128 v241, v[20:23]
    v_pk_fma_f32 v[64:65], v[64:65], v[120:121], v[112:113]
    v_pk_fma_f32 v[66:67], v[66:67], v[122:123], v[114:115]
    v_pk_fma_f32 v[68:69], v[68:69], v[124:125], v[116:117]
    v_pk_fma_f32 v[70:71], v[70:71], v[126:127], v[118:119]
    v_cvt_pk_bf16_f32 v24, v64, v65
    v_cvt_pk_bf16_f32 v25, v66, v67
    v_cvt_pk_bf16_f32 v26, v68, v69
    v_cvt_pk_bf16_f32 v27, v70, v71
    v_pk_fma_f32 v[72:73], v[72:73], v[120:121], v[112:113]
    v_pk_fma_f32 v[74:75], v[74:75], v[122:123], v[114:115]
    v_pk_fma_f32 v[76:77], v[76:77], v[124:125], v[116:117]
    v_pk_fma_f32 v[78:79], v[78:79], v[126:127], v[118:119]
    v_cvt_pk_bf16_f32 v28, v72, v73
    v_cvt_pk_bf16_f32 v29, v74, v75
    v_cvt_pk_bf16_f32 v30, v76, v77
    v_cvt_pk_bf16_f32 v31, v78, v79
    ds_write_b128 v242, v[24:27]
    ds_write_b128 v243, v[28:31]
    v_pk_fma_f32 v[80:81], v[80:81], v[120:121], v[112:113]
    v_pk_fma_f32 v[82:83], v[82:83], v[122:123], v[114:115]
    v_pk_fma_f32 v[84:85], v[84:85], v[124:125], v[116:117]
    v_pk_fma_f32 v[86:87], v[86:87], v[126:127], v[118:119]
    v_cvt_pk_bf16_f32 v16, v80, v81
    v_cvt_pk_bf16_f32 v17, v82, v83
    v_cvt_pk_bf16_f32 v18, v84, v85
    v_cvt_pk_bf16_f32 v19, v86, v87
    v_pk_fma_f32 v[88:89], v[88:89], v[120:121], v[112:113]
    v_pk_fma_f32 v[90:91], v[90:91], v[122:123], v[114:115]
    v_pk_fma_f32 v[92:93], v[92:93], v[124:125], v[116:117]
    v_pk_fma_f32 v[94:95], v[94:95], v[126:127], v[118:119]
    v_cvt_pk_bf16_f32 v20, v88, v89
    v_cvt_pk_bf16_f32 v21, v90, v91
    v_cvt_pk_bf16_f32 v22, v92, v93
    v_cvt_pk_bf16_f32 v23, v94, v95
    ds_write_b128 v244, v[16:19]
    ds_write_b128 v245, v[20:23]
    v_pk_fma_f32 v[96:97], v[96:97], v[120:121], v[112:113]
    v_pk_fma_f32 v[98:99], v[98:99], v[122:123], v[114:115]
    v_pk_fma_f32 v[100:101], v[100:101], v[124:125], v[116:117]
    v_pk_fma_f32 v[102:103], v[102:103], v[126:127], v[118:119]
    v_cvt_pk_bf16_f32 v24, v96, v97
    v_cvt_pk_bf16_f32 v25, v98, v99
    v_cvt_pk_bf16_f32 v26, v100, v101
    v_cvt_pk_bf16_f32 v27, v102, v103
    v_pk_fma_f32 v[104:105], v[104:105], v[120:121], v[112:113]
    v_pk_fma_f32 v[106:107], v[106:107], v[122:123], v[114:115]
    v_pk_fma_f32 v[108:109], v[108:109], v[124:125], v[116:117]
    v_pk_fma_f32 v[110:111], v[110:111], v[126:127], v[118:119]
    v_cvt_pk_bf16_f32 v28, v104, v105
    v_cvt_pk_bf16_f32 v29, v106, v107
    v_cvt_pk_bf16_f32 v30, v108, v109
    v_cvt_pk_bf16_f32 v31, v110, v111
    ds_write_b128 v246, v[24:27]
    ds_write_b128 v247, v[28:31]
    s_waitcnt vmcnt(0) lgkmcnt(0)
    s_barrier
    s_cmp_eq_u32 s3, 0
    s_cbranch_scc0 L_pre_q
    ds_read_b128 v[48:51], v144 offset:0
    ds_read_b128 v[52:55], v145 offset:0
    ds_read_b128 v[56:59], v144 offset:4096
    ds_read_b128 v[60:63], v145 offset:4096
    ds_read_b128 v[64:67], v144 offset:8192
    ds_read_b128 v[68:71], v145 offset:8192
    ds_read_b128 v[72:75], v144 offset:12288
    ds_read_b128 v[76:79], v145 offset:12288
    ds_read_b128 v[80:83], v144 offset:16384
    ds_read_b128 v[84:87], v145 offset:16384
    ds_read_b128 v[88:91], v144 offset:20480
    ds_read_b128 v[92:95], v145 offset:20480
    s_waitcnt lgkmcnt(8)
    ds_read_b128 v[96:99], v144 offset:24576
    ds_read_b128 v[100:103], v145 offset:24576
    ds_read_b128 v[104:107], v144 offset:28672
    ds_read_b128 v[108:111], v145 offset:28672
    s_cmp_ge_u32 s14, 2
    s_cbranch_scc1 L_pre_v
    v_mfma_f32_16x16x32_bf16 v[112:115], a[128:131], v[48:51], 0
    v_mfma_f32_16x16x32_bf16 v[112:115], a[132:135], v[52:55], v[112:115]
    v_mfma_f32_16x16x32_bf16 v[112:115], a[136:139], v[56:59], v[112:115]
    v_mfma_f32_16x16x32_bf16 v[112:115], a[140:143], v[60:63], v[112:115]
    s_waitcnt lgkmcnt(8)
    v_mfma_f32_16x16x32_bf16 v[112:115], a[144:147], v[64:67], v[112:115]
    v_mfma_f32_16x16x32_bf16 v[112:115], a[148:151], v[68:71], v[112:115]
    v_mfma_f32_16x16x32_bf16 v[112:115], a[152:155], v[72:75], v[112:115]
    v_mfma_f32_16x16x32_bf16 v[112:115], a[156:159], v[76:79], v[112:115]
    s_waitcnt lgkmcnt(4)
    v_mfma_f32_16x16x32_bf16 v[112:115], a[160:163], v[80:83], v[112:115]
    v_mfma_f32_16x16x32_bf16 v[112:115], a[164:167], v[84:87], v[112:115]
    v_mfma_f32_16x16x32_bf16 v[112:115], a[168:171], v[88:91], v[112:115]
    v_mfma_f32_16x16x32_bf16 v[112:115], a[172:175], v[92:95], v[112:115]
    s_waitcnt lgkmcnt(0)
    v_mfma_f32_16x16x32_bf16 v[112:115], a[176:179], v[96:99], v[112:115]
    v_mfma_f32_16x16x32_bf16 v[112:115], a[180:183], v[100:103], v[112:115]
    v_mfma_f32_16x16x32_bf16 v[112:115], a[184:187], v[104:107], v[112:115]
    v_mfma_f32_16x16x32_bf16 v[112:115], a[188:191], v[108:111], v[112:115]
    s_branch L_pre_kv
L_pre_v:
    s_nop 4
    v_mfma_f32_16x16x32_bf16 v[112:115], v[48:51], a[128:131], 0
    v_mfma_f32_16x16x32_bf16 v[112:115], v[52:55], a[132:135], v[112:115]
    v_mfma_f32_16x16x32_bf16 v[112:115], v[56:59], a[136:139], v[112:115]
    v_mfma_f32_16x16x32_bf16 v[112:115], v[60:63], a[140:143], v[112:115]
    s_waitcnt lgkmcnt(8)
    v_mfma_f32_16x16x32_bf16 v[112:115], v[64:67], a[144:147], v[112:115]
    v_mfma_f32_16x16x32_bf16 v[112:115], v[68:71], a[148:151], v[112:115]
    v_mfma_f32_16x16x32_bf16 v[112:115], v[72:75], a[152:155], v[112:115]
    v_mfma_f32_16x16x32_bf16 v[112:115], v[76:79], a[156:159], v[112:115]
    s_waitcnt lgkmcnt(4)
    v_mfma_f32_16x16x32_bf16 v[112:115], v[80:83], a[160:163], v[112:115]
    v_mfma_f32_16x16x32_bf16 v[112:115], v[84:87], a[164:167], v[112:115]
    v_mfma_f32_16x16x32_bf16 v[112:115], v[88:91], a[168:171], v[112:115]
    v_mfma_f32_16x16x32_bf16 v[112:115], v[92:95], a[172:175], v[112:115]
    s_waitcnt lgkmcnt(0)
    v_mfma_f32_16x16x32_bf16 v[112:115], v[96:99], a[176:179], v[112:115]
    v_mfma_f32_16x16x32_bf16 v[112:115], v[100:103], a[180:183], v[112:115]
    v_mfma_f32_16x16x32_bf16 v[112:115], v[104:107], a[184:187], v[112:115]
    v_mfma_f32_16x16x32_bf16 v[112:115], v[108:111], a[188:191], v[112:115]
L_pre_kv:
    s_nop 7
    v_cvt_pk_bf16_f32 v116, v112, v113
    v_cvt_pk_bf16_f32 v117, v114, v115
    s_nop 0
    v_permlane32_swap_b32 v116, v118
    v_permlane32_swap_b32 v117, v119
    s_mov_b32 exec_hi, 0
    global_store_dwordx4 v146, v[116:119], s[62:63] sc1
    s_mov_b32 exec_hi, -1
    s_branch L_pre_q3
L_pre_q:
    s_cmp_eq_u32 s3, 3
    s_cbranch_scc1 L_pre_q3
    s_xor_b32 s30, s30, 98304
    s_xor_b32 s31, s31, 393216
    s_add_u32 m0, s30, 0
    s_add_u32 s13, s31, 0
    buffer_load_dwordx4 v11, s[24:27], s13 offen offset:0 lds
    buffer_load_dwordx4 v12, s[24:27], s13 offen offset:1024 lds
    buffer_load_dwordx4 v13, s[24:27], s13 offen offset:2048 lds
    buffer_load_dwordx4 v8, s[24:27], s13 offen offset:3072 lds
    s_add_u32 m0, s30, 4096
    s_add_u32 s13, s31, 16384
    buffer_load_dwordx4 v11, s[24:27], s13 offen offset:0 lds
    buffer_load_dwordx4 v12, s[24:27], s13 offen offset:1024 lds
    buffer_load_dwordx4 v13, s[24:27], s13 offen offset:2048 lds
    buffer_load_dwordx4 v8, s[24:27], s13 offen offset:3072 lds
    s_add_u32 m0, s30, 8192
    s_add_u32 s13, s31, 32768
    buffer_load_dwordx4 v11, s[24:27], s13 offen offset:0 lds
    buffer_load_dwordx4 v12, s[24:27], s13 offen offset:1024 lds
    buffer_load_dwordx4 v13, s[24:27], s13 offen offset:2048 lds
    buffer_load_dwordx4 v8, s[24:27], s13 offen offset:3072 lds
    s_add_u32 m0, s30, 12288
    s_add_u32 s13, s31, 49152
    buffer_load_dwordx4 v11, s[24:27], s13 offen offset:0 lds
    buffer_load_dwordx4 v12, s[24:27], s13 offen offset:1024 lds
    buffer_load_dwordx4 v13, s[24:27], s13 offen offset:2048 lds
    buffer_load_dwordx4 v8, s[24:27], s13 offen offset:3072 lds
    s_cmp_eq_u32 s3, 1
    s_cbranch_scc0 L_pre_q9
    v_lshrrev_b32 v127, 5, v2
    v_lshl_add_u32 v127, v127, 4, v2
    s_mul_i32 s33, s2, 96
    v_add_lshl_u32 v127, v127, s33, 7
    global_load_dword a0, v127, s[56:57] offset:2048
    s_branch L_pre_q3
L_pre_q9:
    v_min_u32 v127, 55, v2
    s_mul_i32 s33, s2, 56
    v_add_lshl_u32 v127, v127, s33, 7
    global_load_dword a0, v127, s[52:53]
L_pre_q3:
    v_lshl_add_u32 v150, v3, 9, v5
    v_xor_b32 v151, 128, v150
    s_lshl2_add_u32 s33, s2, s3
    s_lshr_b32 s35, s33, 5
    s_bfe_u32 s34, s33, 0x30002
    s_and_b32 s46, s33, 2
    s_lshl2_add_u32 s34, s46, s34
    s_mul_i32 s72, s34, 448
    s_add_u32 s72, s72, s35
    s_lshl_b32 s72, s72, 7
    s_mul_i32 s100, s35, 37
    s_lshr_b32 s100, s100, 8
    s_mul_i32 s100, s100, 672
    s_add_u32 s100, s100, s33
    s_lshl_b32 s100, s100, 10
    s_add_u32 s100, s100, 8388608
    s_and_b32 s34, s33, 1
    s_cselect_b32 s64, s50, s48
    s_cselect_b32 s65, s51, s49
    s_lshl_b32 s73, s35, 9
    s_and_b32 s34, s33, 23
    s_add_u32 s73, s73, s34
    s_lshl_b32 s73, s73, 7
    s_bfe_u32 s34, s33, 0x10003
    s_lshl2_add_u32 s73, s34, s73
    s_and_b32 s101, s33, 7
    s_mul_i32 s101, s101, 112
    s_lshr_b32 s34, s33, 3
    s_add_u32 s101, s101, s34
    s_lshl_b32 s101, s101, 11
    s_add_u32 s101, s101, 12582912
    s_cmp_lt_u32 s33, 896
    s_cselect_b32 s66, 1835008, 0
    s_mov_b32 s67, s23
    s_mov_b32 s68, s52
    s_mov_b32 s69, s53
    s_mov_b32 s70, s66
    s_mov_b32 s71, s23
    s_mov_b32 s96, s20
    s_mov_b32 s97, s21
    s_cselect_b32 s98, s22, 0
    s_mov_b32 s99, s23
    v_lshl_add_u32 v248, v254, 5, v6
    v_mul_u32_u24 v248, 3584, v248
    v_add_lshl_u32 v248, v248, v212, 3
    v_lshl_add_u32 v249, v6, 4, v254
    v_lshlrev_b32 v249, 7, v249
    v_add_lshl_u32 v249, v249, v212, 3
    s_and_b32 s33, s2, 7
    s_lshl_b32 s34, s33, 5
    s_add_u32 s34, s34, s12
    s_lshl4_add_u32 s34, s34, 2048
    s_lshl2_add_u32 s35, s12, s3
    s_mul_i32 s35, s35, 48
    s_add_u32 s35, s35, s33
    s_lshl_b32 s35, s35, 9
    v_mul_u32_u24 v251, 6144, v213
    v_lshl_add_u32 v251, v212, 5, v251
    v_add_u32 v255, s35, v251
    s_lshr_b32 s33, s33, 1
    s_cmp_eq_u32 s33, 2
    s_cselect_b32 s38, 1.0, 0
    s_lshl_b32 s39, s34, 1
    s_mul_i32 s33, s3, 786432
    s_add_u32 s33, s33, s34
    s_add_u32 s33, s33, 3072
    v_mul_u32_u24 v135, 12288, v2
    v_add_u32 v135, s33, v135
    s_lshl_b32 s33, s3, 5
    s_add_u32 s33, s33, 17408
    v_lshl_add_u32 v251, v212, 7, s33
    v_lshl_add_u32 v251, v213, 3, v251
    s_cmp_eq_u32 s3, 0
    s_cselect_b64 s[8:9], 1, 0
    s_cselect_b32 s10, 0xff, 0
    s_mov_b32 s11, 0
    s_mov_b64 s[6:7], 0
    v_cmp_eq_u32 vcc, 0, v3
    v_mov_b32 v1, 0xeeeedddd
    v_mov_b32 v3, 0x4444dddd
    v_cndmask_b32 v1, v1, v3, vcc
    s_cmp_eq_u32 s3, 0
    s_cbranch_scc1 L_pre_q4
    s_cmp_eq_u32 s3, 1
    s_cbranch_scc0 L_pre_q5
    s_mov_b64 exec, 0
    s_branch L_w6
L_wb_B1:
    s_mov_b64 exec, -1
    s_waitcnt vmcnt(1)
    s_branch L_pre_q4
    s_branch L_pre_q7
L_pre_q5:
    s_cmp_eq_u32 s3, 2
    s_cbranch_scc0 L_pre_q6
    s_mov_b64 exec, 0
    s_branch L_w7
L_wb_B2:
    s_mov_b64 exec, -1
    s_waitcnt vmcnt(1)
    s_branch L_pre_q4
    s_branch L_pre_q7
L_pre_q6:
    s_mov_b64 exec, 0
    s_branch L_w3
L_wb_B3:
    s_mov_b64 exec, -1
L_pre_q7:
    s_waitcnt vmcnt(0)
L_pre_q4:
    s_barrier
    ds_read_b128 v[152:155], v138 offset:0
    ds_read_b64_tr_b16 v[184:185], v136 offset:0
    ds_read_b64_tr_b16 v[186:187], v136 offset:1024
    ds_read_b128 v[156:159], v139 offset:0
    ds_read_b64_tr_b16 v[188:189], v136 offset:4096
    ds_read_b64_tr_b16 v[190:191], v136 offset:5120
    ds_read_b128 v[160:163], v140 offset:0
    ds_read_b64_tr_b16 v[192:193], v136 offset:8192
    ds_read_b64_tr_b16 v[194:195], v136 offset:9216
    ds_read_b128 v[164:167], v141 offset:0
    ds_read_b64_tr_b16 v[196:197], v136 offset:12288
    ds_read_b64_tr_b16 v[198:199], v136 offset:13312
    s_cmp_lt_u32 s2, 224
    s_cbranch_scc1 L_pre_nwo
    v_perm_b32 v64, v218, v216, s16
    v_perm_b32 v65, v222, v220, s16
    v_perm_b32 v66, v226, v224, s16
    v_perm_b32 v67, v230, v228, s16
    global_store_dwordx4 v250, v[64:67], s[62:63] offset:-4096 sc1
    v_perm_b32 v68, v218, v216, s17
    v_perm_b32 v69, v222, v220, s17
    v_perm_b32 v70, v226, v224, s17
    v_perm_b32 v71, v230, v228, s17
    global_store_dwordx4 v250, v[68:71], s[62:63] offset:-2048 sc1
    v_perm_b32 v72, v219, v217, s16
    v_perm_b32 v73, v223, v221, s16
    v_perm_b32 v74, v227, v225, s16
    v_perm_b32 v75, v231, v229, s16
    global_store_dwordx4 v250, v[72:75], s[62:63] offset:0 sc1
    v_perm_b32 v76, v219, v217, s17
    v_perm_b32 v77, v223, v221, s17
    v_perm_b32 v78, v227, v225, s17
    v_perm_b32 v79, v231, v229, s17
    global_store_dwordx4 v250, v[76:79], s[62:63] offset:2048 sc1
L_pre_nwo:
    v_mov_b32 v120, 0
    v_mov_b32 v121, 0
    s_waitcnt lgkmcnt(9)
    v_mfma_f32_32x32x16_bf16 v[48:63], v[184:187], v[152:155], 0
    s_waitcnt lgkmcnt(6)
    ds_read_b128 v[168:171], v138 offset:4096
    ds_read_b64_tr_b16 v[200:201], v136 offset:16384
    ds_read_b64_tr_b16 v[202:203], v136 offset:17408
    v_lshl_add_u32 v6, v6, 1, v254
    s_lshl_b32 s33, s32, 5
    s_add_u32 s33, s33, s3
    v_mfma_f32_32x32x16_bf16 v[48:63], v[188:191], v[156:159], v[48:63]
    s_waitcnt lgkmcnt(6)
    ds_read_b128 v[172:175], v139 offset:4096
    ds_read_b64_tr_b16 v[204:205], v136 offset:20480
    ds_read_b64_tr_b16 v[206:207], v136 offset:21504
    s_lshl_b32 s33, s33, 8
    s_add_u32 s33, s33, 2048
    v_lshl_add_u32 v128, v6, 10, v214
    v_mfma_f32_32x32x16_bf16 v[48:63], v[192:195], v[160:163], v[48:63]
    s_waitcnt lgkmcnt(6)
    ds_read_b128 v[176:179], v140 offset:4096
    ds_read_b64_tr_b16 v[208:209], v136 offset:24576
    ds_read_b64_tr_b16 v[210:211], v136 offset:25600
    v_add_u32 v128, s33, v128
    s_lshl_b32 s33, s3, 9
    s_add_u32 s33, s33, 20480
    v_mfma_f32_32x32x16_bf16 v[48:63], v[196:199], v[164:167], v[48:63]
    s_waitcnt lgkmcnt(6)
    ds_read_b128 v[180:183], v141 offset:4096
    ds_read_b64_tr_b16 v[184:185], v136 offset:28672
    ds_read_b64_tr_b16 v[186:187], v136 offset:29696
    v_lshl_add_u32 v129, v212, 5, s33
    v_lshrrev_b32 v3, 1, v212
    v_and_b32 v5, 1, v2
    v_mfma_f32_32x32x16_bf16 v[48:63], v[200:203], v[168:171], v[48:63]
    s_waitcnt lgkmcnt(6)
    ds_read_b128 v[152:155], v138 offset:8192
    ds_read_b64_tr_b16 v[188:189], v136 offset:32768
    ds_read_b64_tr_b16 v[190:191], v136 offset:33792
    v_lshlrev_b32 v3, 12, v3
    v_lshl_add_u32 v3, v5, 6, v3
    v_lshl_add_u32 v3, v6, 4, v3
    v_mfma_f32_32x32x16_bf16 v[48:63], v[204:207], v[172:175], v[48:63]
    s_waitcnt lgkmcnt(6)
    ds_read_b128 v[156:159], v139 offset:8192
    ds_read_b64_tr_b16 v[192:193], v136 offset:36864
    ds_read_b64_tr_b16 v[194:195], v136 offset:37888
    s_and_b32 s33, s3, 1
    s_lshl2_add_u32 s33, s33, s14
    s_lshr_b32 s34, s3, 1
    v_mfma_f32_32x32x16_bf16 v[48:63], v[208:211], v[176:179], v[48:63]
    s_waitcnt lgkmcnt(6)
    ds_read_b128 v[160:163], v140 offset:8192
    ds_read_b64_tr_b16 v[196:197], v136 offset:40960
    ds_read_b64_tr_b16 v[198:199], v136 offset:41984
    s_lshl2_add_u32 s33, s33, s34
    s_lshl_b32 s33, s33, 7
    s_add_u32 s33, s33, s19
    v_mfma_f32_32x32x16_bf16 v[48:63], v[184:187], v[180:183], v[48:63]
    s_waitcnt lgkmcnt(6)
    ds_read_b128 v[164:167], v141 offset:8192
    ds_read_b64_tr_b16 v[200:201], v136 offset:45056
    ds_read_b64_tr_b16 v[202:203], v136 offset:46080
    s_add_u32 s33, s33, 14680064
    v_add_u32 v131, s33, v3
    s_add_u32 s33, s15, 3072
    v_mfma_f32_32x32x16_bf16 v[48:63], v[188:191], v[152:155], v[48:63]
    s_waitcnt lgkmcnt(6)
    ds_read_b128 v[168:171], v138 offset:12288
    ds_read_b64_tr_b16 v[204:205], v136 offset:49152
    ds_read_b64_tr_b16 v[206:207], v136 offset:50176
    v_lshl_add_u32 v133, v6, 6, s33
    s_lshl4_add_u32 s33, s3, 3072
    v_lshl_add_u32 v6, v6, 6, s33
    v_mfma_f32_32x32x16_bf16 v[48:63], v[192:195], v[156:159], v[48:63]
    s_waitcnt lgkmcnt(6)
    ds_read_b128 v[172:175], v139 offset:12288
    ds_read_b64_tr_b16 v[208:209], v136 offset:53248
    ds_read_b64_tr_b16 v[210:211], v136 offset:54272
    v_lshl_add_u32 v132, v4, 12, v6
    v_bfe_u32 v3, v2, 1, 2
    v_lshl_add_u32 v3, v5, 2, v3
    v_mfma_f32_32x32x16_bf16 v[48:63], v[196:199], v[160:163], v[48:63]
    s_waitcnt lgkmcnt(6)
    ds_read_b128 v[176:179], v140 offset:12288
    ds_read_b64_tr_b16 v[184:185], v136 offset:57344
    ds_read_b64_tr_b16 v[186:187], v136 offset:58368
    v_and_b32 v6, 56, v2
    v_add_u32 v3, v3, v6
    v_lshlrev_b32 v3, 4, v3
    v_mfma_f32_32x32x16_bf16 v[48:63], v[200:203], v[164:167], v[48:63]
    s_waitcnt lgkmcnt(6)
    ds_read_b128 v[180:183], v141 offset:12288
    ds_read_b64_tr_b16 v[188:189], v136 offset:61440
    ds_read_b64_tr_b16 v[190:191], v136 offset:62464
    v_add_u32 v6, 16384, v3
    v_bfe_u32 v3, v2, 3, 2
    v_lshlrev_b32 v3, 8, v3
    v_mfma_f32_32x32x16_bf16 v[48:63], v[204:207], v[168:171], v[48:63]
    s_waitcnt lgkmcnt(6)
    ds_read_b128 v[152:155], v138 offset:16384
    ds_read_b64_tr_b16 v[192:193], v137 offset:0
    ds_read_b64_tr_b16 v[194:195], v137 offset:1024
    v_lshl_add_u32 v3, v254, 7, v3
    v_lshl_add_u32 v3, v215, 4, v3
    s_lshl2_add_u32 s33, s32, s14
    v_mfma_f32_32x32x16_bf16 v[48:63], v[208:211], v[172:175], v[48:63]
    s_waitcnt lgkmcnt(6)
    ds_read_b128 v[156:159], v139 offset:16384
    ds_read_b64_tr_b16 v[196:197], v137 offset:4096
    ds_read_b64_tr_b16 v[198:199], v137 offset:5120
    s_lshl_b32 s33, s33, 11
    s_add_u32 s33, s33, 2097152
    v_add_u32 v0, s33, v3
L_w2:
    s_cbranch_execz L_wb_A2
    v_mfma_f32_32x32x16_bf16 v[48:63], v[184:187], v[176:179], v[48:63]
    s_waitcnt lgkmcnt(6)
    ds_read_b128 v[160:163], v140 offset:16384
    ds_read_b64_tr_b16 v[200:201], v137 offset:8192
    ds_read_b64_tr_b16 v[202:203], v137 offset:9216
    s_lshl2_add_u32 s33, s3, 16384
    v_add_u32 v5, s33, v3
    v_lshl_add_u32 v3, v2, 3, s15
    v_mfma_f32_32x32x16_bf16 v[48:63], v[188:191], v[180:183], v[48:63]
    s_waitcnt lgkmcnt(6)
    ds_read_b128 v[164:167], v141 offset:16384
    ds_read_b64_tr_b16 v[204:205], v137 offset:12288
    ds_read_b64_tr_b16 v[206:207], v137 offset:13312
    s_lshl_b32 s33, s3, 9
    v_lshl_add_u32 v4, v2, 3, s33
    v_and_b32 v252, 7, v2
    v_mfma_f32_32x32x16_bf16 v[48:63], v[192:195], v[152:155], v[48:63]
    s_waitcnt lgkmcnt(6)
    ds_read_b128 v[168:171], v138 offset:20480
    ds_read_b64_tr_b16 v[208:209], v137 offset:16384
    ds_read_b64_tr_b16 v[210:211], v137 offset:17408
    s_xor_b32 s40, s60, 0
    global_load_dwordx4 a[0:3], v7, s[40:41] offset:-4096 sc1
    v_lshlrev_b32 v252, 2, v252
    v_mfma_f32_32x32x16_bf16 v[48:63], v[196:199], v[156:159], v[48:63]
    s_waitcnt lgkmcnt(6)
    ds_read_b128 v[172:175], v139 offset:20480
    ds_read_b64_tr_b16 v[184:185], v137 offset:20480
    ds_read_b64_tr_b16 v[186:187], v137 offset:21504
    global_load_dwordx4 a[4:7], v9, s[40:41] offset:-3072 sc1
    v_lshlrev_b32 v2, 3, v2
    v_mfma_f32_32x32x16_bf16 v[48:63], v[200:203], v[160:163], v[48:63]
    s_waitcnt lgkmcnt(6)
    ds_read_b128 v[176:179], v140 offset:20480
    ds_read_b64_tr_b16 v[188:189], v137 offset:24576
    ds_read_b64_tr_b16 v[190:191], v137 offset:25600
    global_load_dwordx4 a[8:11], v9, s[40:41] offset:-2048 sc1
    v_mfma_f32_32x32x16_bf16 v[48:63], v[204:207], v[164:167], v[48:63]
    s_waitcnt lgkmcnt(6)
    ds_read_b128 v[180:183], v141 offset:20480
    ds_read_b64_tr_b16 v[192:193], v137 offset:28672
    ds_read_b64_tr_b16 v[194:195], v137 offset:29696
    global_load_dwordx4 a[12:15], v7, s[40:41] offset:0 sc1
    v_mov_b32 v10, -1
    v_mfma_f32_32x32x16_bf16 v[48:63], v[208:211], v[168:171], v[48:63]
    s_waitcnt lgkmcnt(6)
    ds_read_b128 v[152:155], v138 offset:24576
    ds_read_b64_tr_b16 v[196:197], v137 offset:32768
    ds_read_b64_tr_b16 v[198:199], v137 offset:33792
    global_load_dwordx4 a[16:19], v9, s[40:41] offset:1024 sc1
    v_mov_b32 v11, -1
    v_mfma_f32_32x32x16_bf16 v[48:63], v[184:187], v[172:175], v[48:63]
    s_waitcnt lgkmcnt(6)
    ds_read_b128 v[156:159], v139 offset:24576
    ds_read_b64_tr_b16 v[200:201], v137 offset:36864
    ds_read_b64_tr_b16 v[202:203], v137 offset:37888
    global_load_dwordx4 a[20:23], v9, s[40:41] offset:2048 sc1
    v_mov_b32 v12, -1
    v_mfma_f32_32x32x16_bf16 v[48:63], v[188:191], v[176:179], v[48:63]
    s_waitcnt lgkmcnt(6)
    ds_read_b128 v[160:163], v140 offset:24576
    ds_read_b64_tr_b16 v[204:205], v137 offset:40960
    ds_read_b64_tr_b16 v[206:207], v137 offset:41984
    s_xor_b32 s40, s60, 8192
    global_load_dwordx4 a[24:27], v7, s[40:41] offset:-4096 sc1
    v_mov_b32 v13, -1
    v_mfma_f32_32x32x16_bf16 v[48:63], v[192:195], v[180:183], v[48:63]
    s_waitcnt lgkmcnt(6)
    ds_read_b128 v[164:167], v141 offset:24576
    ds_read_b64_tr_b16 v[208:209], v137 offset:45056
    ds_read_b64_tr_b16 v[210:211], v137 offset:46080
    global_load_dwordx4 a[28:31], v9, s[40:41] offset:-3072 sc1
    v_lshlrev_b32 v16, 16, v134
    v_mfma_f32_32x32x16_bf16 v[48:63], v[196:199], v[152:155], v[48:63]
    s_waitcnt lgkmcnt(6)
    ds_read_b128 v[168:171], v138 offset:28672
    ds_read_b64_tr_b16 v[184:185], v137 offset:49152
    ds_read_b64_tr_b16 v[186:187], v137 offset:50176
    v_and_b32 v17, 0xffff0000, v134
    v_mul_f32 v18, 0xbfb8aa3b, v16
    v_mul_f32 v19, 0xbfb8aa3b, v17
    v_mfma_f32_32x32x16_bf16 v[48:63], v[200:203], v[156:159], v[48:63]
    s_waitcnt lgkmcnt(6)
    ds_read_b128 v[172:175], v139 offset:28672
    ds_read_b64_tr_b16 v[188:189], v137 offset:53248
    ds_read_b64_tr_b16 v[190:191], v137 offset:54272
    v_exp_f32 v18, v18
    v_exp_f32 v19, v19
    v_add_f32 v18, 1.0, v18
    v_mfma_f32_32x32x16_bf16 v[48:63], v[204:207], v[160:163], v[48:63]
    s_waitcnt lgkmcnt(6)
    ds_read_b128 v[176:179], v140 offset:28672
    ds_read_b64_tr_b16 v[192:193], v137 offset:57344
    ds_read_b64_tr_b16 v[194:195], v137 offset:58368
    v_add_f32 v19, 1.0, v19
    v_rcp_f32 v18, v18
    v_rcp_f32 v19, v19
    v_mfma_f32_32x32x16_bf16 v[48:63], v[208:211], v[164:167], v[48:63]
    s_waitcnt lgkmcnt(6)
    ds_read_b128 v[180:183], v141 offset:28672
    ds_read_b64_tr_b16 v[196:197], v137 offset:61440
    ds_read_b64_tr_b16 v[198:199], v137 offset:62464
    v_mul_f32 v16, v16, v18
    v_mul_f32 v17, v17, v19
    v_cvt_pk_bf16_f32 v134, v16, v17
    v_mfma_f32_32x32x16_bf16 v[48:63], v[184:187], v[168:171], v[48:63]
    s_waitcnt lgkmcnt(6)
    v_mfma_f32_32x32x16_bf16 v[48:63], v[188:191], v[172:175], v[48:63]
    s_waitcnt lgkmcnt(3)
    v_mfma_f32_32x32x16_bf16 v[48:63], v[192:195], v[176:179], v[48:63]
    s_waitcnt lgkmcnt(0)
    v_mfma_f32_32x32x16_bf16 v[48:63], v[196:199], v[180:183], v[48:63]
    global_load_dwordx4 a[32:35], v9, s[40:41] offset:-2048 sc1
    global_load_dwordx4 a[36:39], v7, s[40:41] offset:0 sc1
    global_load_dwordx4 a[40:43], v9, s[40:41] offset:1024 sc1
    global_load_dwordx4 a[44:47], v9, s[40:41] offset:2048 sc1
    v_mfma_f32_32x32x8_f16 v[64:79], v[120:121], v[120:121], 0
    s_nop 6
    v_mul_f32 v48, 0x3eb8aa3b, v48
    v_mul_f32 v49, 0x3eb8aa3b, v49
    v_mul_f32 v50, 0x3eb8aa3b, v50
    v_mul_f32 v51, 0x3eb8aa3b, v51
    v_mul_f32 v52, 0x3eb8aa3b, v52
    v_mul_f32 v53, 0x3eb8aa3b, v53
    v_mul_f32 v54, 0x3eb8aa3b, v54
    v_mfma_f32_32x32x8_f16 v[80:95], v[120:121], v[120:121], 0
    v_mul_f32 v55, 0x3eb8aa3b, v55
    v_mul_f32 v56, 0x3eb8aa3b, v56
    v_mul_f32 v57, 0x3eb8aa3b, v57
    v_mul_f32 v58, 0x3eb8aa3b, v58
    v_mul_f32 v59, 0x3eb8aa3b, v59
    v_mul_f32 v60, 0x3eb8aa3b, v60
    v_mul_f32 v61, 0x3eb8aa3b, v61
    v_mfma_f32_32x32x8_f16 v[96:111], v[120:121], v[120:121], 0
    v_mul_f32 v62, 0x3eb8aa3b, v62
    v_mul_f32 v63, 0x3eb8aa3b, v63
    v_cvt_pk_bf16_f32 v152, v48, v49
    v_cvt_pk_bf16_f32 v153, v50, v51
    v_cvt_pk_bf16_f32 v154, v52, v53
    v_cvt_pk_bf16_f32 v155, v54, v55
    v_cvt_pk_bf16_f32 v156, v56, v57
    v_cvt_pk_bf16_f32 v157, v58, v59
    v_cvt_pk_bf16_f32 v158, v60, v61
    v_cvt_pk_bf16_f32 v159, v62, v63
    ds_write_b128 v149, v[152:155] offset:0
    ds_write_b128 v149, v[156:159] offset:4096
    s_xor_b32 s40, s60, 16384
    global_load_dwordx4 a[48:51], v7, s[40:41] offset:-4096 sc1
    global_load_dwordx4 a[52:55], v9, s[40:41] offset:-3072 sc1
    global_load_dwordx4 a[56:59], v9, s[40:41] offset:-2048 sc1
    global_load_dwordx4 a[60:63], v7, s[40:41] offset:0 sc1
    global_load_dwordx4 a[64:67], v9, s[40:41] offset:1024 sc1
    global_load_dwordx4 a[68:71], v9, s[40:41] offset:2048 sc1
    global_store_dwordx4 v14, v[152:155], s[62:63] offset:0 sc1
    global_store_dwordx4 v14, v[156:159], s[62:63] offset:256 sc1
    s_waitcnt lgkmcnt(0)
    s_barrier
    ds_read_b128 a[192:195], v150
    ds_read_b128 a[196:199], v151
    v_mov_b32 v14, 0
    v_mov_b32 v15, 0
    v_mov_b32 v112, 0
    s_mov_b32 exec_lo, 0xff000000
    global_load_dword v112, v253, s[62:63] sc1
    s_mov_b32 exec_lo, -1
    s_lshl2_add_u32 s12, s32, 16384
    s_mov_b32 s18, 16384
    s_lshl_b32 s4, s5, 2
    s_lshr_b32 s33, s32, 2
    s_lshl_b64 s[26:27], s[8:9], s33
    s_mul_i32 s33, s8, 0x80808080
    s_or_b32 s26, s26, s33
    s_or_b32 s27, s27, s33
    s_waitcnt vmcnt(15) lgkmcnt(0)
    v_accvgpr_read_b32 v113, a0
    v_accvgpr_read_b32 v114, a4
    v_accvgpr_read_b32 v115, a8
    v_max3_u32 v113, v113, v114, v115
    v_accvgpr_read_b32 v114, a12
    v_accvgpr_read_b32 v115, a16
    v_accvgpr_read_b32 v116, a20
    v_max3_u32 v113, v113, v114, v115
    v_max_u32 v113, v113, v116
    v_cmp_eq_u32 vcc, -1, v113
    s_cbranch_vccnz L_kv0_r
L_kv0_ok:
    v_mfma_f32_32x32x16_bf16 v[16:31], a[0:3], a[192:195], 0
    s_sub_u32 s54, 0, s8
    s_mov_b32 s55, s54
    s_mov_b32 s43, s63
    s_lshl2_add_u32 s33, s3, s14
    s_lshl_b32 s33, s33, 15
    s_add_u32 s33, s33, s62
    s_add_u32 s19, s33, 528384
    s_mov_b32 s45, s63
    s_mov_b32 s47, s63
    s_mov_b32 s51, s63
    s_mov_b32 s53, s63
    s_nop 0
    v_exp_f32 v16, v16
    v_exp_f32 v17, v17
    v_exp_f32 v18, v18
    v_exp_f32 v19, v19
    v_exp_f32 v20, v20
    v_mfma_f32_32x32x16_bf16 v[32:47], a[0:3], a[196:199], 0
    s_mov_b32 s49, s63
    buffer_load_dwordx2 v[216:217], v248, s[64:67], s72 offen offset:0
    v_exp_f32 v21, v21
    v_exp_f32 v22, v22
    v_exp_f32 v23, v23
    v_exp_f32 v24, v24
    v_exp_f32 v25, v25
    v_smfmac_f32_32x32x32_bf16 v[80:95], a[4:7], v[16:23], v1
    s_getreg_b32 s0, hwreg(HW_REG_XCC_ID, 0, 4)
    s_lshl1_add_u32 s0, s0, s5
    buffer_load_dwordx2 v[218:219], v248, s[64:67], s72 offen offset:3584
    v_exp_f32 v26, v26
    v_exp_f32 v27, v27
    v_exp_f32 v28, v28
    v_exp_f32 v29, v29
    v_exp_f32 v30, v30
    v_exp_f32 v31, v31
    v_exp_f32 v32, v32
    v_exp_f32 v33, v33
    v_smfmac_f32_32x32x32_bf16 v[80:95], a[8:11], v[24:31], v1
    s_add_u32 s72, s72, 7168
    s_mov_b32 s1, s0
    buffer_load_dwordx2 v[220:221], v248, s[64:67], s72 offen offset:0
    v_exp_f32 v34, v34
    v_exp_f32 v35, v35
    v_exp_f32 v36, v36
    v_mfma_f32_32x32x16_bf16 v[16:31], a[12:15], a[192:195], 0
    s_and_b32 s75, s12, -64
    v_exp_f32 v37, v37
    v_exp_f32 v38, v38
    v_exp_f32 v39, v39
    v_exp_f32 v40, v40
    v_exp_f32 v41, v41
    v_smfmac_f32_32x32x32_bf16 v[64:79], a[4:7], v[32:39], v1
    s_lshr_b32 s33, s32, 4
    s_lshl2_add_u32 s33, s33, s3
    v_exp_f32 v42, v42
    v_exp_f32 v43, v43
    v_exp_f32 v44, v44
    v_exp_f32 v45, v45
    v_mfma_f32_32x32x8_f16 v[48:63], v[14:15], v[14:15], 0
    s_mul_i32 s33, s33, 112
    v_exp_f32 v46, v46
    v_exp_f32 v47, v47
    v_exp_f32 v16, v16
    v_exp_f32 v17, v17
    v_smfmac_f32_32x32x32_bf16 v[64:79], a[8:11], v[40:47], v1
    s_xor_b32 s40, s60, 24576
    s_bfe_u32 s34, s32, 0x20002
    buffer_load_dwordx2 v[222:223], v248, s[64:67], s72 offen offset:3584
    v_exp_f32 v18, v18
    v_exp_f32 v19, v19
    v_exp_f32 v20, v20
    v_mfma_f32_32x32x16_bf16 v[32:47], a[12:15], a[196:199], 0
    s_add_u32 s72, s72, 7168
    buffer_load_dwordx2 v[224:225], v248, s[64:67], s72 offen offset:0
    v_exp_f32 v21, v21
    v_exp_f32 v22, v22
    v_exp_f32 v23, v23
    v_exp_f32 v24, v24
    v_exp_f32 v25, v25
    v_smfmac_f32_32x32x32_bf16 v[80:95], a[16:19], v[16:23], v1
    s_waitcnt vmcnt(14)
    s_mul_i32 s34, s34, 28
    v_exp_f32 v26, v26
    v_exp_f32 v27, v27
    v_exp_f32 v28, v28
    v_exp_f32 v29, v29
    v_exp_f32 v30, v30
    v_exp_f32 v31, v31
    v_accvgpr_read_b32 v113, a24
    v_accvgpr_read_b32 v114, a28
    v_accvgpr_read_b32 v115, a32
    v_max3_u32 v113, v113, v114, v115
    v_accvgpr_read_b32 v114, a36
    v_accvgpr_read_b32 v115, a40
    v_accvgpr_read_b32 v116, a44
    v_max3_u32 v113, v113, v114, v115
    v_max_u32 v113, v113, v116
    v_cmp_eq_u32 vcc, -1, v113
    s_cbranch_vccnz L_kv1_r
L_kv1_ok:
    v_exp_f32 v32, v32
    v_exp_f32 v33, v33
    v_smfmac_f32_32x32x32_bf16 v[80:95], a[20:23], v[24:31], v1
    s_add_u32 s33, s33, s34
    s_add_u32 s33, s33, s14
    buffer_load_dwordx2 v[226:227], v248, s[64:67], s72 offen offset:3584
    v_exp_f32 v34, v34
    v_exp_f32 v35, v35
    v_exp_f32 v36, v36
    v_mfma_f32_32x32x16_bf16 v[16:31], a[24:27], a[192:195], 0
    s_add_u32 s72, s72, 7168
    v_exp_f32 v37, v37
    v_exp_f32 v38, v38
    v_exp_f32 v39, v39
    v_exp_f32 v40, v40
    v_exp_f32 v41, v41
    v_smfmac_f32_32x32x32_bf16 v[64:79], a[16:19], v[32:39], v1
    s_lshl_b32 s33, s33, 10
    s_add_u32 s33, s33, s62
    v_exp_f32 v42, v42
    v_exp_f32 v43, v43
    v_exp_f32 v44, v44
    v_exp_f32 v45, v45
    v_exp_f32 v46, v46
    v_exp_f32 v47, v47
    v_exp_f32 v16, v16
    v_exp_f32 v17, v17
    v_smfmac_f32_32x32x32_bf16 v[64:79], a[20:23], v[40:47], v1
    s_add_u32 s48, s33, 16777216
    s_bfe_u32 s33, s2, 0x20001
    s_cselect_b32 s28, 0x3fb8aa3b, 1.0
    buffer_load_dwordx2 v[228:229], v248, s[64:67], s72 offen offset:0
    v_exp_f32 v18, v18
    v_exp_f32 v19, v19
    v_exp_f32 v20, v20
    v_mfma_f32_32x32x16_bf16 v[32:47], a[24:27], a[196:199], 0
    s_cmp_eq_u32 s33, 3
    s_cselect_b32 s28, 0x3f317218, s28
    buffer_load_dwordx2 v[230:231], v248, s[64:67], s72 offen offset:3584
    v_exp_f32 v21, v21
    v_exp_f32 v22, v22
    v_exp_f32 v23, v23
    v_exp_f32 v24, v24
    v_exp_f32 v25, v25
    v_smfmac_f32_32x32x32_bf16 v[80:95], a[28:31], v[16:23], v1
    s_waitcnt vmcnt(8)
    v_exp_f32 v26, v26
    v_exp_f32 v27, v27
    v_exp_f32 v28, v28
    v_exp_f32 v29, v29
    v_exp_f32 v30, v30
    v_exp_f32 v31, v31
    v_cmp_eq_u32 vcc, -1, v112
    s_cbranch_vccnz L_kp_r
L_kp_ok:
    v_exp_f32 v32, v32
    v_exp_f32 v33, v33
    v_smfmac_f32_32x32x32_bf16 v[80:95], a[32:35], v[24:31], v1
    global_load_dwordx4 a[72:75], v7, s[40:41] offset:-4096 sc1
    v_exp_f32 v34, v34
    v_exp_f32 v35, v35
    v_exp_f32 v36, v36
    v_mfma_f32_32x32x16_bf16 v[16:31], a[36:39], a[192:195], 0
    global_load_dwordx4 a[76:79], v9, s[40:41] offset:-3072 sc1
    v_exp_f32 v37, v37
    v_exp_f32 v38, v38
    v_exp_f32 v39, v39
    v_exp_f32 v40, v40
    v_exp_f32 v41, v41
    v_smfmac_f32_32x32x32_bf16 v[64:79], a[28:31], v[32:39], v1
    global_load_dwordx4 a[80:83], v9, s[40:41] offset:-2048 sc1
    v_exp_f32 v42, v42
    v_exp_f32 v43, v43
    v_exp_f32 v44, v44
    v_exp_f32 v45, v45
    v_exp_f32 v46, v46
    v_exp_f32 v47, v47
    v_exp_f32 v16, v16
    v_exp_f32 v17, v17
    v_smfmac_f32_32x32x32_bf16 v[64:79], a[32:35], v[40:47], v1
    buffer_load_dword v232, v249, s[68:71], s73 offen
    v_exp_f32 v18, v18
    v_exp_f32 v19, v19
    v_exp_f32 v20, v20
    v_mfma_f32_32x32x16_bf16 v[32:47], a[36:39], a[196:199], 0
    s_add_u32 s73, s73, 4096
    global_load_dwordx4 a[84:87], v7, s[40:41] offset:0 sc1
    v_exp_f32 v21, v21
    v_exp_f32 v22, v22
    v_exp_f32 v23, v23
    v_exp_f32 v24, v24
    v_exp_f32 v25, v25
    v_smfmac_f32_32x32x32_bf16 v[80:95], a[40:43], v[16:23], v1
    s_waitcnt vmcnt(16)
    global_load_dwordx4 a[88:91], v9, s[40:41] offset:1024 sc1
    v_exp_f32 v26, v26
    v_exp_f32 v27, v27
    v_exp_f32 v28, v28
    v_exp_f32 v29, v29
    v_exp_f32 v30, v30
    v_exp_f32 v31, v31
    v_accvgpr_read_b32 v113, a48
    v_accvgpr_read_b32 v114, a52
    v_accvgpr_read_b32 v115, a56
    v_max3_u32 v113, v113, v114, v115
    v_accvgpr_read_b32 v114, a60
    v_accvgpr_read_b32 v115, a64
    v_accvgpr_read_b32 v116, a68
    v_max3_u32 v113, v113, v114, v115
    v_max_u32 v113, v113, v116
    v_cmp_eq_u32 vcc, -1, v113
    s_cbranch_vccnz L_kv2_r
L_kv2_ok:
    v_exp_f32 v32, v32
    v_exp_f32 v33, v33
    v_smfmac_f32_32x32x32_bf16 v[80:95], a[44:47], v[24:31], v1
    global_load_dwordx4 a[92:95], v9, s[40:41] offset:2048 sc1
    v_exp_f32 v34, v34
    v_exp_f32 v35, v35
    v_exp_f32 v36, v36
    v_mfma_f32_32x32x16_bf16 v[16:31], a[48:51], a[192:195], 0
    s_xor_b32 s40, s60, 32768
    buffer_load_dword v233, v249, s[68:71], s73 offen
    v_exp_f32 v37, v37
    v_exp_f32 v38, v38
    v_exp_f32 v39, v39
    v_exp_f32 v40, v40
    v_exp_f32 v41, v41
    v_smfmac_f32_32x32x32_bf16 v[64:79], a[40:43], v[32:39], v1
    s_add_u32 s73, s73, 4096
    buffer_load_dword v234, v249, s[68:71], s73 offen
    v_exp_f32 v42, v42
    v_exp_f32 v43, v43
    v_exp_f32 v44, v44
    v_exp_f32 v45, v45
    v_exp_f32 v46, v46
    v_exp_f32 v47, v47
    v_exp_f32 v16, v16
    v_exp_f32 v17, v17
    v_smfmac_f32_32x32x32_bf16 v[64:79], a[44:47], v[40:47], v1
    s_add_u32 s73, s73, 4096
    buffer_load_dword v235, v249, s[68:71], s73 offen
    v_exp_f32 v18, v18
    v_exp_f32 v19, v19
    v_exp_f32 v20, v20
    v_mfma_f32_32x32x16_bf16 v[32:47], a[48:51], a[196:199], 0
    s_add_u32 s73, s73, 20480
    global_load_dwordx4 a[96:99], v7, s[40:41] offset:-4096 sc1
    v_exp_f32 v21, v21
    v_exp_f32 v22, v22
    v_exp_f32 v23, v23
    v_exp_f32 v24, v24
    v_exp_f32 v25, v25
    v_smfmac_f32_32x32x32_bf16 v[80:95], a[52:55], v[16:23], v1
    global_load_dwordx4 a[100:103], v9, s[40:41] offset:-3072 sc1
    v_exp_f32 v26, v26
    v_exp_f32 v27, v27
    v_exp_f32 v28, v28
    v_exp_f32 v29, v29
    v_exp_f32 v30, v30
    v_exp_f32 v31, v31
    v_exp_f32 v32, v32
    v_exp_f32 v33, v33
    v_smfmac_f32_32x32x32_bf16 v[80:95], a[56:59], v[24:31], v1
    global_load_dwordx4 a[104:107], v9, s[40:41] offset:-2048 sc1
    v_exp_f32 v34, v34
    v_exp_f32 v35, v35
    v_exp_f32 v36, v36
    v_mfma_f32_32x32x16_bf16 v[16:31], a[60:63], a[192:195], 0
    buffer_load_dword v236, v249, s[68:71], s73 offen
    v_exp_f32 v37, v37
    v_exp_f32 v38, v38
    v_exp_f32 v39, v39
    v_exp_f32 v40, v40
    v_exp_f32 v41, v41
    v_smfmac_f32_32x32x32_bf16 v[64:79], a[52:55], v[32:39], v1
    s_add_u32 s73, s73, 4096
    buffer_load_dword v237, v249, s[68:71], s73 offen
    v_exp_f32 v42, v42
    v_exp_f32 v43, v43
    v_exp_f32 v44, v44
    v_exp_f32 v45, v45
    v_exp_f32 v46, v46
    v_exp_f32 v47, v47
    v_mov_b32 v123, s5
    v_exp_f32 v16, v16
    v_exp_f32 v17, v17
    v_smfmac_f32_32x32x32_bf16 v[64:79], a[56:59], v[40:47], v1
    s_waitcnt vmcnt(24)
    s_barrier
    s_add_u32 s73, s73, 4096
    buffer_load_dword v238, v249, s[68:71], s73 offen
    v_exp_f32 v18, v18
    v_exp_f32 v19, v19
    v_exp_f32 v20, v20
    v_mfma_f32_32x32x16_bf16 v[32:47], a[60:63], a[196:199], 0
    s_mov_b64 exec, s[8:9]
    buffer_store_dword v123, v7, s[20:23], s12 offen offset:0 sc1
    s_mov_b64 exec, -1
    v_exp_f32 v21, v21
    v_exp_f32 v22, v22
    v_exp_f32 v23, v23
    v_exp_f32 v24, v24
    v_exp_f32 v25, v25
    v_smfmac_f32_32x32x32_bf16 v[80:95], a[64:67], v[16:23], v1
    s_add_u32 s73, s73, 4096
    global_load_dwordx4 a[108:111], v7, s[40:41] offset:0 sc1
    v_exp_f32 v26, v26
    v_exp_f32 v27, v27
    v_exp_f32 v28, v28
    v_exp_f32 v29, v29
    v_exp_f32 v30, v30
    v_exp_f32 v31, v31
    v_exp_f32 v32, v32
    v_exp_f32 v33, v33
    v_smfmac_f32_32x32x32_bf16 v[80:95], a[68:71], v[24:31], v1
    s_waitcnt vmcnt(15)
    global_load_dwordx4 a[112:115], v9, s[40:41] offset:1024 sc1
    v_exp_f32 v34, v34
    v_exp_f32 v35, v35
    v_exp_f32 v36, v36
    v_mfma_f32_32x32x16_bf16 v[16:31], a[72:75], a[192:195], 0
    global_load_dwordx4 a[116:119], v9, s[40:41] offset:2048 sc1
    v_exp_f32 v37, v37
    v_exp_f32 v38, v38
    v_exp_f32 v39, v39
    v_exp_f32 v40, v40
    v_exp_f32 v41, v41
    v_smfmac_f32_32x32x32_bf16 v[64:79], a[64:67], v[32:39], v1
    s_xor_b32 s40, s60, 40960
    buffer_load_dword v239, v249, s[68:71], s73 offen
    v_exp_f32 v42, v42
    v_exp_f32 v43, v43
    v_exp_f32 v44, v44
    v_exp_f32 v45, v45
    v_exp_f32 v46, v46
    v_exp_f32 v47, v47
    v_exp_f32 v16, v16
    v_exp_f32 v17, v17
    v_smfmac_f32_32x32x32_bf16 v[64:79], a[68:71], v[40:47], v1
    s_lshr_b32 s34, s2, 6
    s_and_b32 s35, s32, 7
    global_load_dwordx4 a[120:123], v7, s[40:41] offset:-4096 sc1
    v_exp_f32 v18, v18
    v_exp_f32 v19, v19
    v_exp_f32 v20, v20
    v_mfma_f32_32x32x16_bf16 v[32:47], a[72:75], a[196:199], 0
    s_lshl3_add_u32 s65, s34, s3
    global_load_dwordx4 a[124:127], v9, s[40:41] offset:-3072 sc1
    v_exp_f32 v21, v21
    v_exp_f32 v22, v22
    v_exp_f32 v23, v23
    v_exp_f32 v24, v24
    v_exp_f32 v25, v25
    v_smfmac_f32_32x32x32_bf16 v[80:95], a[76:79], v[16:23], v1
    s_waitcnt vmcnt(23)
    s_xor_b32 s66, s65, s35
    global_load_dwordx4 a[128:131], v9, s[40:41] offset:-2048 sc1
    v_exp_f32 v26, v26
    v_exp_f32 v27, v27
    v_exp_f32 v28, v28
    v_exp_f32 v29, v29
    v_exp_f32 v30, v30
    v_exp_f32 v31, v31
    v_perm_b32 v176, v218, v216, s16
    v_perm_b32 v177, v222, v220, s16
    v_perm_b32 v178, v226, v224, s16
    v_perm_b32 v179, v230, v228, s16
    v_exp_f32 v32, v32
    v_exp_f32 v33, v33
    v_smfmac_f32_32x32x32_bf16 v[80:95], a[80:83], v[24:31], v1
    s_waitcnt vmcnt(17)
    s_lshl_b32 s65, s65, 12
    buffer_store_dwordx4 v[176:179], v7, s[96:99], s100 offen sc1
    v_exp_f32 v34, v34
    v_exp_f32 v35, v35
    v_exp_f32 v36, v36
    v_mfma_f32_32x32x16_bf16 v[16:31], a[84:87], a[192:195], 0
    s_add_u32 s100, s100, 229376
    global_load_dwordx4 a[132:135], v7, s[40:41] offset:0 sc1
    v_exp_f32 v37, v37
    v_exp_f32 v38, v38
    v_exp_f32 v39, v39
    v_exp_f32 v40, v40
    v_exp_f32 v41, v41
    v_smfmac_f32_32x32x32_bf16 v[64:79], a[76:79], v[32:39], v1
    s_lshl_b32 s66, s66, 12
    s_lshl2_add_u32 s73, s34, s3
    global_load_dwordx4 a[136:139], v9, s[40:41] offset:1024 sc1
    v_exp_f32 v42, v42
    v_exp_f32 v43, v43
    v_exp_f32 v44, v44
    v_exp_f32 v45, v45
    v_exp_f32 v46, v46
    v_exp_f32 v47, v47
    v_exp_f32 v16, v16
    v_exp_f32 v17, v17
    v_smfmac_f32_32x32x32_bf16 v[64:79], a[80:83], v[40:47], v1
    s_xor_b32 s73, s73, s35
    s_lshl_b32 s73, s73, 12
    global_load_dwordx4 a[140:143], v9, s[40:41] offset:2048 sc1
    v_exp_f32 v18, v18
    v_exp_f32 v19, v19
    v_exp_f32 v20, v20
    v_mfma_f32_32x32x16_bf16 v[32:47], a[84:87], a[196:199], 0
    s_xor_b32 s40, s60, 49152
    global_load_dwordx4 a[144:147], v7, s[40:41] offset:-4096 sc1
    v_exp_f32 v21, v21
    v_exp_f32 v22, v22
    v_exp_f32 v23, v23
    v_exp_f32 v24, v24
    v_exp_f32 v25, v25
    v_smfmac_f32_32x32x32_bf16 v[80:95], a[88:91], v[16:23], v1
    s_and_b32 s33, s32, 15
    s_mul_i32 s33, s33, 229376
    global_load_dwordx4 a[148:151], v9, s[40:41] offset:-3072 sc1
    v_exp_f32 v26, v26
    v_exp_f32 v27, v27
    v_exp_f32 v28, v28
    v_exp_f32 v29, v29
    v_exp_f32 v30, v30
    v_exp_f32 v31, v31
    v_exp_f32 v32, v32
    v_exp_f32 v33, v33
    v_smfmac_f32_32x32x32_bf16 v[80:95], a[92:95], v[24:31], v1
    s_waitcnt vmcnt(17)
    s_add_u32 s33, s33, s62
    global_load_dwordx4 a[152:155], v9, s[40:41] offset:-2048 sc1
    v_exp_f32 v34, v34
    v_exp_f32 v35, v35
    v_exp_f32 v36, v36
    v_mfma_f32_32x32x16_bf16 v[16:31], a[96:99], a[192:195], 0
    s_add_u32 s67, s33, 8388608
    global_load_dwordx4 a[156:159], v7, s[40:41] offset:0 sc1
    v_exp_f32 v37, v37
    v_exp_f32 v38, v38
    v_exp_f32 v39, v39
    v_exp_f32 v40, v40
    v_exp_f32 v41, v41
    v_smfmac_f32_32x32x32_bf16 v[64:79], a[88:91], v[32:39], v1
    s_xor_b32 s34, s34, s35
    s_and_b32 s34, s34, 2
    global_load_dwordx4 a[160:163], v9, s[40:41] offset:1024 sc1
    v_exp_f32 v42, v42
    v_exp_f32 v43, v43
    v_exp_f32 v44, v44
    v_exp_f32 v45, v45
    v_exp_f32 v46, v46
    v_exp_f32 v47, v47
    v_perm_b32 v180, v218, v216, s17
    v_perm_b32 v181, v222, v220, s17
    v_perm_b32 v182, v226, v224, s17
    v_perm_b32 v183, v230, v228, s17
    v_exp_f32 v16, v16
    v_exp_f32 v17, v17
    v_smfmac_f32_32x32x32_bf16 v[64:79], a[92:95], v[40:47], v1
    s_mul_i32 s33, s3, 28
    s_add_u32 s34, s34, s33
    buffer_store_dwordx4 v[180:183], v7, s[96:99], s100 offen sc1
    v_exp_f32 v18, v18
    v_exp_f32 v19, v19
    v_exp_f32 v20, v20
    v_mfma_f32_32x32x16_bf16 v[32:47], a[96:99], a[196:199], 0
    s_add_u32 s100, s100, 229376
    global_load_dwordx4 a[164:167], v9, s[40:41] offset:2048 sc1
    v_exp_f32 v21, v21
    v_exp_f32 v22, v22
    v_exp_f32 v23, v23
    v_exp_f32 v24, v24
    v_exp_f32 v25, v25
    v_smfmac_f32_32x32x32_bf16 v[80:95], a[100:103], v[16:23], v1
    s_xor_b32 s40, s60, 57344
    s_mul_i32 s33, s35, 112
    global_load_dwordx4 a[168:171], v7, s[40:41] offset:-4096 sc1
    v_exp_f32 v26, v26
    v_exp_f32 v27, v27
    v_exp_f32 v28, v28
    v_exp_f32 v29, v29
    v_exp_f32 v30, v30
    v_exp_f32 v31, v31
    v_exp_f32 v32, v32
    v_exp_f32 v33, v33
    v_smfmac_f32_32x32x32_bf16 v[80:95], a[104:107], v[24:31], v1
    s_waitcnt vmcnt(16)
    s_add_u32 s33, s33, s34
    global_load_dwordx4 a[172:175], v9, s[40:41] offset:-3072 sc1
    v_exp_f32 v34, v34
    v_exp_f32 v35, v35
    v_exp_f32 v36, v36
    v_mfma_f32_32x32x16_bf16 v[16:31], a[108:111], a[192:195], 0
    s_lshl_b32 s33, s33, 11
    global_load_dwordx4 a[176:179], v9, s[40:41] offset:-2048 sc1
    v_exp_f32 v37, v37
    v_exp_f32 v38, v38
    v_exp_f32 v39, v39
    v_exp_f32 v40, v40
    v_exp_f32 v41, v41
    v_smfmac_f32_32x32x32_bf16 v[64:79], a[100:103], v[32:39], v1
    s_add_u32 s33, s33, s62
    s_add_u32 s68, s33, 12582912
    global_load_dwordx4 a[180:183], v7, s[40:41] offset:0 sc1
    v_exp_f32 v42, v42
    v_exp_f32 v43, v43
    v_exp_f32 v44, v44
    v_exp_f32 v45, v45
    v_exp_f32 v46, v46
    v_exp_f32 v47, v47
    v_exp_f32 v16, v16
    v_exp_f32 v17, v17
    v_smfmac_f32_32x32x32_bf16 v[64:79], a[104:107], v[40:47], v1
    s_xor_b32 s69, s68, 2048
    s_xor_b32 s70, s68, 4096
    global_load_dwordx4 a[184:187], v9, s[40:41] offset:1024 sc1
    v_exp_f32 v18, v18
    v_exp_f32 v19, v19
    v_exp_f32 v20, v20
    v_mfma_f32_32x32x16_bf16 v[32:47], a[108:111], a[196:199], 0
    s_xor_b32 s71, s68, 6144
    global_load_dwordx4 a[188:191], v9, s[40:41] offset:2048 sc1
    v_exp_f32 v21, v21
    v_exp_f32 v22, v22
    v_exp_f32 v23, v23
    v_exp_f32 v24, v24
    v_exp_f32 v25, v25
    v_smfmac_f32_32x32x32_bf16 v[80:95], a[112:115], v[16:23], v1
    v_exp_f32 v26, v26
    v_exp_f32 v27, v27
    v_exp_f32 v28, v28
    v_exp_f32 v29, v29
    v_exp_f32 v30, v30
    v_exp_f32 v31, v31
    v_perm_b32 v184, v219, v217, s16
    v_perm_b32 v185, v223, v221, s16
    v_perm_b32 v186, v227, v225, s16
    v_perm_b32 v187, v231, v229, s16
    v_exp_f32 v32, v32
    v_exp_f32 v33, v33
    v_smfmac_f32_32x32x32_bf16 v[80:95], a[116:119], v[24:31], v1
    s_waitcnt vmcnt(17)
L_w3:
    s_cbranch_execz L_w4
    buffer_store_dwordx4 v[184:187], v7, s[96:99], s100 offen sc1
    v_exp_f32 v34, v34
    v_exp_f32 v35, v35
    v_exp_f32 v36, v36
    v_mfma_f32_32x32x16_bf16 v[16:31], a[120:123], a[192:195], 0
    s_add_u32 s100, s100, 229376
    v_exp_f32 v37, v37
    v_exp_f32 v38, v38
    v_exp_f32 v39, v39
    v_exp_f32 v40, v40
    v_exp_f32 v41, v41
    v_smfmac_f32_32x32x32_bf16 v[64:79], a[112:115], v[32:39], v1
    v_exp_f32 v42, v42
    v_exp_f32 v43, v43
    v_exp_f32 v44, v44
    v_exp_f32 v45, v45
    v_exp_f32 v46, v46
    v_exp_f32 v47, v47
    v_exp_f32 v16, v16
    v_exp_f32 v17, v17
    v_smfmac_f32_32x32x32_bf16 v[64:79], a[116:119], v[40:47], v1
    v_exp_f32 v18, v18
    v_exp_f32 v19, v19
    v_exp_f32 v20, v20
    v_mfma_f32_32x32x16_bf16 v[32:47], a[120:123], a[196:199], 0
    v_exp_f32 v21, v21
    v_exp_f32 v22, v22
    v_exp_f32 v23, v23
    v_exp_f32 v24, v24
    v_exp_f32 v25, v25
    v_smfmac_f32_32x32x32_bf16 v[80:95], a[124:127], v[16:23], v1
    s_waitcnt vmcnt(21)
    s_mov_b64 exec, s[26:27]
    buffer_load_dwordx4 v[116:119], v7, s[20:23], s18 offen offset:0 sc1
    s_mov_b64 exec, -1
    v_exp_f32 v26, v26
    v_exp_f32 v27, v27
    v_exp_f32 v28, v28
    v_exp_f32 v29, v29
    v_exp_f32 v30, v30
    v_exp_f32 v31, v31
    v_perm_b32 v192, v233, v232, s16
    v_perm_b32 v193, v235, v234, s16
    v_perm_b32 v194, v237, v236, s16
    v_perm_b32 v195, v239, v238, s16
    v_exp_f32 v32, v32
    v_exp_f32 v33, v33
    v_smfmac_f32_32x32x32_bf16 v[80:95], a[128:131], v[24:31], v1
    s_waitcnt vmcnt(15)
    global_load_dword v255, v255, s[56:57] offset:2048
    v_exp_f32 v34, v34
    v_exp_f32 v35, v35
    v_exp_f32 v36, v36
    v_mfma_f32_32x32x16_bf16 v[16:31], a[132:135], a[192:195], 0
    v_exp_f32 v37, v37
    v_exp_f32 v38, v38
    v_exp_f32 v39, v39
    v_exp_f32 v40, v40
    v_exp_f32 v41, v41
    v_smfmac_f32_32x32x32_bf16 v[64:79], a[124:127], v[32:39], v1
    v_exp_f32 v42, v42
    v_exp_f32 v43, v43
    v_exp_f32 v44, v44
    v_exp_f32 v45, v45
    v_exp_f32 v46, v46
    v_exp_f32 v47, v47
    v_perm_b32 v188, v219, v217, s17
    v_perm_b32 v189, v223, v221, s17
    v_perm_b32 v190, v227, v225, s17
    v_perm_b32 v191, v231, v229, s17
    v_perm_b32 v196, v233, v232, s17
    v_perm_b32 v197, v235, v234, s17
    v_perm_b32 v198, v237, v236, s17
    v_perm_b32 v199, v239, v238, s17
    v_exp_f32 v16, v16
    v_exp_f32 v17, v17
    v_smfmac_f32_32x32x32_bf16 v[64:79], a[128:131], v[40:47], v1
    s_xor_b32 s42, s19, 0
    buffer_store_dwordx4 v[188:191], v7, s[96:99], s100 offen sc1
    v_exp_f32 v18, v18
    v_exp_f32 v19, v19
    v_exp_f32 v20, v20
    v_mfma_f32_32x32x16_bf16 v[32:47], a[132:135], a[196:199], 0
    v_exp_f32 v21, v21
    v_exp_f32 v22, v22
    v_exp_f32 v23, v23
    v_exp_f32 v24, v24
    v_exp_f32 v25, v25
    v_smfmac_f32_32x32x32_bf16 v[80:95], a[136:139], v[16:23], v1
    v_exp_f32 v26, v26
    v_exp_f32 v27, v27
    v_exp_f32 v28, v28
    v_exp_f32 v29, v29
    v_exp_f32 v30, v30
    v_exp_f32 v31, v31
    v_mov_b32 v122, s0
    v_exp_f32 v32, v32
    v_exp_f32 v33, v33
    v_smfmac_f32_32x32x32_bf16 v[80:95], a[140:143], v[24:31], v1
    s_waitcnt vmcnt(14)
    v_exp_f32 v34, v34
    v_exp_f32 v35, v35
    v_exp_f32 v36, v36
    v_mfma_f32_32x32x16_bf16 v[16:31], a[144:147], a[192:195], 0
    s_mov_b64 exec, s[8:9]
    buffer_store_dword v122, v7, s[20:23], s12 offen offset:3072 sc1
    s_mov_b64 exec, -1
    v_exp_f32 v37, v37
    v_exp_f32 v38, v38
    v_exp_f32 v39, v39
    v_exp_f32 v40, v40
    v_exp_f32 v41, v41
    v_smfmac_f32_32x32x32_bf16 v[64:79], a[136:139], v[32:39], v1
    v_exp_f32 v42, v42
    v_exp_f32 v43, v43
    v_exp_f32 v44, v44
    v_exp_f32 v45, v45
    v_exp_f32 v46, v46
    v_exp_f32 v47, v47
    v_xor_b32 v0, 2048, v0
    v_exp_f32 v16, v16
    v_exp_f32 v17, v17
    v_smfmac_f32_32x32x32_bf16 v[64:79], a[140:143], v[40:47], v1
    v_exp_f32 v18, v18
    v_exp_f32 v19, v19
    v_exp_f32 v20, v20
    v_mfma_f32_32x32x16_bf16 v[32:47], a[144:147], a[196:199], 0
    v_exp_f32 v21, v21
    v_exp_f32 v22, v22
    v_exp_f32 v23, v23
    v_exp_f32 v24, v24
    v_exp_f32 v25, v25
    v_smfmac_f32_32x32x32_bf16 v[80:95], a[148:151], v[16:23], v1
    s_waitcnt vmcnt(3)
    v_exp_f32 v26, v26
    v_exp_f32 v27, v27
    v_exp_f32 v28, v28
    v_exp_f32 v29, v29
    v_exp_f32 v30, v30
    v_exp_f32 v31, v31
    v_add3_u32 v116, v116, v117, v118
    v_add_u32 v116, v116, v119
    v_cmp_ne_u32 vcc, s4, v116
    s_nop 0
    s_and_b64 vcc, vcc, s[26:27]
    s_cbranch_vccnz L_f0_r
L_f0_ok:
    v_exp_f32 v32, v32
    v_exp_f32 v33, v33
    v_smfmac_f32_32x32x32_bf16 v[80:95], a[152:155], v[24:31], v1
    s_waitcnt vmcnt(11)
    s_barrier
    buffer_store_dwordx4 v[192:195], v7, s[96:99], s101 offen offset:0 sc1
    v_exp_f32 v34, v34
    v_exp_f32 v35, v35
    v_exp_f32 v36, v36
    v_mfma_f32_32x32x16_bf16 v[16:31], a[156:159], a[192:195], 0
    global_load_dwordx4 a[200:203], v0, s[62:63] offset:0 sc1
    v_exp_f32 v37, v37
    v_exp_f32 v38, v38
    v_exp_f32 v39, v39
    v_exp_f32 v40, v40
    v_exp_f32 v41, v41
    v_smfmac_f32_32x32x32_bf16 v[64:79], a[148:151], v[32:39], v1
    global_load_dwordx4 a[224:227], v7, s[42:43] offset:-4096 sc1
    v_exp_f32 v42, v42
    v_exp_f32 v43, v43
    v_exp_f32 v44, v44
    v_exp_f32 v45, v45
    v_exp_f32 v46, v46
    v_exp_f32 v47, v47
    v_exp_f32 v16, v16
    v_exp_f32 v17, v17
    v_smfmac_f32_32x32x32_bf16 v[64:79], a[152:155], v[40:47], v1
    global_load_dwordx4 a[228:231], v7, s[42:43] offset:-3072 sc1
    v_exp_f32 v18, v18
    v_exp_f32 v19, v19
    v_exp_f32 v20, v20
    v_mfma_f32_32x32x16_bf16 v[32:47], a[156:159], a[196:199], 0
    global_load_dwordx4 a[232:235], v7, s[42:43] offset:-2048 sc1
    v_exp_f32 v21, v21
    v_exp_f32 v22, v22
    v_exp_f32 v23, v23
    v_exp_f32 v24, v24
    v_exp_f32 v25, v25
    v_smfmac_f32_32x32x32_bf16 v[80:95], a[160:163], v[16:23], v1
    global_load_dwordx4 a[236:239], v7, s[42:43] offset:-1024 sc1
    v_exp_f32 v26, v26
    v_exp_f32 v27, v27
    v_exp_f32 v28, v28
    v_exp_f32 v29, v29
    v_exp_f32 v30, v30
    v_exp_f32 v31, v31
    v_exp_f32 v32, v32
    v_exp_f32 v33, v33
    v_smfmac_f32_32x32x32_bf16 v[80:95], a[164:167], v[24:31], v1
    s_waitcnt vmcnt(14)
    global_load_dwordx4 a[240:243], v7, s[42:43] offset:0 sc1
    v_exp_f32 v34, v34
    v_exp_f32 v35, v35
    v_exp_f32 v36, v36
    v_mfma_f32_32x32x16_bf16 v[16:31], a[168:171], a[192:195], 0
    global_load_dwordx4 a[244:247], v7, s[42:43] offset:1024 sc1
    v_exp_f32 v37, v37
    v_exp_f32 v38, v38
    v_exp_f32 v39, v39
    v_exp_f32 v40, v40
    v_exp_f32 v41, v41
    v_smfmac_f32_32x32x32_bf16 v[64:79], a[160:163], v[32:39], v1
    global_load_dwordx4 a[248:251], v7, s[42:43] offset:2048 sc1
    v_exp_f32 v42, v42
    v_exp_f32 v43, v43
    v_exp_f32 v44, v44
    v_exp_f32 v45, v45
    v_exp_f32 v46, v46
    v_exp_f32 v47, v47
    v_exp_f32 v16, v16
    v_exp_f32 v17, v17
    v_smfmac_f32_32x32x32_bf16 v[64:79], a[164:167], v[40:47], v1
    buffer_store_dwordx4 v[196:199], v7, s[96:99], s101 offen offset:1024 sc1
    v_exp_f32 v18, v18
    v_exp_f32 v19, v19
    v_exp_f32 v20, v20
    v_mfma_f32_32x32x16_bf16 v[32:47], a[168:171], a[196:199], 0
    global_load_dwordx4 a[252:255], v7, s[42:43] offset:3072 sc1
    v_exp_f32 v21, v21
    v_exp_f32 v22, v22
    v_exp_f32 v23, v23
    v_exp_f32 v24, v24
    v_exp_f32 v25, v25
    v_smfmac_f32_32x32x32_bf16 v[80:95], a[172:175], v[16:23], v1
    s_xor_b32 s42, s19, 8192
    global_load_dwordx4 v[152:155], v7, s[42:43] offset:-4096 sc1
    v_exp_f32 v26, v26
    v_exp_f32 v27, v27
    v_exp_f32 v28, v28
    v_exp_f32 v29, v29
    v_exp_f32 v30, v30
    v_exp_f32 v31, v31
    v_exp_f32 v32, v32
    v_exp_f32 v33, v33
    v_smfmac_f32_32x32x32_bf16 v[80:95], a[176:179], v[24:31], v1
    s_waitcnt vmcnt(17)
    global_load_dwordx4 v[156:159], v7, s[42:43] offset:-3072 sc1
    v_exp_f32 v34, v34
    v_exp_f32 v35, v35
    v_exp_f32 v36, v36
    v_mfma_f32_32x32x16_bf16 v[16:31], a[180:183], a[192:195], 0
    global_load_dwordx4 v[160:163], v7, s[42:43] offset:-2048 sc1
    v_exp_f32 v37, v37
    v_exp_f32 v38, v38
    v_exp_f32 v39, v39
    v_exp_f32 v40, v40
    v_exp_f32 v41, v41
    v_smfmac_f32_32x32x32_bf16 v[64:79], a[172:175], v[32:39], v1
    global_load_dwordx4 v[164:167], v7, s[42:43] offset:-1024 sc1
    v_exp_f32 v42, v42
    v_exp_f32 v43, v43
    v_exp_f32 v44, v44
    v_exp_f32 v45, v45
    v_exp_f32 v46, v46
    v_exp_f32 v47, v47
    v_exp_f32 v16, v16
    v_exp_f32 v17, v17
    v_smfmac_f32_32x32x32_bf16 v[64:79], a[176:179], v[40:47], v1
    global_load_dwordx4 v[168:171], v7, s[42:43] offset:0 sc1
    v_exp_f32 v18, v18
    v_exp_f32 v19, v19
    v_exp_f32 v20, v20
    v_mfma_f32_32x32x16_bf16 v[32:47], a[180:183], a[196:199], 0
    global_load_dwordx4 v[172:175], v7, s[42:43] offset:1024 sc1
    v_exp_f32 v21, v21
    v_exp_f32 v22, v22
    v_exp_f32 v23, v23
    v_exp_f32 v24, v24
    v_exp_f32 v25, v25
    v_smfmac_f32_32x32x32_bf16 v[80:95], a[184:187], v[16:23], v1
    global_load_dwordx4 v[200:203], v7, s[42:43] offset:2048 sc1
    v_exp_f32 v26, v26
    v_exp_f32 v27, v27
    v_exp_f32 v28, v28
    v_exp_f32 v29, v29
    v_exp_f32 v30, v30
    v_exp_f32 v31, v31
    v_exp_f32 v32, v32
    v_exp_f32 v33, v33
    v_smfmac_f32_32x32x32_bf16 v[80:95], a[188:191], v[24:31], v1
    s_waitcnt vmcnt(16)
    global_load_dwordx4 v[204:207], v7, s[42:43] offset:3072 sc1
    v_exp_f32 v34, v34
    v_exp_f32 v35, v35
    v_exp_f32 v36, v36
    v_mfma_f32_32x32x16_bf16 v[16:31], a[0:3], a[200:203], 0
    s_xor_b32 s42, s19, 16384
    global_load_dwordx4 a[204:207], v0, s[62:63] offset:1024 sc1
    v_exp_f32 v37, v37
    v_exp_f32 v38, v38
    v_exp_f32 v39, v39
    v_exp_f32 v40, v40
    v_exp_f32 v41, v41
    v_smfmac_f32_32x32x32_bf16 v[64:79], a[184:187], v[32:39], v1
    ds_write2st64_b64 v3, v[80:81], v[82:83] offset0:0 offset1:1
    v_exp_f32 v42, v42
    v_exp_f32 v43, v43
    v_exp_f32 v44, v44
    v_exp_f32 v45, v45
    v_exp_f32 v46, v46
    v_exp_f32 v47, v47
    v_exp_f32 v16, v16
    v_exp_f32 v17, v17
    v_smfmac_f32_32x32x32_bf16 v[64:79], a[188:191], v[40:47], v1
    ds_write2st64_b64 v3, v[84:85], v[86:87] offset0:2 offset1:3
    v_exp_f32 v18, v18
    v_exp_f32 v19, v19
    v_exp_f32 v20, v20
    v_mfma_f32_32x32x16_bf16 v[32:47], a[12:15], a[200:203], 0
    ds_write_b32 v3, v88 offset:2048
    v_exp_f32 v21, v21
    v_exp_f32 v22, v22
    v_exp_f32 v23, v23
    v_exp_f32 v24, v24
    v_exp_f32 v25, v25
    v_smfmac_f32_32x32x32_bf16 v[48:63], a[4:7], v[16:23], v1
    global_load_dwordx4 v[208:211], v7, s[42:43] offset:-4096 sc1
    v_exp_f32 v26, v26
    v_exp_f32 v27, v27
    v_exp_f32 v28, v28
    v_exp_f32 v29, v29
    v_exp_f32 v30, v30
    v_exp_f32 v31, v31
    v_mov_b32 v123, s5
    v_exp_f32 v32, v32
    v_exp_f32 v33, v33
    v_smfmac_f32_32x32x32_bf16 v[48:63], a[8:11], v[24:31], v1
    s_waitcnt vmcnt(11) lgkmcnt(0)
    s_barrier
    ds_read2st64_b32 v[124:125], v2 offset0:8 offset1:24
    ds_read2st64_b32 v[126:127], v2 offset0:40 offset1:56
    v_exp_f32 v34, v34
    v_exp_f32 v35, v35
    v_exp_f32 v36, v36
    v_mfma_f32_32x32x16_bf16 v[16:31], a[24:27], a[200:203], 0
    s_mov_b64 exec, s[8:9]
    buffer_store_dword v123, v7, s[20:23], s12 offen offset:1024 sc1
    s_mov_b64 exec, -1
    ds_read2st64_b64 v[116:119], v4 offset0:0 offset1:8
    v_exp_f32 v37, v37
    v_exp_f32 v38, v38
    v_exp_f32 v39, v39
    v_exp_f32 v40, v40
    v_exp_f32 v41, v41
    v_smfmac_f32_32x32x32_bf16 v[48:63], a[16:19], v[32:39], v1
    ds_read2st64_b64 v[120:123], v4 offset0:16 offset1:24
    v_exp_f32 v42, v42
    v_exp_f32 v43, v43
    v_exp_f32 v44, v44
    v_exp_f32 v45, v45
    v_exp_f32 v46, v46
    v_exp_f32 v47, v47
    v_exp_f32 v16, v16
    v_exp_f32 v17, v17
    v_smfmac_f32_32x32x32_bf16 v[48:63], a[20:23], v[40:47], v1
    s_lshr_b32 s33, s32, 3
    s_mul_i32 s33, s33, 224
    global_store_dwordx4 v131, v[10:13], s[62:63] offset:0 sc1
    v_exp_f32 v18, v18
    v_exp_f32 v19, v19
    v_exp_f32 v20, v20
    v_mfma_f32_32x32x16_bf16 v[32:47], a[36:39], a[200:203], 0
    s_add_u32 s33, s33, s34
    global_load_dwordx4 v[212:215], v7, s[42:43] offset:-3072 sc1
    v_exp_f32 v21, v21
    v_exp_f32 v22, v22
    v_exp_f32 v23, v23
    v_exp_f32 v24, v24
    v_exp_f32 v25, v25
    v_smfmac_f32_32x32x32_bf16 v[48:63], a[28:31], v[16:23], v1
    s_waitcnt lgkmcnt(0)
    s_lshl_b32 s33, s33, 10
    global_load_dwordx4 v[216:219], v7, s[42:43] offset:-2048 sc1
    v_exp_f32 v26, v26
    v_exp_f32 v27, v27
    v_exp_f32 v28, v28
    v_exp_f32 v29, v29
    v_mfma_f32_32x32x8_f16 v[80:95], v[14:15], v[14:15], 0
    s_add_u32 s33, s33, s62
    v_exp_f32 v30, v30
    v_exp_f32 v31, v31
    v_add_f32 v124, v124, v125
    v_add_f32 v126, v126, v127
    v_add_f32 v116, v116, v118
    v_add_f32 v124, v124, v126
    v_add_f32 v117, v117, v119
    v_rcp_f32 v125, v124
    v_add_f32 v120, v120, v122
    v_add_f32 v121, v121, v123
    v_add_f32 v116, v116, v120
    v_add_f32 v117, v117, v121
    v_mul_f32 v116, v116, v125
    v_mul_f32 v117, v117, v125
    v_cvt_pk_bf16_f32 v118, v116, v117
    v_add_f32 v124, v124, v125
    v_cmp_ngt_f32 vcc, 0x5f800000, v124
    v_exp_f32 v32, v32
    v_exp_f32 v33, v33
    v_smfmac_f32_32x32x32_bf16 v[48:63], a[32:35], v[24:31], v1
    s_add_u32 s24, s33, 16777216
    s_or_b64 s[6:7], s[6:7], vcc
    ds_write_b32 v5, v118
    v_exp_f32 v34, v34
    v_exp_f32 v35, v35
    v_exp_f32 v36, v36
    v_mfma_f32_32x32x16_bf16 v[16:31], a[48:51], a[200:203], 0
    s_xor_b32 s25, s24, 2048
    global_load_dwordx4 v[220:223], v7, s[42:43] offset:-1024 sc1
    v_exp_f32 v37, v37
    v_exp_f32 v38, v38
    v_exp_f32 v39, v39
    v_exp_f32 v40, v40
    v_exp_f32 v41, v41
    v_smfmac_f32_32x32x32_bf16 v[48:63], a[40:43], v[32:39], v1
    s_lshr_b32 s33, s15, 1
    s_add_u32 s61, s33, 20480
    global_load_dwordx4 v[224:227], v7, s[42:43] offset:0 sc1
    v_exp_f32 v42, v42
    v_exp_f32 v43, v43
    v_exp_f32 v44, v44
    v_exp_f32 v45, v45
    v_exp_f32 v46, v46
    v_exp_f32 v47, v47
    v_exp_f32 v16, v16
    v_exp_f32 v17, v17
    v_smfmac_f32_32x32x32_bf16 v[48:63], a[44:47], v[40:47], v1
    s_waitcnt lgkmcnt(0)
    s_barrier
    ds_read_b128 v[112:115], v6
    v_exp_f32 v18, v18
    v_exp_f32 v19, v19
    v_exp_f32 v20, v20
    v_mfma_f32_32x32x16_bf16 v[32:47], a[60:63], a[200:203], 0
    s_add_u32 s33, s33, s62
    global_load_dwordx4 v[228:231], v7, s[42:43] offset:1024 sc1
    v_exp_f32 v21, v21
    v_exp_f32 v22, v22
    v_exp_f32 v23, v23
    v_exp_f32 v24, v24
    v_exp_f32 v25, v25
    v_smfmac_f32_32x32x32_bf16 v[48:63], a[52:55], v[16:23], v1
    s_add_u32 s50, s33, 4096
    s_lshr_b32 s33, s32, 4
    global_load_dwordx4 v[232:235], v7, s[42:43] offset:2048 sc1
    v_exp_f32 v26, v26
    v_exp_f32 v27, v27
    v_exp_f32 v28, v28
    v_exp_f32 v29, v29
    v_exp_f32 v30, v30
    v_exp_f32 v31, v31
    v_exp_f32 v32, v32
    v_exp_f32 v33, v33
    v_smfmac_f32_32x32x32_bf16 v[48:63], a[56:59], v[24:31], v1
    s_lshl2_add_u32 s33, s33, s3
    s_lshl3_add_u32 s34, s33, s35
    global_load_dwordx4 v[236:239], v7, s[42:43] offset:3072 sc1
    v_exp_f32 v34, v34
    v_exp_f32 v35, v35
    v_exp_f32 v36, v36
    v_mfma_f32_32x32x16_bf16 v[16:31], a[72:75], a[200:203], 0
    s_xor_b32 s42, s19, 24576
    global_load_dwordx4 v[240:243], v7, s[42:43] offset:-4096 sc1
    v_exp_f32 v37, v37
    v_exp_f32 v38, v38
    v_exp_f32 v39, v39
    v_exp_f32 v40, v40
    v_exp_f32 v41, v41
    v_smfmac_f32_32x32x32_bf16 v[48:63], a[64:67], v[32:39], v1
    s_waitcnt vmcnt(27) lgkmcnt(0)
    s_lshl_b32 s34, s34, 12
    ds_write2st64_b64 v3, v[64:65], v[66:67] offset0:0 offset1:1
    v_exp_f32 v42, v42
    v_exp_f32 v43, v43
    v_exp_f32 v44, v44
    v_exp_f32 v45, v45
    v_smfmac_f32_16x16x64_bf16 v[80:83], v[112:115], a[224:231], v1 abid:1
    s_add_u32 s34, s34, s62
    global_load_dwordx4 v[244:247], v7, s[42:43] offset:-3072 sc1
    v_exp_f32 v46, v46
    v_exp_f32 v47, v47
    v_exp_f32 v16, v16
    v_exp_f32 v17, v17
    v_smfmac_f32_32x32x32_bf16 v[48:63], a[68:71], v[40:47], v1
    s_add_u32 s96, s34, 14680064
    s_mov_b32 s97, s48
    ds_write2st64_b64 v3, v[68:69], v[70:71] offset0:2 offset1:3
    v_exp_f32 v18, v18
    v_exp_f32 v19, v19
    v_exp_f32 v20, v20
    v_mfma_f32_32x32x16_bf16 v[32:47], a[84:87], a[200:203], 0
    s_lshr_b32 s33, s32, 3
    ds_write_b32 v3, v72 offset:2048
    v_exp_f32 v21, v21
    v_exp_f32 v22, v22
    v_exp_f32 v23, v23
    v_exp_f32 v24, v24
    v_exp_f32 v25, v25
    v_smfmac_f32_32x32x32_bf16 v[48:63], a[76:79], v[16:23], v1
    s_waitcnt vmcnt(26)
    s_lshr_b32 s98, s3, 1
    global_load_dwordx4 v[176:179], v7, s[42:43] offset:-2048 sc1
    v_exp_f32 v26, v26
    v_exp_f32 v27, v27
    v_exp_f32 v28, v28
    v_exp_f32 v29, v29
    v_smfmac_f32_16x16x64_bf16 v[84:87], v[112:115], a[232:239], v1 abid:1
    s_lshl2_add_u32 s33, s33, s3
    global_load_dwordx4 v[180:183], v7, s[42:43] offset:-1024 sc1
    v_exp_f32 v30, v30
    v_exp_f32 v31, v31
    v_exp_f32 v32, v32
    v_exp_f32 v33, v33
    v_smfmac_f32_32x32x32_bf16 v[48:63], a[80:83], v[24:31], v1
    s_waitcnt lgkmcnt(0)
    s_barrier
    ds_read2st64_b32 v[124:125], v2 offset0:8 offset1:24
    ds_read2st64_b32 v[126:127], v2 offset0:40 offset1:56
    v_exp_f32 v34, v34
    v_exp_f32 v35, v35
    v_exp_f32 v36, v36
    v_mfma_f32_32x32x16_bf16 v[16:31], a[96:99], a[200:203], 0
    s_lshl_b32 s33, s33, 7
    ds_read2st64_b64 v[116:119], v4 offset0:0 offset1:8
    v_exp_f32 v37, v37
    v_exp_f32 v38, v38
    v_exp_f32 v39, v39
    v_exp_f32 v40, v40
    v_exp_f32 v41, v41
    v_smfmac_f32_32x32x32_bf16 v[48:63], a[88:91], v[32:39], v1
    s_waitcnt vmcnt(26)
    s_add_u32 s33, s33, s35
    ds_read2st64_b64 v[120:123], v4 offset0:16 offset1:24
    v_exp_f32 v42, v42
    v_exp_f32 v43, v43
    v_exp_f32 v44, v44
    v_exp_f32 v45, v45
    v_smfmac_f32_16x16x64_bf16 v[88:91], v[112:115], a[240:247], v1 abid:1
    s_lshl_b32 s99, s33, 7
    global_load_dwordx4 v[184:187], v7, s[42:43] offset:0 sc1
    v_exp_f32 v46, v46
    v_exp_f32 v47, v47
    v_exp_f32 v16, v16
    v_exp_f32 v17, v17
    v_smfmac_f32_32x32x32_bf16 v[48:63], a[92:95], v[40:47], v1
    s_lshl_b32 s100, s35, 8
    s_add_u32 s100, s100, 10240
    global_load_dwordx4 v[188:191], v7, s[42:43] offset:1024 sc1
    v_exp_f32 v18, v18
    v_exp_f32 v19, v19
    v_exp_f32 v20, v20
    v_mfma_f32_32x32x16_bf16 v[32:47], a[108:111], a[200:203], 0
    s_mul_i32 s98, s98, 113664
    global_load_dwordx4 v[192:195], v7, s[42:43] offset:2048 sc1
    v_exp_f32 v21, v21
    v_exp_f32 v22, v22
    v_exp_f32 v23, v23
    v_exp_f32 v24, v24
    v_exp_f32 v25, v25
    v_smfmac_f32_32x32x32_bf16 v[48:63], a[100:103], v[16:23], v1
    s_waitcnt vmcnt(26) lgkmcnt(0)
    s_lshl_b32 s33, s3, 9
    global_load_dwordx4 v[196:199], v7, s[42:43] offset:3072 sc1
    v_exp_f32 v26, v26
    v_exp_f32 v27, v27
    v_exp_f32 v28, v28
    v_exp_f32 v29, v29
    v_smfmac_f32_16x16x64_bf16 v[92:95], v[112:115], a[248:255], v1 abid:1
    s_xor_b32 s42, s19, 32768
    v_exp_f32 v30, v30
    v_exp_f32 v31, v31
    v_add_f32 v124, v124, v125
    v_add_f32 v126, v126, v127
    v_add_f32 v116, v116, v118
    v_add_f32 v124, v124, v126
    v_add_f32 v117, v117, v119
    v_rcp_f32 v125, v124
    v_add_f32 v120, v120, v122
    v_add_f32 v121, v121, v123
    v_add_f32 v116, v116, v120
    v_add_f32 v117, v117, v121
    v_mul_f32 v116, v116, v125
    v_mul_f32 v117, v117, v125
    v_cvt_pk_bf16_f32 v118, v116, v117
    v_add_f32 v124, v124, v125
    v_cmp_ngt_f32 vcc, 0x5f800000, v124
    v_exp_f32 v32, v32
    v_exp_f32 v33, v33
    v_smfmac_f32_32x32x32_bf16 v[48:63], a[104:107], v[24:31], v1
    s_add_u32 s98, s98, s33
    s_or_b64 s[6:7], s[6:7], vcc
    ds_write_b32 v5, v118
    v_exp_f32 v34, v34
    v_exp_f32 v35, v35
    v_exp_f32 v36, v36
    v_mfma_f32_32x32x16_bf16 v[16:31], a[120:123], a[200:203], 0
    s_add_u32 s101, s67, 163840
    global_load_dwordx4 a[192:195], v7, s[42:43] offset:-4096 sc1
    v_exp_f32 v37, v37
    v_exp_f32 v38, v38
    v_exp_f32 v39, v39
    v_exp_f32 v40, v40
    v_exp_f32 v41, v41
    v_smfmac_f32_32x32x32_bf16 v[48:63], a[112:115], v[32:39], v1
    s_waitcnt vmcnt(26)
    s_mov_b64 s[30:31], -1
    global_load_dwordx4 a[196:199], v7, s[42:43] offset:-3072 sc1
    v_exp_f32 v42, v42
    v_exp_f32 v43, v43
    v_exp_f32 v44, v44
    v_exp_f32 v45, v45
    v_smfmac_f32_16x16x64_bf16 v[96:99], v[112:115], v[152:159], v1 abid:1
    global_load_dwordx4 a[224:227], v7, s[42:43] offset:-2048 sc1
    v_exp_f32 v46, v46
    v_exp_f32 v47, v47
    v_exp_f32 v16, v16
    v_exp_f32 v17, v17
    v_smfmac_f32_32x32x32_bf16 v[48:63], a[116:119], v[40:47], v1
    global_load_dwordx4 a[228:231], v7, s[42:43] offset:-1024 sc1
    v_exp_f32 v18, v18
    v_exp_f32 v19, v19
    v_exp_f32 v20, v20
    v_mfma_f32_32x32x16_bf16 v[32:47], a[132:135], a[200:203], 0
    global_load_dwordx4 a[232:235], v7, s[42:43] offset:0 sc1
    v_exp_f32 v21, v21
    v_exp_f32 v22, v22
    v_exp_f32 v23, v23
    v_exp_f32 v24, v24
    v_exp_f32 v25, v25
    v_smfmac_f32_32x32x32_bf16 v[48:63], a[124:127], v[16:23], v1
    s_waitcnt vmcnt(28)
    global_load_dwordx4 a[236:239], v7, s[42:43] offset:1024 sc1
    v_exp_f32 v26, v26
    v_exp_f32 v27, v27
    v_exp_f32 v28, v28
    v_exp_f32 v29, v29
    v_smfmac_f32_16x16x64_bf16 v[100:103], v[112:115], v[160:167], v1 abid:1
    v_exp_f32 v30, v30
    v_exp_f32 v31, v31
    v_exp_f32 v32, v32
    v_exp_f32 v33, v33
    v_smfmac_f32_32x32x32_bf16 v[48:63], a[128:131], v[24:31], v1
    global_load_dwordx4 a[240:243], v7, s[42:43] offset:2048 sc1
    v_exp_f32 v34, v34
    v_exp_f32 v35, v35
    v_exp_f32 v36, v36
    v_mfma_f32_32x32x16_bf16 v[16:31], a[144:147], a[200:203], 0
    global_load_dwordx4 a[244:247], v7, s[42:43] offset:3072 sc1
    v_exp_f32 v37, v37
    v_exp_f32 v38, v38
    v_exp_f32 v39, v39
    v_exp_f32 v40, v40
    v_exp_f32 v41, v41
    v_smfmac_f32_32x32x32_bf16 v[48:63], a[136:139], v[32:39], v1
    s_waitcnt vmcnt(29)
    s_xor_b32 s42, s19, 40960
    global_load_dwordx4 a[248:251], v7, s[42:43] offset:-4096 sc1
    v_exp_f32 v42, v42
    v_exp_f32 v43, v43
    v_exp_f32 v44, v44
    v_exp_f32 v45, v45
    v_smfmac_f32_16x16x64_bf16 v[104:107], v[112:115], v[168:175], v1 abid:1
    v_exp_f32 v46, v46
    v_exp_f32 v47, v47
    v_xor_b32 v0, 6144, v0
    v_exp_f32 v16, v16
    v_exp_f32 v17, v17
    v_smfmac_f32_32x32x32_bf16 v[48:63], a[140:143], v[40:47], v1
    global_load_dwordx4 a[208:211], v0, s[62:63] offset:0 sc1
    v_exp_f32 v18, v18
    v_exp_f32 v19, v19
    v_exp_f32 v20, v20
    v_mfma_f32_32x32x16_bf16 v[32:47], a[156:159], a[200:203], 0
    global_load_dwordx4 a[252:255], v7, s[42:43] offset:-3072 sc1
    v_exp_f32 v21, v21
    v_exp_f32 v22, v22
    v_exp_f32 v23, v23
    v_exp_f32 v24, v24
    v_exp_f32 v25, v25
    v_smfmac_f32_32x32x32_bf16 v[48:63], a[148:151], v[16:23], v1
    s_waitcnt vmcnt(30)
    global_load_dwordx4 a[212:215], v0, s[62:63] offset:1024 sc1
    v_exp_f32 v26, v26
    v_exp_f32 v27, v27
    v_exp_f32 v28, v28
    v_exp_f32 v29, v29
    v_smfmac_f32_16x16x64_bf16 v[108:111], v[112:115], v[200:207], v1 abid:1
    v_exp_f32 v30, v30
    v_exp_f32 v31, v31
    v_exp_f32 v32, v32
    v_exp_f32 v33, v33
    v_smfmac_f32_32x32x32_bf16 v[48:63], a[152:155], v[24:31], v1
    s_waitcnt lgkmcnt(0)
    s_barrier
    ds_read_b128 v[112:115], v6
    v_exp_f32 v34, v34
    v_exp_f32 v35, v35
    v_exp_f32 v36, v36
    v_mfma_f32_32x32x16_bf16 v[16:31], a[168:171], a[200:203], 0
    v_exp_f32 v37, v37
    v_exp_f32 v38, v38
    v_exp_f32 v39, v39
    v_exp_f32 v40, v40
    v_exp_f32 v41, v41
    v_smfmac_f32_32x32x32_bf16 v[48:63], a[160:163], v[32:39], v1
    s_mov_b64 exec, s[54:55]
    buffer_load_dwordx4 v[116:119], v7, s[20:23], s18 offen offset:1024 sc1
    s_mov_b64 exec, -1
    v_exp_f32 v42, v42
    v_exp_f32 v43, v43
    v_exp_f32 v44, v44
    v_exp_f32 v45, v45
    v_mfma_f32_32x32x8_f16 v[64:79], v[14:15], v[14:15], 0
    v_exp_f32 v46, v46
    v_exp_f32 v47, v47
    v_exp_f32 v16, v16
    v_exp_f32 v17, v17
    v_smfmac_f32_32x32x32_bf16 v[48:63], a[164:167], v[40:47], v1
    global_load_dwordx4 v[136:139], v135, s[56:57] offset:-3072
    v_exp_f32 v18, v18
    v_exp_f32 v19, v19
    v_exp_f32 v20, v20
    v_mfma_f32_32x32x16_bf16 v[32:47], a[180:183], a[200:203], 0
    global_load_dwordx4 v[140:143], v135, s[56:57] offset:3072
    v_exp_f32 v21, v21
    v_exp_f32 v22, v22
    v_exp_f32 v23, v23
    v_exp_f32 v24, v24
    v_exp_f32 v25, v25
    v_smfmac_f32_32x32x32_bf16 v[48:63], a[172:175], v[16:23], v1
    s_waitcnt vmcnt(29) lgkmcnt(0)
    v_exp_f32 v26, v26
    v_exp_f32 v27, v27
    v_exp_f32 v28, v28
    v_exp_f32 v29, v29
    v_smfmac_f32_16x16x64_bf16 v[80:83], v[112:115], v[208:215], v1 abid:1
    v_exp_f32 v30, v30
    v_exp_f32 v31, v31
    v_exp_f32 v32, v32
    v_exp_f32 v33, v33
    v_smfmac_f32_32x32x32_bf16 v[48:63], a[176:179], v[24:31], v1
    s_waitcnt vmcnt(33)
    global_store_dwordx4 v131, v[10:13], s[62:63] offset:256 sc1
    v_exp_f32 v34, v34
    v_exp_f32 v35, v35
    v_exp_f32 v36, v36
    v_mfma_f32_32x32x16_bf16 v[16:31], a[0:3], a[204:207], 0
    s_add_u32 s52, s48, 0
    v_exp_f32 v37, v37
    v_exp_f32 v38, v38
    v_exp_f32 v39, v39
    v_exp_f32 v40, v40
    v_exp_f32 v41, v41
    v_smfmac_f32_32x32x32_bf16 v[48:63], a[184:187], v[32:39], v1
    s_waitcnt vmcnt(28)
    v_exp_f32 v42, v42
    v_exp_f32 v43, v43
    v_exp_f32 v44, v44
    v_exp_f32 v45, v45
    v_smfmac_f32_16x16x64_bf16 v[84:87], v[112:115], v[216:223], v1 abid:1
    v_exp_f32 v46, v46
    v_exp_f32 v47, v47
    v_exp_f32 v16, v16
    v_exp_f32 v17, v17
    v_smfmac_f32_32x32x32_bf16 v[48:63], a[188:191], v[40:47], v1
    v_exp_f32 v18, v18
    v_exp_f32 v19, v19
    v_exp_f32 v20, v20
    v_mfma_f32_32x32x16_bf16 v[32:47], a[12:15], a[204:207], 0
    v_exp_f32 v21, v21
    v_exp_f32 v22, v22
    v_exp_f32 v23, v23
    v_exp_f32 v24, v24
    v_exp_f32 v25, v25
    v_smfmac_f32_32x32x32_bf16 v[64:79], a[4:7], v[16:23], v1
    s_waitcnt vmcnt(26)
    s_nop 0
    ds_write2st64_b64 v3, v[48:49], v[50:51] offset0:0 offset1:1
    v_exp_f32 v26, v26
    v_exp_f32 v27, v27
    v_exp_f32 v28, v28
    v_exp_f32 v29, v29
    v_smfmac_f32_16x16x64_bf16 v[88:91], v[112:115], v[224:231], v1 abid:1
    v_exp_f32 v30, v30
    v_exp_f32 v31, v31
    v_exp_f32 v32, v32
    v_exp_f32 v33, v33
    v_smfmac_f32_32x32x32_bf16 v[64:79], a[8:11], v[24:31], v1
    ds_write2st64_b64 v3, v[52:53], v[54:55] offset0:2 offset1:3
    v_exp_f32 v34, v34
    v_exp_f32 v35, v35
    v_exp_f32 v36, v36
    v_mfma_f32_32x32x16_bf16 v[16:31], a[24:27], a[204:207], 0
    ds_write_b32 v3, v56 offset:2048
    v_exp_f32 v37, v37
    v_exp_f32 v38, v38
    v_exp_f32 v39, v39
    v_exp_f32 v40, v40
    v_exp_f32 v41, v41
    v_smfmac_f32_32x32x32_bf16 v[64:79], a[16:19], v[32:39], v1
L_w4:
    s_cbranch_execz L_w5
    s_waitcnt vmcnt(3)
    v_exp_f32 v42, v42
    v_exp_f32 v43, v43
    v_exp_f32 v44, v44
    v_exp_f32 v45, v45
    v_smfmac_f32_16x16x64_bf16 v[92:95], v[112:115], v[232:239], v1 abid:1
    v_exp_f32 v46, v46
    v_exp_f32 v47, v47
    v_add3_u32 v116, v116, v117, v118
    v_add_u32 v116, v116, v119
    v_cmp_ne_u32 vcc, s4, v116
    s_nop 0
    s_and_b64 vcc, vcc, s[54:55]
    s_cbranch_vccnz L_f1_r
L_f1_ok:
    v_exp_f32 v16, v16
    v_exp_f32 v17, v17
    v_smfmac_f32_32x32x32_bf16 v[64:79], a[20:23], v[40:47], v1
    s_waitcnt lgkmcnt(0)
    s_barrier
    ds_read2st64_b32 v[124:125], v2 offset0:8 offset1:24
    ds_read2st64_b32 v[126:127], v2 offset0:40 offset1:56
    v_exp_f32 v18, v18
    v_exp_f32 v19, v19
    v_exp_f32 v20, v20
    v_mfma_f32_32x32x16_bf16 v[32:47], a[36:39], a[204:207], 0
    s_xor_b32 s13, s65, 0
    ds_read2st64_b64 v[116:119], v4 offset0:0 offset1:8
    v_exp_f32 v21, v21
    v_exp_f32 v22, v22
    v_exp_f32 v23, v23
    v_exp_f32 v24, v24
    v_exp_f32 v25, v25
    v_smfmac_f32_32x32x32_bf16 v[64:79], a[28:31], v[16:23], v1
    s_waitcnt vmcnt(22)
    s_add_u32 m0, s13, 32768
    ds_read2st64_b64 v[120:123], v4 offset0:16 offset1:24
    v_exp_f32 v26, v26
    v_exp_f32 v27, v27
    v_exp_f32 v28, v28
    v_exp_f32 v29, v29
    v_smfmac_f32_16x16x64_bf16 v[96:99], v[112:115], v[240:247], v1 abid:1
    s_xor_b32 s13, s66, 0
    global_store_dwordx4 v7, v[10:13], s[52:53] sc1
    v_exp_f32 v30, v30
    v_exp_f32 v31, v31
    v_exp_f32 v32, v32
    v_exp_f32 v33, v33
    v_smfmac_f32_32x32x32_bf16 v[64:79], a[32:35], v[24:31], v1
    s_add_u32 s44, s13, s67
    s_add_u32 s46, s68, 0
    v_exp_f32 v34, v34
    v_exp_f32 v35, v35
    v_exp_f32 v36, v36
    v_mfma_f32_32x32x16_bf16 v[16:31], a[48:51], a[204:207], 0
    v_exp_f32 v37, v37
    v_exp_f32 v38, v38
    v_exp_f32 v39, v39
    v_exp_f32 v40, v40
    v_exp_f32 v41, v41
    v_smfmac_f32_32x32x32_bf16 v[64:79], a[40:43], v[32:39], v1
    s_waitcnt vmcnt(21) lgkmcnt(0)
    v_exp_f32 v42, v42
    v_exp_f32 v43, v43
    v_exp_f32 v44, v44
    v_exp_f32 v45, v45
    v_smfmac_f32_16x16x64_bf16 v[100:103], v[112:115], v[176:183], v1 abid:1
    v_exp_f32 v46, v46
    v_exp_f32 v47, v47
    v_add_f32 v124, v124, v125
    v_add_f32 v126, v126, v127
    v_add_f32 v116, v116, v118
    v_add_f32 v124, v124, v126
    v_add_f32 v117, v117, v119
    v_rcp_f32 v125, v124
    v_add_f32 v120, v120, v122
    v_add_f32 v121, v121, v123
    v_add_f32 v116, v116, v120
    v_add_f32 v117, v117, v121
    v_mul_f32 v116, v116, v125
    v_mul_f32 v117, v117, v125
    v_cvt_pk_bf16_f32 v118, v116, v117
    v_add_f32 v124, v124, v125
    v_cmp_ngt_f32 vcc, 0x5f800000, v124
    v_exp_f32 v16, v16
    v_exp_f32 v17, v17
    v_smfmac_f32_32x32x32_bf16 v[64:79], a[44:47], v[40:47], v1
    s_or_b64 s[6:7], s[6:7], vcc
    ds_write_b32 v5, v118
    v_exp_f32 v18, v18
    v_exp_f32 v19, v19
    v_exp_f32 v20, v20
    v_mfma_f32_32x32x16_bf16 v[32:47], a[60:63], a[204:207], 0
    v_exp_f32 v21, v21
    v_exp_f32 v22, v22
    v_exp_f32 v23, v23
    v_exp_f32 v24, v24
    v_exp_f32 v25, v25
    v_smfmac_f32_32x32x32_bf16 v[64:79], a[52:55], v[16:23], v1
    s_waitcnt vmcnt(19)
    v_exp_f32 v26, v26
    v_exp_f32 v27, v27
    v_exp_f32 v28, v28
    v_exp_f32 v29, v29
    v_smfmac_f32_16x16x64_bf16 v[104:107], v[112:115], v[184:191], v1 abid:1
    v_exp_f32 v30, v30
    v_exp_f32 v31, v31
    v_exp_f32 v32, v32
    v_exp_f32 v33, v33
    v_smfmac_f32_32x32x32_bf16 v[64:79], a[56:59], v[24:31], v1
    global_load_lds_dwordx4 v7, s[44:45] offset:0 sc1
    v_exp_f32 v34, v34
    v_exp_f32 v35, v35
    v_exp_f32 v36, v36
    v_mfma_f32_32x32x16_bf16 v[16:31], a[72:75], a[204:207], 0
    global_load_dwordx4 v[152:155], v7, s[46:47] offset:0 sc1
    v_exp_f32 v37, v37
    v_exp_f32 v38, v38
    v_exp_f32 v39, v39
    v_exp_f32 v40, v40
    v_exp_f32 v41, v41
    v_smfmac_f32_32x32x32_bf16 v[64:79], a[64:67], v[32:39], v1
    s_waitcnt vmcnt(19)
    v_exp_f32 v42, v42
    v_exp_f32 v43, v43
    v_exp_f32 v44, v44
    v_exp_f32 v45, v45
    v_smfmac_f32_16x16x64_bf16 v[108:111], v[112:115], v[192:199], v1 abid:1
    v_exp_f32 v46, v46
    v_exp_f32 v47, v47
    v_exp_f32 v16, v16
    v_exp_f32 v17, v17
    v_smfmac_f32_32x32x32_bf16 v[64:79], a[68:71], v[40:47], v1
    s_waitcnt lgkmcnt(0)
    s_barrier
    ds_read_b128 v[112:115], v6
    v_exp_f32 v18, v18
    v_exp_f32 v19, v19
    v_exp_f32 v20, v20
    v_mfma_f32_32x32x16_bf16 v[32:47], a[84:87], a[204:207], 0
    global_load_lds_dwordx4 v7, s[44:45] offset:1024 sc1
    v_exp_f32 v21, v21
    v_exp_f32 v22, v22
    v_exp_f32 v23, v23
    v_exp_f32 v24, v24
    v_exp_f32 v25, v25
    v_smfmac_f32_32x32x32_bf16 v[64:79], a[76:79], v[16:23], v1
    v_exp_f32 v26, v26
    v_exp_f32 v27, v27
    v_exp_f32 v28, v28
    v_exp_f32 v29, v29
    v_mfma_f32_32x32x8_f16 v[48:63], v[14:15], v[14:15], 0
    v_exp_f32 v30, v30
    v_exp_f32 v31, v31
    v_exp_f32 v32, v32
    v_exp_f32 v33, v33
    v_smfmac_f32_32x32x32_bf16 v[64:79], a[80:83], v[24:31], v1
    global_load_dwordx4 v[156:159], v7, s[46:47] offset:1024 sc1
    v_exp_f32 v34, v34
    v_exp_f32 v35, v35
    v_exp_f32 v36, v36
    v_mfma_f32_32x32x16_bf16 v[16:31], a[96:99], a[204:207], 0
    s_add_u32 s46, s69, 0
    v_exp_f32 v37, v37
    v_exp_f32 v38, v38
    v_exp_f32 v39, v39
    v_exp_f32 v40, v40
    v_exp_f32 v41, v41
    v_smfmac_f32_32x32x32_bf16 v[64:79], a[88:91], v[32:39], v1
    s_waitcnt vmcnt(19) lgkmcnt(0)
    v_exp_f32 v42, v42
    v_exp_f32 v43, v43
    v_exp_f32 v44, v44
    v_exp_f32 v45, v45
    v_smfmac_f32_16x16x64_bf16 v[80:83], v[112:115], a[192:199], v1 abid:1
    v_exp_f32 v46, v46
    v_exp_f32 v47, v47
    v_exp_f32 v16, v16
    v_exp_f32 v17, v17
    v_smfmac_f32_32x32x32_bf16 v[64:79], a[92:95], v[40:47], v1
    global_load_dwordx4 a[192:195], v7, s[42:43] offset:-2048 sc1
    v_exp_f32 v18, v18
    v_exp_f32 v19, v19
    v_exp_f32 v20, v20
    v_mfma_f32_32x32x16_bf16 v[32:47], a[108:111], a[204:207], 0
    global_load_dwordx4 a[196:199], v7, s[42:43] offset:-1024 sc1
    v_exp_f32 v21, v21
    v_exp_f32 v22, v22
    v_exp_f32 v23, v23
    v_exp_f32 v24, v24
    v_exp_f32 v25, v25
    v_smfmac_f32_32x32x32_bf16 v[64:79], a[100:103], v[16:23], v1
    s_waitcnt vmcnt(8)
    global_load_lds_dwordx4 v7, s[44:45] offset:2048 sc1
    v_exp_f32 v26, v26
    v_exp_f32 v27, v27
    v_exp_f32 v28, v28
    v_exp_f32 v29, v29
    v_smfmac_f32_16x16x64_bf16 v[84:87], v[112:115], a[224:231], v1 abid:1
    v_exp_f32 v30, v30
    v_exp_f32 v31, v31
    v_perm_b32 v144, v140, v136, s16
    v_perm_b32 v145, v140, v136, s17
    v_perm_b32 v146, v141, v137, s16
    v_perm_b32 v147, v141, v137, s17
    v_perm_b32 v148, v142, v138, s16
    v_perm_b32 v149, v142, v138, s17
    v_perm_b32 v150, v143, v139, s16
    v_perm_b32 v151, v143, v139, s17
    v_exp_f32 v32, v32
    v_exp_f32 v33, v33
    v_smfmac_f32_32x32x32_bf16 v[64:79], a[104:107], v[24:31], v1
    global_load_dwordx4 a[224:227], v7, s[42:43] offset:0 sc1
    v_exp_f32 v34, v34
    v_exp_f32 v35, v35
    v_exp_f32 v36, v36
    v_mfma_f32_32x32x16_bf16 v[16:31], a[120:123], a[204:207], 0
    global_load_dwordx4 a[228:231], v7, s[42:43] offset:1024 sc1
    v_exp_f32 v37, v37
    v_exp_f32 v38, v38
    v_exp_f32 v39, v39
    v_exp_f32 v40, v40
    v_exp_f32 v41, v41
    v_smfmac_f32_32x32x32_bf16 v[64:79], a[112:115], v[32:39], v1
    global_load_dwordx4 v[160:163], v7, s[46:47] offset:0 sc1
    v_exp_f32 v42, v42
    v_exp_f32 v43, v43
    v_exp_f32 v44, v44
    v_exp_f32 v45, v45
    v_exp_f32 v46, v46
    v_exp_f32 v47, v47
    v_dot2_f32_bf16 v144, v144, v134, 0
    v_dot2_f32_bf16 v145, v145, v134, 0
    v_dot2_f32_bf16 v146, v146, v134, 0
    v_dot2_f32_bf16 v147, v147, v134, 0
    v_dot2_f32_bf16 v148, v148, v134, 0
    v_dot2_f32_bf16 v149, v149, v134, 0
    v_dot2_f32_bf16 v150, v150, v134, 0
    v_dot2_f32_bf16 v151, v151, v134, 0
    v_exp_f32 v16, v16
    v_exp_f32 v17, v17
    v_smfmac_f32_32x32x32_bf16 v[64:79], a[116:119], v[40:47], v1
    global_load_lds_dwordx4 v7, s[44:45] offset:3072 sc1
    v_exp_f32 v18, v18
    v_exp_f32 v19, v19
    v_exp_f32 v20, v20
    v_mfma_f32_32x32x16_bf16 v[32:47], a[132:135], a[204:207], 0
    s_xor_b32 s13, s65, 16384
    v_exp_f32 v21, v21
    v_exp_f32 v22, v22
    v_exp_f32 v23, v23
    v_exp_f32 v24, v24
    v_exp_f32 v25, v25
    v_smfmac_f32_32x32x32_bf16 v[64:79], a[124:127], v[16:23], v1
    s_waitcnt vmcnt(22)
    s_add_u32 m0, s13, 32768
    v_exp_f32 v26, v26
    v_exp_f32 v27, v27
    v_exp_f32 v28, v28
    v_exp_f32 v29, v29
    v_smfmac_f32_16x16x64_bf16 v[88:91], v[112:115], a[232:239], v1 abid:1
    s_xor_b32 s13, s66, 16384
    v_exp_f32 v30, v30
    v_exp_f32 v31, v31
    v_permlane32_swap_b32 v144, v148
    v_permlane32_swap_b32 v145, v149
    v_permlane32_swap_b32 v146, v150
    v_permlane32_swap_b32 v147, v151
    v_add_f32 v144, v144, v148
    v_add_f32 v145, v145, v149
    v_add_f32 v146, v146, v150
    v_add_f32 v147, v147, v151
    v_exp_f32 v32, v32
    v_exp_f32 v33, v33
    v_smfmac_f32_32x32x32_bf16 v[64:79], a[128:131], v[24:31], v1
    s_add_u32 s44, s13, s67
    global_load_dwordx4 a[232:235], v7, s[42:43] offset:2048 sc1
    v_exp_f32 v34, v34
    v_exp_f32 v35, v35
    v_exp_f32 v36, v36
    v_mfma_f32_32x32x16_bf16 v[16:31], a[144:147], a[204:207], 0
    global_load_dwordx4 a[236:239], v7, s[42:43] offset:3072 sc1
    v_exp_f32 v37, v37
    v_exp_f32 v38, v38
    v_exp_f32 v39, v39
    v_exp_f32 v40, v40
    v_exp_f32 v41, v41
    v_smfmac_f32_32x32x32_bf16 v[64:79], a[136:139], v[32:39], v1
    s_xor_b32 s42, s19, 49152
    global_load_dwordx4 v[164:167], v7, s[46:47] offset:1024 sc1
    v_exp_f32 v42, v42
    v_exp_f32 v43, v43
    v_exp_f32 v44, v44
    v_exp_f32 v45, v45
    v_exp_f32 v46, v46
    v_exp_f32 v47, v47
    v_permlane16_swap_b32 v144, v146
    v_permlane16_swap_b32 v145, v147
    v_add_f32 v144, v144, v146
    v_add_f32 v145, v145, v147
    v_add_u32 v136, 17408, v252
    v_exp_f32 v16, v16
    v_exp_f32 v17, v17
    v_smfmac_f32_32x32x32_bf16 v[64:79], a[140:143], v[40:47], v1
    s_add_u32 s46, s70, 0
    global_load_lds_dwordx4 v7, s[44:45] offset:0 sc1
    v_exp_f32 v18, v18
    v_exp_f32 v19, v19
    v_exp_f32 v20, v20
    v_mfma_f32_32x32x16_bf16 v[32:47], a[156:159], a[204:207], 0
    v_exp_f32 v21, v21
    v_exp_f32 v22, v22
    v_exp_f32 v23, v23
    v_exp_f32 v24, v24
    v_exp_f32 v25, v25
    v_smfmac_f32_32x32x32_bf16 v[64:79], a[148:151], v[16:23], v1
    s_waitcnt vmcnt(24)
    v_exp_f32 v26, v26
    v_exp_f32 v27, v27
    v_exp_f32 v28, v28
    v_exp_f32 v29, v29
    v_smfmac_f32_16x16x64_bf16 v[92:95], v[112:115], a[240:247], v1 abid:1
    v_exp_f32 v30, v30
    v_exp_f32 v31, v31
    v_add_f32_dpp v144, v144, v144 row_ror:1 row_mask:0xf bank_mask:0xf
    v_add_f32_dpp v145, v145, v145 row_ror:1 row_mask:0xf bank_mask:0xf
    v_exp_f32 v32, v32
    v_exp_f32 v33, v33
    v_smfmac_f32_32x32x32_bf16 v[64:79], a[152:155], v[24:31], v1
    global_load_dwordx4 a[240:243], v7, s[42:43] offset:-4096 sc1
    v_exp_f32 v34, v34
    v_exp_f32 v35, v35
    v_exp_f32 v36, v36
    v_mfma_f32_32x32x16_bf16 v[16:31], a[168:171], a[204:207], 0
    global_load_dwordx4 a[244:247], v7, s[42:43] offset:-3072 sc1
    v_exp_f32 v37, v37
    v_exp_f32 v38, v38
    v_exp_f32 v39, v39
    v_exp_f32 v40, v40
    v_exp_f32 v41, v41
    v_smfmac_f32_32x32x32_bf16 v[64:79], a[160:163], v[32:39], v1
    global_load_dwordx4 v[168:171], v7, s[46:47] offset:0 sc1
    v_exp_f32 v42, v42
    v_exp_f32 v43, v43
    v_exp_f32 v44, v44
    v_exp_f32 v45, v45
    v_exp_f32 v46, v46
    v_exp_f32 v47, v47
    v_add_f32_dpp v144, v144, v144 row_ror:2 row_mask:0xf bank_mask:0xf
    v_add_f32_dpp v145, v145, v145 row_ror:2 row_mask:0xf bank_mask:0xf
    v_exp_f32 v16, v16
    v_exp_f32 v17, v17
    v_smfmac_f32_32x32x32_bf16 v[64:79], a[164:167], v[40:47], v1
    global_load_lds_dwordx4 v7, s[44:45] offset:1024 sc1
    v_exp_f32 v18, v18
    v_exp_f32 v19, v19
    v_exp_f32 v20, v20
    v_mfma_f32_32x32x16_bf16 v[32:47], a[180:183], a[204:207], 0
    v_exp_f32 v21, v21
    v_exp_f32 v22, v22
    v_exp_f32 v23, v23
    v_exp_f32 v24, v24
    v_exp_f32 v25, v25
    v_smfmac_f32_32x32x32_bf16 v[64:79], a[172:175], v[16:23], v1
    s_waitcnt vmcnt(25)
    v_exp_f32 v26, v26
    v_exp_f32 v27, v27
    v_exp_f32 v28, v28
    v_exp_f32 v29, v29
    v_smfmac_f32_16x16x64_bf16 v[96:99], v[112:115], a[248:255], v1 abid:1
    v_exp_f32 v30, v30
    v_exp_f32 v31, v31
    v_add_f32_dpp v144, v144, v144 row_ror:4 row_mask:0xf bank_mask:0xf
    v_add_f32_dpp v145, v145, v145 row_ror:4 row_mask:0xf bank_mask:0xf
    v_exp_f32 v32, v32
    v_exp_f32 v33, v33
    v_smfmac_f32_32x32x32_bf16 v[64:79], a[176:179], v[24:31], v1
    s_waitcnt vmcnt(26)
    global_load_dwordx4 a[200:203], v7, s[42:43] offset:-2048 sc1
    v_exp_f32 v34, v34
    v_exp_f32 v35, v35
    v_exp_f32 v36, v36
    v_mfma_f32_32x32x16_bf16 v[16:31], a[0:3], a[208:211], 0
    global_load_dwordx4 a[204:207], v7, s[42:43] offset:-1024 sc1
    v_exp_f32 v37, v37
    v_exp_f32 v38, v38
    v_exp_f32 v39, v39
    v_exp_f32 v40, v40
    v_exp_f32 v41, v41
    v_smfmac_f32_32x32x32_bf16 v[64:79], a[184:187], v[32:39], v1
    global_load_dwordx4 a[248:251], v7, s[42:43] offset:0 sc1
    v_exp_f32 v42, v42
    v_exp_f32 v43, v43
    v_exp_f32 v44, v44
    v_exp_f32 v45, v45
    v_exp_f32 v46, v46
    v_exp_f32 v47, v47
    v_add_f32_dpp v144, v144, v144 row_ror:8 row_mask:0xf bank_mask:0xf
    v_add_f32_dpp v145, v145, v145 row_ror:8 row_mask:0xf bank_mask:0xf
    v_exp_f32 v16, v16
    v_exp_f32 v17, v17
    v_smfmac_f32_32x32x32_bf16 v[64:79], a[188:191], v[40:47], v1
    ds_write_b64 v251, v[144:145]
    v_exp_f32 v18, v18
    v_exp_f32 v19, v19
    v_exp_f32 v20, v20
    v_mfma_f32_32x32x16_bf16 v[32:47], a[12:15], a[208:211], 0
    global_load_dwordx4 a[252:255], v7, s[42:43] offset:1024 sc1
    v_exp_f32 v21, v21
    v_exp_f32 v22, v22
    v_exp_f32 v23, v23
    v_exp_f32 v24, v24
    v_exp_f32 v25, v25
    v_smfmac_f32_32x32x32_bf16 v[48:63], a[4:7], v[16:23], v1
    s_waitcnt vmcnt(17)
    ds_write2st64_b64 v3, v[64:65], v[66:67] offset0:0 offset1:1
    v_exp_f32 v26, v26
    v_exp_f32 v27, v27
    v_exp_f32 v28, v28
    v_exp_f32 v29, v29
    v_smfmac_f32_16x16x64_bf16 v[100:103], v[112:115], a[192:199], v1 abid:1
    global_load_lds_dwordx4 v7, s[44:45] offset:2048 sc1
    v_exp_f32 v30, v30
    v_exp_f32 v31, v31
    v_exp_f32 v32, v32
    v_exp_f32 v33, v33
    v_smfmac_f32_32x32x32_bf16 v[48:63], a[8:11], v[24:31], v1
    ds_write2st64_b64 v3, v[68:69], v[70:71] offset0:2 offset1:3
    v_exp_f32 v34, v34
    v_exp_f32 v35, v35
    v_exp_f32 v36, v36
    v_mfma_f32_32x32x16_bf16 v[16:31], a[24:27], a[208:211], 0
    ds_write_b32 v3, v72 offset:2048
    v_exp_f32 v37, v37
    v_exp_f32 v38, v38
    v_exp_f32 v39, v39
    v_exp_f32 v40, v40
    v_exp_f32 v41, v41
    v_smfmac_f32_32x32x32_bf16 v[48:63], a[16:19], v[32:39], v1
    global_load_dwordx4 a[192:195], v7, s[42:43] offset:2048 sc1
    v_exp_f32 v42, v42
    v_exp_f32 v43, v43
    v_exp_f32 v44, v44
    v_exp_f32 v45, v45
    v_exp_f32 v46, v46
    v_exp_f32 v47, v47
    v_exp_f32 v16, v16
    v_exp_f32 v17, v17
    v_smfmac_f32_32x32x32_bf16 v[48:63], a[20:23], v[40:47], v1
    s_waitcnt lgkmcnt(0)
    s_barrier
    ds_read2st64_b32 v[124:125], v2 offset0:8 offset1:24
    ds_read2st64_b32 v[126:127], v2 offset0:40 offset1:56
    v_exp_f32 v18, v18
    v_exp_f32 v19, v19
    v_exp_f32 v20, v20
    v_mfma_f32_32x32x16_bf16 v[32:47], a[36:39], a[208:211], 0
    ds_read2st64_b64 v[116:119], v4 offset0:0 offset1:8
    v_exp_f32 v21, v21
    v_exp_f32 v22, v22
    v_exp_f32 v23, v23
    v_exp_f32 v24, v24
    v_exp_f32 v25, v25
    v_smfmac_f32_32x32x32_bf16 v[48:63], a[28:31], v[16:23], v1
    s_waitcnt vmcnt(16)
    ds_read2st64_b64 v[120:123], v4 offset0:16 offset1:24
    v_exp_f32 v26, v26
    v_exp_f32 v27, v27
    v_exp_f32 v28, v28
    v_exp_f32 v29, v29
    v_smfmac_f32_16x16x64_bf16 v[104:107], v[112:115], a[224:231], v1 abid:1
    global_load_dwordx4 a[196:199], v7, s[42:43] offset:3072 sc1
    v_exp_f32 v30, v30
    v_exp_f32 v31, v31
    v_exp_f32 v32, v32
    v_exp_f32 v33, v33
    v_smfmac_f32_32x32x32_bf16 v[48:63], a[32:35], v[24:31], v1
    s_xor_b32 s42, s19, 57344
    global_load_dwordx4 a[224:227], v7, s[42:43] offset:-4096 sc1
    v_exp_f32 v34, v34
    v_exp_f32 v35, v35
    v_exp_f32 v36, v36
    v_mfma_f32_32x32x16_bf16 v[16:31], a[48:51], a[208:211], 0
    global_load_dwordx4 a[228:231], v7, s[42:43] offset:-3072 sc1
    v_exp_f32 v37, v37
    v_exp_f32 v38, v38
    v_exp_f32 v39, v39
    v_exp_f32 v40, v40
    v_exp_f32 v41, v41
    v_smfmac_f32_32x32x32_bf16 v[48:63], a[40:43], v[32:39], v1
    s_waitcnt lgkmcnt(0)
    global_load_lds_dwordx4 v7, s[44:45] offset:3072 sc1
    v_exp_f32 v42, v42
    v_exp_f32 v43, v43
    v_exp_f32 v44, v44
    v_exp_f32 v45, v45
    v_exp_f32 v46, v46
    v_exp_f32 v47, v47
    v_add_f32 v124, v124, v125
    v_add_f32 v126, v126, v127
    v_add_f32 v116, v116, v118
    v_add_f32 v124, v124, v126
    v_add_f32 v117, v117, v119
    v_rcp_f32 v125, v124
    v_add_f32 v120, v120, v122
    v_add_f32 v121, v121, v123
    v_add_f32 v116, v116, v120
    v_add_f32 v117, v117, v121
    v_mul_f32 v116, v116, v125
    v_mul_f32 v117, v117, v125
    v_cvt_pk_bf16_f32 v118, v116, v117
    v_add_f32 v124, v124, v125
    v_cmp_ngt_f32 vcc, 0x5f800000, v124
    v_exp_f32 v16, v16
    v_exp_f32 v17, v17
    v_smfmac_f32_32x32x32_bf16 v[48:63], a[44:47], v[40:47], v1
    s_xor_b32 s13, s65, 32768
    s_or_b64 s[6:7], s[6:7], vcc
    ds_write_b32 v5, v118
    v_exp_f32 v18, v18
    v_exp_f32 v19, v19
    v_exp_f32 v20, v20
    v_mfma_f32_32x32x16_bf16 v[32:47], a[60:63], a[208:211], 0
    s_add_u32 m0, s13, 32768
    ds_read2_b32 v[144:145], v136 offset0:0 offset1:8
    ds_read2_b32 v[146:147], v136 offset0:16 offset1:24
    v_exp_f32 v21, v21
    v_exp_f32 v22, v22
    v_exp_f32 v23, v23
    v_exp_f32 v24, v24
    v_exp_f32 v25, v25
    v_smfmac_f32_32x32x32_bf16 v[48:63], a[52:55], v[16:23], v1
    s_waitcnt vmcnt(16)
    s_xor_b32 s13, s66, 32768
    global_load_dwordx4 v[172:175], v7, s[46:47] offset:1024 sc1
    v_exp_f32 v26, v26
    v_exp_f32 v27, v27
    v_exp_f32 v28, v28
    v_exp_f32 v29, v29
    v_smfmac_f32_16x16x64_bf16 v[108:111], v[112:115], a[232:239], v1 abid:1
    s_add_u32 s44, s13, s67
    global_load_lds_dwordx4 v7, s[44:45] offset:0 sc1
    v_exp_f32 v30, v30
    v_exp_f32 v31, v31
    v_exp_f32 v32, v32
    v_exp_f32 v33, v33
    v_smfmac_f32_32x32x32_bf16 v[48:63], a[56:59], v[24:31], v1
    s_waitcnt lgkmcnt(0)
    s_barrier
    ds_read_b128 v[112:115], v6
    v_exp_f32 v34, v34
    v_exp_f32 v35, v35
    v_exp_f32 v36, v36
    v_mfma_f32_32x32x16_bf16 v[16:31], a[72:75], a[208:211], 0
    s_add_u32 s46, s71, 0
    global_load_dwordx4 a[232:235], v7, s[42:43] offset:-2048 sc1
    v_exp_f32 v37, v37
    v_exp_f32 v38, v38
    v_exp_f32 v39, v39
    v_exp_f32 v40, v40
    v_exp_f32 v41, v41
    v_smfmac_f32_32x32x32_bf16 v[48:63], a[64:67], v[32:39], v1
    global_load_dwordx4 a[236:239], v7, s[42:43] offset:-1024 sc1
    v_exp_f32 v42, v42
    v_exp_f32 v43, v43
    v_exp_f32 v44, v44
    v_exp_f32 v45, v45
    v_mfma_f32_32x32x8_f16 v[64:79], v[14:15], v[14:15], 0
    global_load_dwordx4 v[200:203], v7, s[46:47] offset:0 sc1
    v_exp_f32 v46, v46
    v_exp_f32 v47, v47
    v_add_f32 v144, v144, v145
    v_add_f32 v146, v146, v147
    v_add_f32 v144, v144, v146
    v_cvt_pk_bf16_f32 v144, v144, v144
    v_lshlrev_b32 v144, 16, v144
    v_add_f32 v144, s38, v144
    v_cvt_pk_bf16_f32 v144, v144, v144
    v_lshlrev_b32 v144, 16, v144
    v_mul_f32 v144, s28, v144
    v_exp_f32 v16, v16
    v_exp_f32 v17, v17
    v_smfmac_f32_32x32x32_bf16 v[48:63], a[68:71], v[40:47], v1
    s_mov_b64 exec, s[10:11]
    buffer_store_dword v144, v252, s[20:23], s39 offen sc1
    s_mov_b64 exec, -1
    v_exp_f32 v18, v18
    v_exp_f32 v19, v19
    v_exp_f32 v20, v20
    v_mfma_f32_32x32x16_bf16 v[32:47], a[84:87], a[208:211], 0
    global_load_lds_dwordx4 v7, s[44:45] offset:1024 sc1
    v_exp_f32 v21, v21
    v_exp_f32 v22, v22
    v_exp_f32 v23, v23
    v_exp_f32 v24, v24
    v_exp_f32 v25, v25
    v_smfmac_f32_32x32x32_bf16 v[48:63], a[76:79], v[16:23], v1
    s_waitcnt vmcnt(19) lgkmcnt(0)
    global_load_dwordx4 v[204:207], v7, s[46:47] offset:1024 sc1
    v_exp_f32 v26, v26
    v_exp_f32 v27, v27
    v_exp_f32 v28, v28
    v_exp_f32 v29, v29
    v_smfmac_f32_16x16x64_bf16 v[80:83], v[112:115], a[240:247], v1 abid:1
    s_add_u32 s46, s68, 8192
    global_load_dwordx4 v[208:211], v7, s[46:47] offset:0 sc1
    v_exp_f32 v30, v30
    v_exp_f32 v31, v31
    v_exp_f32 v32, v32
    v_exp_f32 v33, v33
    v_smfmac_f32_32x32x32_bf16 v[48:63], a[80:83], v[24:31], v1
    global_load_dwordx4 a[240:243], v7, s[42:43] offset:0 sc1
    v_exp_f32 v34, v34
    v_exp_f32 v35, v35
    v_exp_f32 v36, v36
    v_mfma_f32_32x32x16_bf16 v[16:31], a[96:99], a[208:211], 0
    global_load_dwordx4 a[244:247], v7, s[42:43] offset:1024 sc1
    v_exp_f32 v37, v37
    v_exp_f32 v38, v38
    v_exp_f32 v39, v39
    v_exp_f32 v40, v40
    v_exp_f32 v41, v41
    v_smfmac_f32_32x32x32_bf16 v[48:63], a[88:91], v[32:39], v1
    global_load_dwordx4 v[212:215], v7, s[46:47] offset:1024 sc1
    v_exp_f32 v42, v42
    v_exp_f32 v43, v43
    v_exp_f32 v44, v44
    v_exp_f32 v45, v45
    v_exp_f32 v46, v46
    v_exp_f32 v47, v47
    v_exp_f32 v16, v16
    v_exp_f32 v17, v17
    v_smfmac_f32_32x32x32_bf16 v[48:63], a[92:95], v[40:47], v1
    s_add_u32 s46, s69, 8192
    global_load_lds_dwordx4 v7, s[44:45] offset:2048 sc1
    v_exp_f32 v18, v18
    v_exp_f32 v19, v19
    v_exp_f32 v20, v20
    v_mfma_f32_32x32x16_bf16 v[32:47], a[108:111], a[208:211], 0
    v_exp_f32 v21, v21
    v_exp_f32 v22, v22
    v_exp_f32 v23, v23
    v_exp_f32 v24, v24
    v_exp_f32 v25, v25
    v_smfmac_f32_32x32x32_bf16 v[48:63], a[100:103], v[16:23], v1
    s_waitcnt vmcnt(21)
    v_exp_f32 v26, v26
    v_exp_f32 v27, v27
    v_exp_f32 v28, v28
    v_exp_f32 v29, v29
    v_smfmac_f32_16x16x64_bf16 v[84:87], v[112:115], a[200:207], v1 abid:1
    v_exp_f32 v30, v30
    v_exp_f32 v31, v31
    v_exp_f32 v32, v32
    v_exp_f32 v33, v33
    v_smfmac_f32_32x32x32_bf16 v[48:63], a[104:107], v[24:31], v1
    global_load_dwordx4 a[200:203], v7, s[42:43] offset:2048 sc1
    v_exp_f32 v34, v34
    v_exp_f32 v35, v35
    v_exp_f32 v36, v36
    v_mfma_f32_32x32x16_bf16 v[16:31], a[120:123], a[208:211], 0
    global_load_dwordx4 a[204:207], v7, s[42:43] offset:3072 sc1
    v_exp_f32 v37, v37
    v_exp_f32 v38, v38
    v_exp_f32 v39, v39
    v_exp_f32 v40, v40
    v_exp_f32 v41, v41
    v_smfmac_f32_32x32x32_bf16 v[48:63], a[112:115], v[32:39], v1
    s_xor_b32 s42, s19, 65536
    global_load_dwordx4 v[216:219], v7, s[46:47] offset:0 sc1
    v_exp_f32 v42, v42
    v_exp_f32 v43, v43
    v_exp_f32 v44, v44
    v_exp_f32 v45, v45
    v_exp_f32 v46, v46
    v_exp_f32 v47, v47
    v_exp_f32 v16, v16
    v_exp_f32 v17, v17
    v_smfmac_f32_32x32x32_bf16 v[48:63], a[116:119], v[40:47], v1
    global_load_lds_dwordx4 v7, s[44:45] offset:3072 sc1
    v_exp_f32 v18, v18
    v_exp_f32 v19, v19
    v_exp_f32 v20, v20
    v_mfma_f32_32x32x16_bf16 v[32:47], a[132:135], a[208:211], 0
    s_xor_b32 s13, s65, 49152
    v_exp_f32 v21, v21
    v_exp_f32 v22, v22
    v_exp_f32 v23, v23
    v_exp_f32 v24, v24
    v_exp_f32 v25, v25
    v_smfmac_f32_32x32x32_bf16 v[48:63], a[124:127], v[16:23], v1
    s_waitcnt vmcnt(23)
    s_add_u32 m0, s13, 32768
    v_exp_f32 v26, v26
    v_exp_f32 v27, v27
    v_exp_f32 v28, v28
    v_exp_f32 v29, v29
    v_smfmac_f32_16x16x64_bf16 v[88:91], v[112:115], a[248:255], v1 abid:1
    s_xor_b32 s13, s66, 49152
    v_exp_f32 v30, v30
    v_exp_f32 v31, v31
    v_exp_f32 v32, v32
    v_exp_f32 v33, v33
    v_smfmac_f32_32x32x32_bf16 v[48:63], a[128:131], v[24:31], v1
    s_add_u32 s52, s48, 4096
    s_add_u32 s44, s13, s67
    global_load_dwordx4 a[248:251], v7, s[42:43] offset:-4096 sc1
    v_exp_f32 v34, v34
    v_exp_f32 v35, v35
    v_exp_f32 v36, v36
    v_mfma_f32_32x32x16_bf16 v[16:31], a[144:147], a[208:211], 0
    global_load_dwordx4 a[252:255], v7, s[42:43] offset:-3072 sc1
    v_exp_f32 v37, v37
    v_exp_f32 v38, v38
    v_exp_f32 v39, v39
    v_exp_f32 v40, v40
    v_exp_f32 v41, v41
    v_smfmac_f32_32x32x32_bf16 v[48:63], a[136:139], v[32:39], v1
    global_load_dwordx4 v[220:223], v7, s[46:47] offset:1024 sc1
    v_exp_f32 v42, v42
    v_exp_f32 v43, v43
    v_exp_f32 v44, v44
    v_exp_f32 v45, v45
    v_exp_f32 v46, v46
    v_exp_f32 v47, v47
    v_xor_b32 v0, 2048, v0
    v_exp_f32 v16, v16
    v_exp_f32 v17, v17
    v_smfmac_f32_32x32x32_bf16 v[48:63], a[140:143], v[40:47], v1
    s_add_u32 s46, s70, 8192
    global_load_dwordx4 a[216:219], v0, s[62:63] offset:0 sc1
    v_exp_f32 v18, v18
    v_exp_f32 v19, v19
    v_exp_f32 v20, v20
    v_mfma_f32_32x32x16_bf16 v[32:47], a[156:159], a[208:211], 0
    global_load_dwordx4 a[220:223], v0, s[62:63] offset:1024 sc1
    v_exp_f32 v21, v21
    v_exp_f32 v22, v22
    v_exp_f32 v23, v23
    v_exp_f32 v24, v24
    v_exp_f32 v25, v25
    v_smfmac_f32_32x32x32_bf16 v[48:63], a[148:151], v[16:23], v1
    s_waitcnt vmcnt(25)
    global_load_lds_dwordx4 v7, s[44:45] offset:0 sc1
    v_exp_f32 v26, v26
    v_exp_f32 v27, v27
    v_exp_f32 v28, v28
    v_exp_f32 v29, v29
    v_smfmac_f32_16x16x64_bf16 v[92:95], v[112:115], a[192:199], v1 abid:1
    v_exp_f32 v30, v30
    v_exp_f32 v31, v31
    v_exp_f32 v32, v32
    v_exp_f32 v33, v33
    v_smfmac_f32_32x32x32_bf16 v[48:63], a[152:155], v[24:31], v1
    global_load_dwordx4 a[192:195], v7, s[42:43] offset:-2048 sc1
    v_exp_f32 v34, v34
    v_exp_f32 v35, v35
    v_exp_f32 v36, v36
    v_mfma_f32_32x32x16_bf16 v[16:31], a[168:171], a[208:211], 0
    global_load_dwordx4 a[196:199], v7, s[42:43] offset:-1024 sc1
    v_exp_f32 v37, v37
    v_exp_f32 v38, v38
    v_exp_f32 v39, v39
    v_exp_f32 v40, v40
    v_exp_f32 v41, v41
    v_smfmac_f32_32x32x32_bf16 v[48:63], a[160:163], v[32:39], v1
    global_load_dwordx4 v[224:227], v7, s[46:47] offset:0 sc1
    v_exp_f32 v42, v42
    v_exp_f32 v43, v43
    v_exp_f32 v44, v44
    v_exp_f32 v45, v45
    v_exp_f32 v46, v46
    v_exp_f32 v47, v47
    v_exp_f32 v16, v16
    v_exp_f32 v17, v17
    v_smfmac_f32_32x32x32_bf16 v[48:63], a[164:167], v[40:47], v1
    global_store_dwordx4 v7, v[10:13], s[52:53] sc1
    v_exp_f32 v18, v18
    v_exp_f32 v19, v19
    v_exp_f32 v20, v20
    v_mfma_f32_32x32x16_bf16 v[32:47], a[180:183], a[208:211], 0
    global_load_lds_dwordx4 v7, s[44:45] offset:1024 sc1
    v_exp_f32 v21, v21
    v_exp_f32 v22, v22
    v_exp_f32 v23, v23
    v_exp_f32 v24, v24
    v_exp_f32 v25, v25
    v_smfmac_f32_32x32x32_bf16 v[48:63], a[172:175], v[16:23], v1
    s_waitcnt vmcnt(29)
    v_exp_f32 v26, v26
    v_exp_f32 v27, v27
L_w5:
    s_cbranch_execz L_wb_B3
    v_exp_f32 v28, v28
    v_exp_f32 v29, v29
    v_smfmac_f32_16x16x64_bf16 v[96:99], v[112:115], a[224:231], v1 abid:1
    v_exp_f32 v30, v30
    v_exp_f32 v31, v31
    v_exp_f32 v32, v32
    v_exp_f32 v33, v33
    v_smfmac_f32_32x32x32_bf16 v[48:63], a[176:179], v[24:31], v1
    s_waitcnt vmcnt(62)
    global_load_dwordx4 a[224:227], v7, s[42:43] offset:0 sc1
    v_exp_f32 v34, v34
    v_exp_f32 v35, v35
    v_exp_f32 v36, v36
    v_mfma_f32_32x32x16_bf16 v[16:31], a[0:3], a[212:215], 0
    global_load_dwordx4 a[228:231], v7, s[42:43] offset:1024 sc1
    v_exp_f32 v37, v37
    v_exp_f32 v38, v38
    v_exp_f32 v39, v39
    v_exp_f32 v40, v40
    v_exp_f32 v41, v41
    v_smfmac_f32_32x32x32_bf16 v[48:63], a[184:187], v[32:39], v1
    global_load_dwordx4 v[228:231], v7, s[46:47] offset:1024 sc1
    v_exp_f32 v42, v42
    v_exp_f32 v43, v43
    v_exp_f32 v44, v44
    v_exp_f32 v45, v45
    v_exp_f32 v46, v46
    v_exp_f32 v47, v47
    v_exp_f32 v16, v16
    v_exp_f32 v17, v17
    v_smfmac_f32_32x32x32_bf16 v[48:63], a[188:191], v[40:47], v1
    s_add_u32 s46, s71, 8192
    global_load_lds_dwordx4 v7, s[44:45] offset:2048 sc1
    v_exp_f32 v18, v18
    v_exp_f32 v19, v19
    v_exp_f32 v20, v20
    v_mfma_f32_32x32x16_bf16 v[32:47], a[12:15], a[212:215], 0
    v_exp_f32 v21, v21
    v_exp_f32 v22, v22
    v_exp_f32 v23, v23
    v_exp_f32 v24, v24
    v_exp_f32 v25, v25
    v_smfmac_f32_32x32x32_bf16 v[64:79], a[4:7], v[16:23], v1
    s_waitcnt vmcnt(28)
    ds_write2st64_b64 v3, v[48:49], v[50:51] offset0:0 offset1:1
    v_exp_f32 v26, v26
    v_exp_f32 v27, v27
    v_exp_f32 v28, v28
    v_exp_f32 v29, v29
    v_smfmac_f32_16x16x64_bf16 v[100:103], v[112:115], a[232:239], v1 abid:1
    v_exp_f32 v30, v30
    v_exp_f32 v31, v31
    v_exp_f32 v32, v32
    v_exp_f32 v33, v33
    v_smfmac_f32_32x32x32_bf16 v[64:79], a[8:11], v[24:31], v1
    ds_write2st64_b64 v3, v[52:53], v[54:55] offset0:2 offset1:3
    v_exp_f32 v34, v34
    v_exp_f32 v35, v35
    v_exp_f32 v36, v36
    v_mfma_f32_32x32x16_bf16 v[16:31], a[24:27], a[212:215], 0
    ds_write_b32 v3, v56 offset:2048
    v_exp_f32 v37, v37
    v_exp_f32 v38, v38
    v_exp_f32 v39, v39
    v_exp_f32 v40, v40
    v_exp_f32 v41, v41
    v_smfmac_f32_32x32x32_bf16 v[64:79], a[16:19], v[32:39], v1
    global_load_dwordx4 a[232:235], v7, s[42:43] offset:2048 sc1
    v_exp_f32 v42, v42
    v_exp_f32 v43, v43
    v_exp_f32 v44, v44
    v_exp_f32 v45, v45
    v_exp_f32 v46, v46
    v_exp_f32 v47, v47
    v_mov_b32 v123, s5
    v_exp_f32 v16, v16
    v_exp_f32 v17, v17
    v_smfmac_f32_32x32x32_bf16 v[64:79], a[20:23], v[40:47], v1
    s_waitcnt vmcnt(27) lgkmcnt(0)
    s_barrier
    ds_read2st64_b32 v[124:125], v2 offset0:8 offset1:24
    ds_read2st64_b32 v[126:127], v2 offset0:40 offset1:56
    v_exp_f32 v18, v18
    v_exp_f32 v19, v19
    v_exp_f32 v20, v20
    v_mfma_f32_32x32x16_bf16 v[32:47], a[36:39], a[212:215], 0
    s_mov_b64 exec, s[8:9]
    buffer_store_dword v123, v7, s[20:23], s12 offen offset:2048 sc1
    s_mov_b64 exec, -1
    ds_read2st64_b64 v[116:119], v4 offset0:0 offset1:8
    v_exp_f32 v21, v21
    v_exp_f32 v22, v22
    v_exp_f32 v23, v23
    v_exp_f32 v24, v24
    v_exp_f32 v25, v25
    v_smfmac_f32_32x32x32_bf16 v[64:79], a[28:31], v[16:23], v1
    s_waitcnt vmcnt(23)
    ds_read2st64_b64 v[120:123], v4 offset0:16 offset1:24
    v_exp_f32 v26, v26
    v_exp_f32 v27, v27
    v_exp_f32 v28, v28
    v_exp_f32 v29, v29
    v_smfmac_f32_16x16x64_bf16 v[104:107], v[112:115], a[240:247], v1 abid:1
    global_load_dwordx4 a[236:239], v7, s[42:43] offset:3072 sc1
    v_exp_f32 v30, v30
    v_exp_f32 v31, v31
    v_exp_f32 v32, v32
    v_exp_f32 v33, v33
    v_smfmac_f32_32x32x32_bf16 v[64:79], a[32:35], v[24:31], v1
    s_xor_b32 s42, s19, 73728
    s_add_u32 s52, s48, 8192
    global_load_dwordx4 a[240:243], v7, s[42:43] offset:-4096 sc1
    v_exp_f32 v34, v34
    v_exp_f32 v35, v35
    v_exp_f32 v36, v36
    v_mfma_f32_32x32x16_bf16 v[16:31], a[48:51], a[212:215], 0
    global_load_dwordx4 a[244:247], v7, s[42:43] offset:-3072 sc1
    v_exp_f32 v37, v37
    v_exp_f32 v38, v38
    v_exp_f32 v39, v39
    v_exp_f32 v40, v40
    v_exp_f32 v41, v41
    v_smfmac_f32_32x32x32_bf16 v[64:79], a[40:43], v[32:39], v1
    s_waitcnt lgkmcnt(0)
    global_load_lds_dwordx4 v7, s[44:45] offset:3072 sc1
    v_exp_f32 v42, v42
    v_exp_f32 v43, v43
    v_exp_f32 v44, v44
    v_exp_f32 v45, v45
    v_exp_f32 v46, v46
    v_exp_f32 v47, v47
    v_add_f32 v124, v124, v125
    v_add_f32 v126, v126, v127
    v_add_f32 v116, v116, v118
    v_add_f32 v124, v124, v126
    v_add_f32 v117, v117, v119
    v_rcp_f32 v125, v124
    v_add_f32 v120, v120, v122
    v_add_f32 v121, v121, v123
    v_add_f32 v116, v116, v120
    v_add_f32 v117, v117, v121
    v_mul_f32 v116, v116, v125
    v_mul_f32 v117, v117, v125
    v_cvt_pk_bf16_f32 v118, v116, v117
    v_add_f32 v124, v124, v125
    v_cmp_ngt_f32 vcc, 0x5f800000, v124
    v_exp_f32 v16, v16
    v_exp_f32 v17, v17
    v_smfmac_f32_32x32x32_bf16 v[64:79], a[44:47], v[40:47], v1
    s_xor_b32 s13, s65, 65536
    s_or_b64 s[6:7], s[6:7], vcc
    ds_write_b32 v5, v118
    v_exp_f32 v18, v18
    v_exp_f32 v19, v19
    v_exp_f32 v20, v20
    v_mfma_f32_32x32x16_bf16 v[32:47], a[60:63], a[212:215], 0
    s_add_u32 m0, s13, 32768
    global_load_dwordx4 v[232:235], v7, s[46:47] offset:0 sc1
    v_exp_f32 v21, v21
    v_exp_f32 v22, v22
    v_exp_f32 v23, v23
    v_exp_f32 v24, v24
    v_exp_f32 v25, v25
    v_smfmac_f32_32x32x32_bf16 v[64:79], a[52:55], v[16:23], v1
    s_waitcnt vmcnt(24)
    s_xor_b32 s13, s66, 65536
    global_load_dwordx4 v[236:239], v7, s[46:47] offset:1024 sc1
    v_exp_f32 v26, v26
    v_exp_f32 v27, v27
    v_exp_f32 v28, v28
    v_exp_f32 v29, v29
    v_smfmac_f32_16x16x64_bf16 v[108:111], v[112:115], a[200:207], v1 abid:1
    s_add_u32 s44, s13, s67
    global_load_lds_dwordx4 v7, s[44:45] offset:0 sc1
    v_exp_f32 v30, v30
    v_exp_f32 v31, v31
    v_exp_f32 v32, v32
    v_exp_f32 v33, v33
    v_smfmac_f32_32x32x32_bf16 v[64:79], a[56:59], v[24:31], v1
    s_waitcnt lgkmcnt(0)
    s_barrier
    ds_read_b128 v[112:115], v6
    v_exp_f32 v34, v34
    v_exp_f32 v35, v35
    v_exp_f32 v36, v36
    v_mfma_f32_32x32x16_bf16 v[16:31], a[72:75], a[212:215], 0
    s_add_u32 s46, s68, 16384
    global_load_dwordx4 a[200:203], v7, s[42:43] offset:-2048 sc1
    v_exp_f32 v37, v37
    v_exp_f32 v38, v38
    v_exp_f32 v39, v39
    v_exp_f32 v40, v40
    v_exp_f32 v41, v41
    v_smfmac_f32_32x32x32_bf16 v[64:79], a[64:67], v[32:39], v1
    global_load_dwordx4 a[204:207], v7, s[42:43] offset:-1024 sc1
    v_exp_f32 v42, v42
    v_exp_f32 v43, v43
    v_exp_f32 v44, v44
    v_exp_f32 v45, v45
    v_mfma_f32_32x32x8_f16 v[48:63], v[14:15], v[14:15], 0
    global_load_lds_dwordx4 v7, s[44:45] offset:1024 sc1
    v_exp_f32 v46, v46
    v_exp_f32 v47, v47
    v_exp_f32 v16, v16
    v_exp_f32 v17, v17
    v_smfmac_f32_32x32x32_bf16 v[64:79], a[68:71], v[40:47], v1
    global_store_dwordx4 v7, v[10:13], s[52:53] sc1
    v_exp_f32 v18, v18
    v_exp_f32 v19, v19
    v_exp_f32 v20, v20
    v_mfma_f32_32x32x16_bf16 v[32:47], a[84:87], a[212:215], 0
    global_load_dwordx4 v[240:243], v7, s[46:47] offset:0 sc1
    v_exp_f32 v21, v21
    v_exp_f32 v22, v22
    v_exp_f32 v23, v23
    v_exp_f32 v24, v24
    v_exp_f32 v25, v25
    v_smfmac_f32_32x32x32_bf16 v[64:79], a[76:79], v[16:23], v1
    s_waitcnt vmcnt(27) lgkmcnt(0)
    global_load_dwordx4 v[244:247], v7, s[46:47] offset:1024 sc1
    v_exp_f32 v26, v26
    v_exp_f32 v27, v27
    v_exp_f32 v28, v28
    v_exp_f32 v29, v29
    v_smfmac_f32_16x16x64_bf16 v[80:83], v[112:115], a[248:255], v1 abid:1
    s_add_u32 s46, s69, 16384
    v_exp_f32 v30, v30
    v_exp_f32 v31, v31
    v_exp_f32 v32, v32
    v_exp_f32 v33, v33
    v_smfmac_f32_32x32x32_bf16 v[64:79], a[80:83], v[24:31], v1
    global_load_dwordx4 a[248:251], v7, s[42:43] offset:0 sc1
    v_exp_f32 v34, v34
    v_exp_f32 v35, v35
    v_exp_f32 v36, v36
    v_mfma_f32_32x32x16_bf16 v[16:31], a[96:99], a[212:215], 0
    global_load_dwordx4 a[252:255], v7, s[42:43] offset:1024 sc1
    v_exp_f32 v37, v37
    v_exp_f32 v38, v38
    v_exp_f32 v39, v39
    v_exp_f32 v40, v40
    v_exp_f32 v41, v41
    v_smfmac_f32_32x32x32_bf16 v[64:79], a[88:91], v[32:39], v1
    global_load_lds_dwordx4 v7, s[44:45] offset:2048 sc1
    v_exp_f32 v42, v42
    v_exp_f32 v43, v43
    v_exp_f32 v44, v44
    v_exp_f32 v45, v45
    v_exp_f32 v46, v46
    v_exp_f32 v47, v47
    v_exp_f32 v16, v16
    v_exp_f32 v17, v17
    v_smfmac_f32_32x32x32_bf16 v[64:79], a[92:95], v[40:47], v1
    global_load_dwordx4 v[176:179], v7, s[46:47] offset:0 sc1
    v_exp_f32 v18, v18
    v_exp_f32 v19, v19
    v_exp_f32 v20, v20
    v_mfma_f32_32x32x16_bf16 v[32:47], a[108:111], a[212:215], 0
    v_exp_f32 v21, v21
    v_exp_f32 v22, v22
    v_exp_f32 v23, v23
    v_exp_f32 v24, v24
    v_exp_f32 v25, v25
    v_smfmac_f32_32x32x32_bf16 v[64:79], a[100:103], v[16:23], v1
    s_waitcnt vmcnt(26)
    v_exp_f32 v26, v26
    v_exp_f32 v27, v27
    v_exp_f32 v28, v28
    v_exp_f32 v29, v29
    v_smfmac_f32_16x16x64_bf16 v[84:87], v[112:115], a[192:199], v1 abid:1
    v_exp_f32 v30, v30
    v_exp_f32 v31, v31
    v_exp_f32 v32, v32
    v_exp_f32 v33, v33
    v_smfmac_f32_32x32x32_bf16 v[64:79], a[104:107], v[24:31], v1
    global_load_dwordx4 a[192:195], v7, s[42:43] offset:2048 sc1
    v_exp_f32 v34, v34
    v_exp_f32 v35, v35
    v_exp_f32 v36, v36
    v_mfma_f32_32x32x16_bf16 v[16:31], a[120:123], a[212:215], 0
    global_load_dwordx4 a[196:199], v7, s[42:43] offset:3072 sc1
    v_exp_f32 v37, v37
    v_exp_f32 v38, v38
    v_exp_f32 v39, v39
    v_exp_f32 v40, v40
    v_exp_f32 v41, v41
    v_smfmac_f32_32x32x32_bf16 v[64:79], a[112:115], v[32:39], v1
    s_xor_b32 s42, s19, 81920
    global_load_lds_dwordx4 v7, s[44:45] offset:3072 sc1
    v_exp_f32 v42, v42
    v_exp_f32 v43, v43
    v_exp_f32 v44, v44
    v_exp_f32 v45, v45
    v_exp_f32 v46, v46
    v_exp_f32 v47, v47
    v_exp_f32 v16, v16
    v_exp_f32 v17, v17
    v_smfmac_f32_32x32x32_bf16 v[64:79], a[116:119], v[40:47], v1
    s_xor_b32 s13, s65, 81920
    s_add_u32 m0, s13, 32768
    global_load_dwordx4 v[180:183], v7, s[46:47] offset:1024 sc1
    v_exp_f32 v18, v18
    v_exp_f32 v19, v19
    v_exp_f32 v20, v20
    v_mfma_f32_32x32x16_bf16 v[32:47], a[132:135], a[212:215], 0
    s_xor_b32 s13, s66, 81920
    v_exp_f32 v21, v21
    v_exp_f32 v22, v22
    v_exp_f32 v23, v23
    v_exp_f32 v24, v24
    v_exp_f32 v25, v25
    v_smfmac_f32_32x32x32_bf16 v[64:79], a[124:127], v[16:23], v1
    s_waitcnt vmcnt(25)
    s_mov_b64 exec, 0xff
    buffer_load_dwordx2 v[116:117], v2, s[20:23], s75 offen offset:3072 sc1
    s_mov_b64 exec, -1
    v_exp_f32 v26, v26
    v_exp_f32 v27, v27
    v_exp_f32 v28, v28
    v_exp_f32 v29, v29
    v_smfmac_f32_16x16x64_bf16 v[88:91], v[112:115], a[224:231], v1 abid:1
    s_add_u32 s44, s13, s67
    v_exp_f32 v30, v30
    v_exp_f32 v31, v31
    v_exp_f32 v32, v32
    v_exp_f32 v33, v33
    v_smfmac_f32_32x32x32_bf16 v[64:79], a[128:131], v[24:31], v1
    s_add_u32 s52, s48, 12288
    s_add_u32 s46, s70, 16384
    global_load_dwordx4 a[224:227], v7, s[42:43] offset:-4096 sc1
    v_exp_f32 v34, v34
    v_exp_f32 v35, v35
    v_exp_f32 v36, v36
    v_mfma_f32_32x32x16_bf16 v[16:31], a[144:147], a[212:215], 0
    global_load_dwordx4 a[228:231], v7, s[42:43] offset:-3072 sc1
    v_exp_f32 v37, v37
    v_exp_f32 v38, v38
    v_exp_f32 v39, v39
    v_exp_f32 v40, v40
    v_exp_f32 v41, v41
    v_smfmac_f32_32x32x32_bf16 v[64:79], a[136:139], v[32:39], v1
    global_load_lds_dwordx4 v7, s[44:45] offset:0 sc1
    v_exp_f32 v42, v42
    v_exp_f32 v43, v43
    v_exp_f32 v44, v44
    v_exp_f32 v45, v45
    v_exp_f32 v46, v46
    v_exp_f32 v47, v47
    v_exp_f32 v16, v16
    v_exp_f32 v17, v17
    v_smfmac_f32_32x32x32_bf16 v[64:79], a[140:143], v[40:47], v1
    global_load_dwordx4 v[184:187], v7, s[46:47] offset:0 sc1
    v_exp_f32 v18, v18
    v_exp_f32 v19, v19
    v_exp_f32 v20, v20
    v_mfma_f32_32x32x16_bf16 v[32:47], a[156:159], a[212:215], 0
    v_exp_f32 v21, v21
    v_exp_f32 v22, v22
    v_exp_f32 v23, v23
    v_exp_f32 v24, v24
    v_exp_f32 v25, v25
    v_smfmac_f32_32x32x32_bf16 v[64:79], a[148:151], v[16:23], v1
    s_waitcnt vmcnt(25)
    v_exp_f32 v26, v26
    v_exp_f32 v27, v27
    v_exp_f32 v28, v28
    v_exp_f32 v29, v29
    v_smfmac_f32_16x16x64_bf16 v[92:95], v[112:115], a[232:239], v1 abid:1
    v_exp_f32 v30, v30
    v_exp_f32 v31, v31
    v_exp_f32 v32, v32
    v_exp_f32 v33, v33
    v_smfmac_f32_32x32x32_bf16 v[64:79], a[152:155], v[24:31], v1
    global_load_dwordx4 a[232:235], v7, s[42:43] offset:-2048 sc1
    v_exp_f32 v34, v34
    v_exp_f32 v35, v35
    v_exp_f32 v36, v36
    v_mfma_f32_32x32x16_bf16 v[16:31], a[168:171], a[212:215], 0
    global_load_dwordx4 a[236:239], v7, s[42:43] offset:-1024 sc1
    v_exp_f32 v37, v37
    v_exp_f32 v38, v38
    v_exp_f32 v39, v39
    v_exp_f32 v40, v40
    v_exp_f32 v41, v41
    v_smfmac_f32_32x32x32_bf16 v[64:79], a[160:163], v[32:39], v1
    global_load_lds_dwordx4 v7, s[44:45] offset:1024 sc1
    v_exp_f32 v42, v42
    v_exp_f32 v43, v43
    v_exp_f32 v44, v44
    v_exp_f32 v45, v45
    v_exp_f32 v46, v46
    v_exp_f32 v47, v47
    v_exp_f32 v16, v16
    v_exp_f32 v17, v17
    v_smfmac_f32_32x32x32_bf16 v[64:79], a[164:167], v[40:47], v1
    global_store_dwordx4 v7, v[10:13], s[52:53] sc1
    v_exp_f32 v18, v18
    v_exp_f32 v19, v19
    v_exp_f32 v20, v20
    v_mfma_f32_32x32x16_bf16 v[32:47], a[180:183], a[212:215], 0
    global_load_dwordx4 v[188:191], v7, s[46:47] offset:1024 sc1
    v_exp_f32 v21, v21
    v_exp_f32 v22, v22
    v_exp_f32 v23, v23
    v_exp_f32 v24, v24
    v_exp_f32 v25, v25
    v_smfmac_f32_32x32x32_bf16 v[64:79], a[172:175], v[16:23], v1
    s_waitcnt vmcnt(28)
    s_add_u32 s46, s71, 16384
    v_exp_f32 v26, v26
    v_exp_f32 v27, v27
    v_exp_f32 v28, v28
    v_exp_f32 v29, v29
    v_smfmac_f32_16x16x64_bf16 v[96:99], v[112:115], a[240:247], v1 abid:1
    v_exp_f32 v30, v30
    v_exp_f32 v31, v31
    v_exp_f32 v32, v32
    v_exp_f32 v33, v33
    v_smfmac_f32_32x32x32_bf16 v[64:79], a[176:179], v[24:31], v1
    s_waitcnt vmcnt(44)
    global_load_dwordx4 a[208:211], v7, s[42:43] offset:0 sc1
    v_exp_f32 v34, v34
    v_exp_f32 v35, v35
    v_exp_f32 v36, v36
    v_mfma_f32_32x32x16_bf16 v[16:31], a[0:3], a[216:219], 0
    global_load_dwordx4 a[212:215], v7, s[42:43] offset:1024 sc1
    v_exp_f32 v37, v37
    v_exp_f32 v38, v38
    v_exp_f32 v39, v39
    v_exp_f32 v40, v40
    v_exp_f32 v41, v41
    v_smfmac_f32_32x32x32_bf16 v[64:79], a[184:187], v[32:39], v1
    s_waitcnt vmcnt(11)
    global_load_dwordx4 a[240:243], v7, s[42:43] offset:2048 sc1
    v_exp_f32 v42, v42
    v_exp_f32 v43, v43
    v_exp_f32 v44, v44
    v_exp_f32 v45, v45
    v_exp_f32 v46, v46
    v_exp_f32 v47, v47
    v_cmp_ne_u64 vcc, s[0:1], v[116:117]
    v_exp_f32 v16, v16
    v_exp_f32 v17, v17
    v_smfmac_f32_32x32x32_bf16 v[64:79], a[188:191], v[40:47], v1
    s_and_b32 s0, vcc_lo, 0xff
    global_load_dwordx4 a[244:247], v7, s[42:43] offset:3072 sc1
    v_exp_f32 v18, v18
    v_exp_f32 v19, v19
    v_exp_f32 v20, v20
    v_mfma_f32_32x32x16_bf16 v[32:47], a[12:15], a[216:219], 0
    s_xor_b32 s42, s19, 90112
    global_load_lds_dwordx4 v7, s[44:45] offset:2048 sc1
    v_exp_f32 v21, v21
    v_exp_f32 v22, v22
    v_exp_f32 v23, v23
    v_exp_f32 v24, v24
    v_exp_f32 v25, v25
    v_smfmac_f32_32x32x32_bf16 v[48:63], a[4:7], v[16:23], v1
    s_waitcnt vmcnt(27)
    ds_write2st64_b64 v3, v[64:65], v[66:67] offset0:0 offset1:1
    v_exp_f32 v26, v26
    v_exp_f32 v27, v27
    v_exp_f32 v28, v28
    v_exp_f32 v29, v29
    v_smfmac_f32_16x16x64_bf16 v[100:103], v[112:115], a[200:207], v1 abid:1
    global_load_dwordx4 v[192:195], v7, s[46:47] offset:0 sc1
    v_exp_f32 v30, v30
    v_exp_f32 v31, v31
    v_exp_f32 v32, v32
    v_exp_f32 v33, v33
    v_smfmac_f32_32x32x32_bf16 v[48:63], a[8:11], v[24:31], v1
    ds_write2st64_b64 v3, v[68:69], v[70:71] offset0:2 offset1:3
    v_exp_f32 v34, v34
    v_exp_f32 v35, v35
    v_exp_f32 v36, v36
    v_mfma_f32_32x32x16_bf16 v[16:31], a[24:27], a[216:219], 0
    ds_write_b32 v3, v72 offset:2048
    v_exp_f32 v37, v37
    v_exp_f32 v38, v38
    v_exp_f32 v39, v39
    v_exp_f32 v40, v40
    v_exp_f32 v41, v41
    v_smfmac_f32_32x32x32_bf16 v[48:63], a[16:19], v[32:39], v1
    global_load_dwordx4 a[200:203], v7, s[42:43] offset:-4096 sc1
    v_exp_f32 v42, v42
    v_exp_f32 v43, v43
    v_exp_f32 v44, v44
    v_exp_f32 v45, v45
    v_exp_f32 v46, v46
    v_exp_f32 v47, v47
    v_exp_f32 v16, v16
    v_exp_f32 v17, v17
    v_smfmac_f32_32x32x32_bf16 v[48:63], a[20:23], v[40:47], v1
    s_waitcnt lgkmcnt(0)
    s_barrier
    ds_read2st64_b32 v[124:125], v2 offset0:8 offset1:24
    ds_read2st64_b32 v[126:127], v2 offset0:40 offset1:56
    v_exp_f32 v18, v18
    v_exp_f32 v19, v19
    v_exp_f32 v20, v20
    v_mfma_f32_32x32x16_bf16 v[32:47], a[36:39], a[216:219], 0
    ds_read2st64_b64 v[116:119], v4 offset0:0 offset1:8
    v_exp_f32 v21, v21
    v_exp_f32 v22, v22
    v_exp_f32 v23, v23
    v_exp_f32 v24, v24
    v_exp_f32 v25, v25
    v_smfmac_f32_32x32x32_bf16 v[48:63], a[28:31], v[16:23], v1
    s_waitcnt vmcnt(23)
    ds_read2st64_b64 v[120:123], v4 offset0:16 offset1:24
    v_exp_f32 v26, v26
    v_exp_f32 v27, v27
    v_exp_f32 v28, v28
    v_exp_f32 v29, v29
    v_smfmac_f32_16x16x64_bf16 v[104:107], v[112:115], a[248:255], v1 abid:1
    global_load_dwordx4 a[204:207], v7, s[42:43] offset:-3072 sc1
    v_exp_f32 v30, v30
    v_exp_f32 v31, v31
    v_exp_f32 v32, v32
    v_exp_f32 v33, v33
    v_smfmac_f32_32x32x32_bf16 v[48:63], a[32:35], v[24:31], v1
    s_add_u32 s52, s48, 16384
    global_load_dwordx4 a[248:251], v7, s[42:43] offset:-2048 sc1
    v_exp_f32 v34, v34
    v_exp_f32 v35, v35
    v_exp_f32 v36, v36
    v_mfma_f32_32x32x16_bf16 v[16:31], a[48:51], a[216:219], 0
    global_load_dwordx4 a[252:255], v7, s[42:43] offset:-1024 sc1
    v_exp_f32 v37, v37
    v_exp_f32 v38, v38
    v_exp_f32 v39, v39
    v_exp_f32 v40, v40
    v_exp_f32 v41, v41
    v_smfmac_f32_32x32x32_bf16 v[48:63], a[40:43], v[32:39], v1
    s_waitcnt lgkmcnt(0)
    global_load_lds_dwordx4 v7, s[44:45] offset:3072 sc1
    v_exp_f32 v42, v42
    v_exp_f32 v43, v43
    v_exp_f32 v44, v44
    v_exp_f32 v45, v45
    v_exp_f32 v46, v46
    v_exp_f32 v47, v47
    v_add_f32 v124, v124, v125
    v_add_f32 v126, v126, v127
    v_add_f32 v116, v116, v118
    v_add_f32 v124, v124, v126
    v_add_f32 v117, v117, v119
    v_rcp_f32 v125, v124
    v_add_f32 v120, v120, v122
    v_add_f32 v121, v121, v123
    v_add_f32 v116, v116, v120
    v_add_f32 v117, v117, v121
    v_mul_f32 v116, v116, v125
    v_mul_f32 v117, v117, v125
    v_cvt_pk_bf16_f32 v118, v116, v117
    v_add_f32 v124, v124, v125
    v_cmp_ngt_f32 vcc, 0x5f800000, v124
    v_exp_f32 v16, v16
    v_exp_f32 v17, v17
    v_smfmac_f32_32x32x32_bf16 v[48:63], a[44:47], v[40:47], v1
    s_xor_b32 s13, s65, 98304
    s_or_b64 s[6:7], s[6:7], vcc
    ds_write_b32 v5, v118
    v_exp_f32 v18, v18
    v_exp_f32 v19, v19
    v_exp_f32 v20, v20
    v_mfma_f32_32x32x16_bf16 v[32:47], a[60:63], a[216:219], 0
    s_add_u32 m0, s13, 32768
    global_load_dwordx4 v[196:199], v7, s[46:47] offset:1024 sc1
    v_exp_f32 v21, v21
    v_exp_f32 v22, v22
    v_exp_f32 v23, v23
    v_exp_f32 v24, v24
    v_exp_f32 v25, v25
    v_smfmac_f32_32x32x32_bf16 v[48:63], a[52:55], v[16:23], v1
    s_waitcnt vmcnt(24)
    s_add_u32 s46, s68, 24576
    global_load_dwordx4 v[136:139], v7, s[46:47] offset:0 sc1
    v_exp_f32 v26, v26
    v_exp_f32 v27, v27
    v_exp_f32 v28, v28
    v_exp_f32 v29, v29
    v_smfmac_f32_16x16x64_bf16 v[108:111], v[112:115], a[192:199], v1 abid:1
    s_xor_b32 s13, s66, 98304
    v_exp_f32 v30, v30
    v_exp_f32 v31, v31
    v_exp_f32 v32, v32
    v_exp_f32 v33, v33
    v_smfmac_f32_32x32x32_bf16 v[48:63], a[56:59], v[24:31], v1
    s_waitcnt lgkmcnt(0)
    s_barrier
    ds_read_b128 v[112:115], v6
    v_exp_f32 v34, v34
    v_exp_f32 v35, v35
    v_exp_f32 v36, v36
    v_mfma_f32_32x32x16_bf16 v[16:31], a[72:75], a[216:219], 0
    s_add_u32 s44, s13, s67
    global_load_dwordx4 a[192:195], v7, s[42:43] offset:0 sc1
    v_exp_f32 v37, v37
    v_exp_f32 v38, v38
    v_exp_f32 v39, v39
    v_exp_f32 v40, v40
    v_exp_f32 v41, v41
    v_smfmac_f32_32x32x32_bf16 v[48:63], a[64:67], v[32:39], v1
    global_load_dwordx4 a[196:199], v7, s[42:43] offset:1024 sc1
    v_exp_f32 v42, v42
    v_exp_f32 v43, v43
    v_exp_f32 v44, v44
    v_exp_f32 v45, v45
    v_mfma_f32_32x32x8_f16 v[64:79], v[14:15], v[14:15], 0
    global_load_lds_dwordx4 v7, s[44:45] offset:0 sc1
    v_exp_f32 v46, v46
    v_exp_f32 v47, v47
    v_exp_f32 v16, v16
    v_exp_f32 v17, v17
    v_smfmac_f32_32x32x32_bf16 v[48:63], a[68:71], v[40:47], v1
    global_store_dwordx4 v7, v[10:13], s[52:53] sc1
    v_exp_f32 v18, v18
    v_exp_f32 v19, v19
    v_exp_f32 v20, v20
    v_mfma_f32_32x32x16_bf16 v[32:47], a[84:87], a[216:219], 0
    global_load_lds_dwordx4 v7, s[44:45] offset:1024 sc1
    v_exp_f32 v21, v21
    v_exp_f32 v22, v22
    v_exp_f32 v23, v23
    v_exp_f32 v24, v24
    v_exp_f32 v25, v25
    v_smfmac_f32_32x32x32_bf16 v[48:63], a[76:79], v[16:23], v1
    s_waitcnt vmcnt(25) lgkmcnt(0)
    global_load_dwordx4 v[140:143], v7, s[46:47] offset:1024 sc1
    v_exp_f32 v26, v26
    v_exp_f32 v27, v27
    v_exp_f32 v28, v28
    v_exp_f32 v29, v29
    v_smfmac_f32_16x16x64_bf16 v[80:83], v[112:115], a[224:231], v1 abid:1
    s_add_u32 s46, s69, 24576
    v_exp_f32 v30, v30
    v_exp_f32 v31, v31
    v_exp_f32 v32, v32
    v_exp_f32 v33, v33
    v_smfmac_f32_32x32x32_bf16 v[48:63], a[80:83], v[24:31], v1
    global_load_dwordx4 a[224:227], v7, s[42:43] offset:2048 sc1
    v_exp_f32 v34, v34
    v_exp_f32 v35, v35
    v_exp_f32 v36, v36
    v_mfma_f32_32x32x16_bf16 v[16:31], a[96:99], a[216:219], 0
    global_load_dwordx4 a[228:231], v7, s[42:43] offset:3072 sc1
    v_exp_f32 v37, v37
    v_exp_f32 v38, v38
    v_exp_f32 v39, v39
    v_exp_f32 v40, v40
    v_exp_f32 v41, v41
    v_smfmac_f32_32x32x32_bf16 v[48:63], a[88:91], v[32:39], v1
    s_xor_b32 s42, s19, 98304
    global_load_lds_dwordx4 v7, s[44:45] offset:2048 sc1
    v_exp_f32 v42, v42
    v_exp_f32 v43, v43
    v_exp_f32 v44, v44
    v_exp_f32 v45, v45
    v_exp_f32 v46, v46
    v_exp_f32 v47, v47
    v_exp_f32 v16, v16
    v_exp_f32 v17, v17
    v_smfmac_f32_32x32x32_bf16 v[48:63], a[92:95], v[40:47], v1
    global_load_dwordx4 v[144:147], v7, s[46:47] offset:0 sc1
    v_exp_f32 v18, v18
    v_exp_f32 v19, v19
    v_exp_f32 v20, v20
    v_mfma_f32_32x32x16_bf16 v[32:47], a[108:111], a[216:219], 0
    v_exp_f32 v21, v21
    v_exp_f32 v22, v22
    v_exp_f32 v23, v23
    v_exp_f32 v24, v24
    v_exp_f32 v25, v25
    v_smfmac_f32_32x32x32_bf16 v[48:63], a[100:103], v[16:23], v1
    s_waitcnt vmcnt(26)
    v_exp_f32 v26, v26
    v_exp_f32 v27, v27
    v_exp_f32 v28, v28
    v_exp_f32 v29, v29
    v_smfmac_f32_16x16x64_bf16 v[84:87], v[112:115], a[232:239], v1 abid:1
    v_exp_f32 v30, v30
    v_exp_f32 v31, v31
    v_exp_f32 v32, v32
    v_exp_f32 v33, v33
    v_smfmac_f32_32x32x32_bf16 v[48:63], a[104:107], v[24:31], v1
    s_add_u32 s52, s48, 20480
    global_load_dwordx4 a[232:235], v7, s[42:43] offset:-4096 sc1
    v_exp_f32 v34, v34
    v_exp_f32 v35, v35
    v_exp_f32 v36, v36
    v_mfma_f32_32x32x16_bf16 v[16:31], a[120:123], a[216:219], 0
    global_load_dwordx4 a[236:239], v7, s[42:43] offset:-3072 sc1
    v_exp_f32 v37, v37
    v_exp_f32 v38, v38
    v_exp_f32 v39, v39
    v_exp_f32 v40, v40
    v_exp_f32 v41, v41
    v_smfmac_f32_32x32x32_bf16 v[48:63], a[112:115], v[32:39], v1
    s_mov_b64 exec, s[54:55]
    buffer_load_dwordx4 v[116:119], v7, s[20:23], s18 offen offset:2048 sc1
    s_mov_b64 exec, -1
    v_exp_f32 v42, v42
    v_exp_f32 v43, v43
    v_exp_f32 v44, v44
    v_exp_f32 v45, v45
    v_exp_f32 v46, v46
    v_exp_f32 v47, v47
    v_exp_f32 v16, v16
    v_exp_f32 v17, v17
    v_smfmac_f32_32x32x32_bf16 v[48:63], a[116:119], v[40:47], v1
    global_load_lds_dwordx4 v7, s[44:45] offset:3072 sc1
    v_exp_f32 v18, v18
    v_exp_f32 v19, v19
    v_exp_f32 v20, v20
    v_mfma_f32_32x32x16_bf16 v[32:47], a[132:135], a[216:219], 0
    global_load_dwordx4 v[148:151], v7, s[46:47] offset:1024 sc1
    v_exp_f32 v21, v21
    v_exp_f32 v22, v22
    v_exp_f32 v23, v23
    v_exp_f32 v24, v24
    v_exp_f32 v25, v25
    v_smfmac_f32_32x32x32_bf16 v[48:63], a[124:127], v[16:23], v1
    s_waitcnt vmcnt(26)
    s_add_u32 s46, s70, 24576
    v_exp_f32 v26, v26
    v_exp_f32 v27, v27
    v_exp_f32 v28, v28
    v_exp_f32 v29, v29
    v_smfmac_f32_16x16x64_bf16 v[88:91], v[112:115], a[208:215], v1 abid:1
    v_exp_f32 v30, v30
    v_exp_f32 v31, v31
    v_exp_f32 v32, v32
    v_exp_f32 v33, v33
    v_smfmac_f32_32x32x32_bf16 v[48:63], a[128:131], v[24:31], v1
    s_mov_b32 m0, s61
    global_load_dwordx4 a[208:211], v7, s[42:43] offset:-2048 sc1
    v_exp_f32 v34, v34
    v_exp_f32 v35, v35
    v_exp_f32 v36, v36
    v_mfma_f32_32x32x16_bf16 v[16:31], a[144:147], a[216:219], 0
    global_load_dwordx4 a[212:215], v7, s[42:43] offset:-1024 sc1
    v_exp_f32 v37, v37
    v_exp_f32 v38, v38
    v_exp_f32 v39, v39
    v_exp_f32 v40, v40
    v_exp_f32 v41, v41
    v_smfmac_f32_32x32x32_bf16 v[48:63], a[136:139], v[32:39], v1
    v_exp_f32 v42, v42
    v_exp_f32 v43, v43
    v_exp_f32 v44, v44
    v_exp_f32 v45, v45
    v_exp_f32 v46, v46
    v_exp_f32 v47, v47
    v_exp_f32 v16, v16
    v_exp_f32 v17, v17
    v_smfmac_f32_32x32x32_bf16 v[48:63], a[140:143], v[40:47], v1
    global_store_dwordx4 v7, v[10:13], s[52:53] sc1
    v_exp_f32 v18, v18
    v_exp_f32 v19, v19
    v_exp_f32 v20, v20
    v_mfma_f32_32x32x16_bf16 v[32:47], a[156:159], a[216:219], 0
    global_load_dwordx4 v[248:251], v7, s[46:47] offset:0 sc1
    v_exp_f32 v21, v21
    v_exp_f32 v22, v22
    v_exp_f32 v23, v23
    v_exp_f32 v24, v24
    v_exp_f32 v25, v25
    v_smfmac_f32_32x32x32_bf16 v[48:63], a[148:151], v[16:23], v1
    s_waitcnt vmcnt(28)
    v_exp_f32 v26, v26
    v_exp_f32 v27, v27
    v_exp_f32 v28, v28
    v_exp_f32 v29, v29
    v_smfmac_f32_16x16x64_bf16 v[92:95], v[112:115], a[240:247], v1 abid:1
    v_exp_f32 v30, v30
    v_exp_f32 v31, v31
    v_exp_f32 v32, v32
    v_exp_f32 v33, v33
    v_smfmac_f32_32x32x32_bf16 v[48:63], a[152:155], v[24:31], v1
    s_add_u32 s52, s48, 24576
    global_load_dwordx4 a[240:243], v7, s[42:43] offset:0 sc1
    v_exp_f32 v34, v34
    v_exp_f32 v35, v35
    v_exp_f32 v36, v36
    v_mfma_f32_32x32x16_bf16 v[16:31], a[168:171], a[216:219], 0
    global_load_dwordx4 a[244:247], v7, s[42:43] offset:1024 sc1
    v_exp_f32 v37, v37
    v_exp_f32 v38, v38
    v_exp_f32 v39, v39
    v_exp_f32 v40, v40
    v_exp_f32 v41, v41
L_w6:
    s_cbranch_execz L_wb_B1
    v_smfmac_f32_32x32x32_bf16 v[48:63], a[160:163], v[32:39], v1
    s_waitcnt vmcnt(8)
    v_exp_f32 v42, v42
    v_exp_f32 v43, v43
    v_exp_f32 v44, v44
    v_exp_f32 v45, v45
    v_exp_f32 v46, v46
    v_exp_f32 v47, v47
    v_add3_u32 v116, v116, v117, v118
    v_add_u32 v116, v116, v119
    v_cmp_ne_u32 vcc, s4, v116
    s_nop 0
    s_and_b64 vcc, vcc, s[54:55]
    s_cbranch_vccnz L_f2_r
L_f2_ok:
    v_exp_f32 v16, v16
    v_exp_f32 v17, v17
    v_smfmac_f32_32x32x32_bf16 v[48:63], a[164:167], v[40:47], v1
    s_barrier
    global_load_lds_dwordx4 v7, s[50:51] offset:0 sc1
    v_exp_f32 v18, v18
    v_exp_f32 v19, v19
    v_exp_f32 v20, v20
    v_mfma_f32_32x32x16_bf16 v[32:47], a[180:183], a[216:219], 0
    global_load_lds_dwordx4 v7, s[50:51] offset:1024 sc1
    v_exp_f32 v21, v21
    v_exp_f32 v22, v22
    v_exp_f32 v23, v23
    v_exp_f32 v24, v24
    v_exp_f32 v25, v25
    v_smfmac_f32_32x32x32_bf16 v[48:63], a[172:175], v[16:23], v1
    s_waitcnt vmcnt(28)
    s_xor_b32 s13, s65, 114688
    global_load_dwordx4 v[252:255], v7, s[46:47] offset:1024 sc1
    v_exp_f32 v26, v26
    v_exp_f32 v27, v27
    v_exp_f32 v28, v28
    v_exp_f32 v29, v29
    v_smfmac_f32_16x16x64_bf16 v[96:99], v[112:115], a[200:207], v1 abid:1
    s_add_u32 m0, s13, 32768
    v_exp_f32 v30, v30
    v_exp_f32 v31, v31
    v_exp_f32 v32, v32
    v_exp_f32 v33, v33
    v_smfmac_f32_32x32x32_bf16 v[48:63], a[176:179], v[24:31], v1
    s_waitcnt vmcnt(63)
    s_xor_b32 s13, s66, 114688
    global_load_dwordx4 a[200:203], v7, s[42:43] offset:2048 sc1
    v_exp_f32 v34, v34
    v_exp_f32 v35, v35
    v_exp_f32 v36, v36
    v_mfma_f32_32x32x16_bf16 v[16:31], a[0:3], a[220:223], 0
    s_add_u32 s44, s13, s67
    global_load_dwordx4 a[204:207], v7, s[42:43] offset:3072 sc1
    v_exp_f32 v37, v37
    v_exp_f32 v38, v38
    v_exp_f32 v39, v39
    v_exp_f32 v40, v40
    v_exp_f32 v41, v41
    v_smfmac_f32_32x32x32_bf16 v[48:63], a[184:187], v[32:39], v1
    s_xor_b32 s42, s19, 106496
    global_load_lds_dwordx4 v7, s[44:45] offset:0 sc1
    v_exp_f32 v42, v42
    v_exp_f32 v43, v43
    v_exp_f32 v44, v44
    v_exp_f32 v45, v45
    v_exp_f32 v46, v46
    v_exp_f32 v47, v47
    v_exp_f32 v16, v16
    v_exp_f32 v17, v17
    v_smfmac_f32_32x32x32_bf16 v[48:63], a[188:191], v[40:47], v1
    s_add_u32 s46, s71, 24576
    global_store_dwordx4 v7, v[10:13], s[52:53] sc1
    v_exp_f32 v18, v18
    v_exp_f32 v19, v19
    v_exp_f32 v20, v20
    v_mfma_f32_32x32x16_bf16 v[32:47], a[12:15], a[220:223], 0
    global_load_lds_dwordx4 v7, s[44:45] offset:1024 sc1
    v_exp_f32 v21, v21
    v_exp_f32 v22, v22
    v_exp_f32 v23, v23
    v_exp_f32 v24, v24
    v_exp_f32 v25, v25
    v_smfmac_f32_32x32x32_bf16 v[64:79], a[4:7], v[16:23], v1
    s_waitcnt vmcnt(32)
    ds_write2st64_b64 v3, v[48:49], v[50:51] offset0:0 offset1:1
    v_exp_f32 v26, v26
    v_exp_f32 v27, v27
    v_exp_f32 v28, v28
    v_exp_f32 v29, v29
    v_smfmac_f32_16x16x64_bf16 v[100:103], v[112:115], a[248:255], v1 abid:1
    global_load_lds_dwordx4 v7, s[44:45] offset:2048 sc1
    v_exp_f32 v30, v30
    v_exp_f32 v31, v31
    v_exp_f32 v32, v32
    v_exp_f32 v33, v33
    v_smfmac_f32_32x32x32_bf16 v[64:79], a[8:11], v[24:31], v1
    ds_write2st64_b64 v3, v[52:53], v[54:55] offset0:2 offset1:3
    v_exp_f32 v34, v34
    v_exp_f32 v35, v35
    v_exp_f32 v36, v36
    v_mfma_f32_32x32x16_bf16 v[16:31], a[24:27], a[220:223], 0
    ds_write_b32 v3, v56 offset:2048
    v_exp_f32 v37, v37
    v_exp_f32 v38, v38
    v_exp_f32 v39, v39
    v_exp_f32 v40, v40
    v_exp_f32 v41, v41
    v_smfmac_f32_32x32x32_bf16 v[64:79], a[16:19], v[32:39], v1
    global_load_dwordx4 a[0:3], v7, s[42:43] offset:-4096 sc1
    v_exp_f32 v42, v42
    v_exp_f32 v43, v43
    v_exp_f32 v44, v44
    v_exp_f32 v45, v45
    v_exp_f32 v46, v46
    v_exp_f32 v47, v47
    v_exp_f32 v16, v16
    v_exp_f32 v17, v17
    v_smfmac_f32_32x32x32_bf16 v[64:79], a[20:23], v[40:47], v1
    s_waitcnt lgkmcnt(0)
    s_barrier
    ds_read2st64_b32 v[124:125], v2 offset0:8 offset1:24
    ds_read2st64_b32 v[126:127], v2 offset0:40 offset1:56
    v_exp_f32 v18, v18
    v_exp_f32 v19, v19
    v_exp_f32 v20, v20
    v_mfma_f32_32x32x16_bf16 v[32:47], a[36:39], a[220:223], 0
    ds_read2st64_b64 v[116:119], v4 offset0:0 offset1:8
    v_exp_f32 v21, v21
    v_exp_f32 v22, v22
    v_exp_f32 v23, v23
    v_exp_f32 v24, v24
    v_exp_f32 v25, v25
    v_smfmac_f32_32x32x32_bf16 v[64:79], a[28:31], v[16:23], v1
    s_waitcnt vmcnt(29)
    ds_read2st64_b64 v[120:123], v4 offset0:16 offset1:24
    v_exp_f32 v26, v26
    v_exp_f32 v27, v27
    v_exp_f32 v28, v28
    v_exp_f32 v29, v29
    v_smfmac_f32_16x16x64_bf16 v[104:107], v[112:115], a[192:199], v1 abid:1
    global_load_dwordx4 a[4:7], v7, s[42:43] offset:-3072 sc1
    v_exp_f32 v30, v30
    v_exp_f32 v31, v31
    v_exp_f32 v32, v32
    v_exp_f32 v33, v33
    v_smfmac_f32_32x32x32_bf16 v[64:79], a[32:35], v[24:31], v1
    global_load_dwordx4 a[248:251], v7, s[42:43] offset:-2048 sc1
    v_exp_f32 v34, v34
    v_exp_f32 v35, v35
    v_exp_f32 v36, v36
    v_mfma_f32_32x32x16_bf16 v[16:31], a[48:51], a[220:223], 0
    global_load_dwordx4 a[252:255], v7, s[42:43] offset:-1024 sc1
    v_exp_f32 v37, v37
    v_exp_f32 v38, v38
    v_exp_f32 v39, v39
    v_exp_f32 v40, v40
    v_exp_f32 v41, v41
    v_smfmac_f32_32x32x32_bf16 v[64:79], a[40:43], v[32:39], v1
    s_waitcnt lgkmcnt(0)
    global_load_dwordx4 a[8:11], v7, s[42:43] offset:0 sc1
    v_exp_f32 v42, v42
    v_exp_f32 v43, v43
    v_exp_f32 v44, v44
    v_exp_f32 v45, v45
    v_exp_f32 v46, v46
    v_exp_f32 v47, v47
    v_add_f32 v124, v124, v125
    v_add_f32 v126, v126, v127
    v_add_f32 v116, v116, v118
    v_add_f32 v124, v124, v126
    v_add_f32 v117, v117, v119
    v_rcp_f32 v125, v124
    v_add_f32 v120, v120, v122
    v_add_f32 v121, v121, v123
    v_add_f32 v116, v116, v120
    v_add_f32 v117, v117, v121
    v_mul_f32 v116, v116, v125
    v_mul_f32 v117, v117, v125
    v_cvt_pk_bf16_f32 v118, v116, v117
    v_add_f32 v124, v124, v125
    v_cmp_ngt_f32 vcc, 0x5f800000, v124
    v_exp_f32 v16, v16
    v_exp_f32 v17, v17
    v_smfmac_f32_32x32x32_bf16 v[64:79], a[44:47], v[40:47], v1
    s_or_b64 s[6:7], s[6:7], vcc
    ds_write_b32 v5, v118
    v_exp_f32 v18, v18
    v_exp_f32 v19, v19
    v_exp_f32 v20, v20
    v_mfma_f32_32x32x16_bf16 v[32:47], a[60:63], a[220:223], 0
    global_load_dwordx4 a[12:15], v7, s[42:43] offset:1024 sc1
    v_exp_f32 v21, v21
    v_exp_f32 v22, v22
    v_exp_f32 v23, v23
    v_exp_f32 v24, v24
    v_exp_f32 v25, v25
    v_smfmac_f32_32x32x32_bf16 v[64:79], a[52:55], v[16:23], v1
    s_waitcnt vmcnt(28)
    global_load_dwordx4 a[16:19], v7, s[42:43] offset:2048 sc1
    v_exp_f32 v26, v26
    v_exp_f32 v27, v27
    v_exp_f32 v28, v28
    v_exp_f32 v29, v29
    v_smfmac_f32_16x16x64_bf16 v[108:111], v[112:115], a[224:231], v1 abid:1
    global_load_dwordx4 a[20:23], v7, s[42:43] offset:3072 sc1
    v_exp_f32 v30, v30
    v_exp_f32 v31, v31
    v_exp_f32 v32, v32
    v_exp_f32 v33, v33
    v_smfmac_f32_32x32x32_bf16 v[64:79], a[56:59], v[24:31], v1
    s_waitcnt vmcnt(15) lgkmcnt(0)
    s_barrier
    ds_read_b128 v[112:115], v6
    v_exp_f32 v34, v34
    v_exp_f32 v35, v35
    v_exp_f32 v36, v36
    v_mfma_f32_32x32x16_bf16 v[16:31], a[72:75], a[220:223], 0
    s_xor_b32 s42, s19, 114688
    global_load_dwordx4 a[24:27], v7, s[42:43] offset:-4096 sc1
    v_exp_f32 v37, v37
    v_exp_f32 v38, v38
    v_exp_f32 v39, v39
    v_exp_f32 v40, v40
    v_exp_f32 v41, v41
    v_smfmac_f32_32x32x32_bf16 v[64:79], a[64:67], v[32:39], v1
    global_load_dwordx4 a[28:31], v7, s[42:43] offset:-3072 sc1
    v_exp_f32 v42, v42
    v_exp_f32 v43, v43
    v_exp_f32 v44, v44
    v_exp_f32 v45, v45
    v_exp_f32 v46, v46
    v_exp_f32 v47, v47
    v_exp_f32 v16, v16
    v_exp_f32 v17, v17
    v_smfmac_f32_32x32x32_bf16 v[64:79], a[68:71], v[40:47], v1
    global_load_dwordx4 a[32:35], v7, s[42:43] offset:-2048 sc1
    v_exp_f32 v18, v18
    v_exp_f32 v19, v19
    v_exp_f32 v20, v20
    v_mfma_f32_32x32x16_bf16 v[32:47], a[84:87], a[220:223], 0
    global_load_dwordx4 a[36:39], v7, s[42:43] offset:-1024 sc1
    v_exp_f32 v21, v21
    v_exp_f32 v22, v22
    v_exp_f32 v23, v23
    v_exp_f32 v24, v24
    v_exp_f32 v25, v25
    v_smfmac_f32_32x32x32_bf16 v[64:79], a[76:79], v[16:23], v1
    s_waitcnt vmcnt(30) lgkmcnt(0)
    global_load_dwordx4 a[40:43], v7, s[42:43] offset:0 sc1
    v_exp_f32 v26, v26
    v_exp_f32 v27, v27
    v_exp_f32 v28, v28
    v_exp_f32 v29, v29
    v_smfmac_f32_16x16x64_bf16 v[80:83], v[112:115], a[232:239], v1 abid:1
    v_exp_f32 v30, v30
    v_exp_f32 v31, v31
    v_exp_f32 v32, v32
    v_exp_f32 v33, v33
    v_smfmac_f32_32x32x32_bf16 v[64:79], a[80:83], v[24:31], v1
    global_load_dwordx4 a[44:47], v7, s[42:43] offset:1024 sc1
    v_exp_f32 v34, v34
    v_exp_f32 v35, v35
    v_exp_f32 v36, v36
    v_mfma_f32_32x32x16_bf16 v[16:31], a[96:99], a[220:223], 0
    global_load_dwordx4 a[48:51], v7, s[42:43] offset:2048 sc1
    v_exp_f32 v37, v37
    v_exp_f32 v38, v38
    v_exp_f32 v39, v39
    v_exp_f32 v40, v40
    v_exp_f32 v41, v41
    v_smfmac_f32_32x32x32_bf16 v[64:79], a[88:91], v[32:39], v1
    s_waitcnt vmcnt(28)
    global_load_dwordx4 a[52:55], v7, s[42:43] offset:3072 sc1
    v_exp_f32 v42, v42
    v_exp_f32 v43, v43
    v_exp_f32 v44, v44
    v_exp_f32 v45, v45
    v_smfmac_f32_16x16x64_bf16 v[84:87], v[112:115], a[208:215], v1 abid:1
    s_xor_b32 s42, s19, 122880
    v_exp_f32 v46, v46
    v_exp_f32 v47, v47
    v_exp_f32 v16, v16
    v_exp_f32 v17, v17
    v_smfmac_f32_32x32x32_bf16 v[64:79], a[92:95], v[40:47], v1
    global_load_dwordx4 a[56:59], v7, s[42:43] offset:-4096 sc1
    v_exp_f32 v18, v18
    v_exp_f32 v19, v19
    v_exp_f32 v20, v20
    v_mfma_f32_32x32x16_bf16 v[32:47], a[108:111], a[220:223], 0
    global_load_dwordx4 a[60:63], v7, s[42:43] offset:-3072 sc1
    v_exp_f32 v21, v21
    v_exp_f32 v22, v22
    v_exp_f32 v23, v23
    v_exp_f32 v24, v24
    v_exp_f32 v25, v25
    v_smfmac_f32_32x32x32_bf16 v[64:79], a[100:103], v[16:23], v1
    s_waitcnt vmcnt(27)
    global_load_dwordx4 a[64:67], v7, s[42:43] offset:-2048 sc1
    v_exp_f32 v26, v26
    v_exp_f32 v27, v27
    v_exp_f32 v28, v28
    v_exp_f32 v29, v29
    v_smfmac_f32_16x16x64_bf16 v[88:91], v[112:115], a[240:247], v1 abid:1
    v_exp_f32 v30, v30
    v_exp_f32 v31, v31
    v_exp_f32 v32, v32
    v_exp_f32 v33, v33
    v_smfmac_f32_32x32x32_bf16 v[64:79], a[104:107], v[24:31], v1
    global_load_dwordx4 a[68:71], v7, s[42:43] offset:-1024 sc1
    v_exp_f32 v34, v34
    v_exp_f32 v35, v35
    v_exp_f32 v36, v36
    v_mfma_f32_32x32x16_bf16 v[16:31], a[120:123], a[220:223], 0
    global_load_dwordx4 a[72:75], v7, s[42:43] offset:0 sc1
    v_exp_f32 v37, v37
    v_exp_f32 v38, v38
    v_exp_f32 v39, v39
    v_exp_f32 v40, v40
    v_exp_f32 v41, v41
    v_smfmac_f32_32x32x32_bf16 v[64:79], a[112:115], v[32:39], v1
    s_waitcnt vmcnt(25)
    global_load_dwordx4 a[76:79], v7, s[42:43] offset:1024 sc1
    v_exp_f32 v42, v42
    v_exp_f32 v43, v43
    v_exp_f32 v44, v44
    v_exp_f32 v45, v45
    v_smfmac_f32_16x16x64_bf16 v[92:95], v[112:115], a[200:207], v1 abid:1
    v_exp_f32 v46, v46
    v_exp_f32 v47, v47
    v_exp_f32 v16, v16
    v_exp_f32 v17, v17
    v_smfmac_f32_32x32x32_bf16 v[64:79], a[116:119], v[40:47], v1
    global_load_dwordx4 a[80:83], v7, s[42:43] offset:2048 sc1
    v_exp_f32 v18, v18
    v_exp_f32 v19, v19
    v_exp_f32 v20, v20
    v_mfma_f32_32x32x16_bf16 v[32:47], a[132:135], a[220:223], 0
    global_load_dwordx4 a[84:87], v7, s[42:43] offset:3072 sc1
    v_exp_f32 v21, v21
    v_exp_f32 v22, v22
    v_exp_f32 v23, v23
    v_exp_f32 v24, v24
    v_exp_f32 v25, v25
    v_smfmac_f32_32x32x32_bf16 v[64:79], a[124:127], v[16:23], v1
    s_waitcnt vmcnt(22)
    global_load_dwordx4 v[48:51], v128, s[36:37] offset:-2048
    v_exp_f32 v26, v26
    v_exp_f32 v27, v27
    v_exp_f32 v28, v28
    v_exp_f32 v29, v29
    v_smfmac_f32_16x16x64_bf16 v[96:99], v[112:115], a[0:7], v1 abid:1
    v_exp_f32 v30, v30
    v_exp_f32 v31, v31
    v_exp_f32 v32, v32
    v_exp_f32 v33, v33
    v_smfmac_f32_32x32x32_bf16 v[64:79], a[128:131], v[24:31], v1
    global_load_dwordx4 v[52:55], v128, s[36:37] offset:2048
    v_exp_f32 v34, v34
    v_exp_f32 v35, v35
    v_exp_f32 v36, v36
    v_mfma_f32_32x32x16_bf16 v[16:31], a[144:147], a[220:223], 0
    global_load_lds_dwordx4 v7, s[44:45] offset:3072 sc1
    v_exp_f32 v37, v37
    v_exp_f32 v38, v38
    v_exp_f32 v39, v39
    v_exp_f32 v40, v40
    v_exp_f32 v41, v41
    v_smfmac_f32_32x32x32_bf16 v[64:79], a[136:139], v[32:39], v1
    s_waitcnt vmcnt(23)
    global_load_dwordx4 a[192:195], v7, s[46:47] offset:0 sc1
    v_exp_f32 v42, v42
    v_exp_f32 v43, v43
    v_exp_f32 v44, v44
    v_exp_f32 v45, v45
    v_smfmac_f32_16x16x64_bf16 v[100:103], v[112:115], a[248:255], v1 abid:1
    v_exp_f32 v46, v46
    v_exp_f32 v47, v47
    v_exp_f32 v16, v16
    v_exp_f32 v17, v17
    v_smfmac_f32_32x32x32_bf16 v[64:79], a[140:143], v[40:47], v1
    ds_read_b128 v[56:59], v129 offset:0
    ds_read_b128 v[60:63], v129 offset:16
    v_exp_f32 v18, v18
    v_exp_f32 v19, v19
    v_exp_f32 v20, v20
    v_mfma_f32_32x32x16_bf16 v[32:47], a[156:159], a[220:223], 0
    global_load_dwordx4 a[196:199], v7, s[46:47] offset:1024 sc1
    v_exp_f32 v21, v21
    v_exp_f32 v22, v22
    v_exp_f32 v23, v23
    v_exp_f32 v24, v24
    v_exp_f32 v25, v25
    v_smfmac_f32_32x32x32_bf16 v[64:79], a[148:151], v[16:23], v1
    s_waitcnt vmcnt(23)
    s_add_u32 s46, s68, 32768
    global_load_dwordx4 a[224:227], v7, s[46:47] offset:0 sc1
    v_exp_f32 v26, v26
    v_exp_f32 v27, v27
    v_exp_f32 v28, v28
    v_exp_f32 v29, v29
    v_smfmac_f32_16x16x64_bf16 v[104:107], v[112:115], a[8:15], v1 abid:1
    global_load_dwordx4 a[228:231], v7, s[46:47] offset:1024 sc1
    v_exp_f32 v30, v30
    v_exp_f32 v31, v31
    v_exp_f32 v32, v32
    v_exp_f32 v33, v33
    v_smfmac_f32_32x32x32_bf16 v[64:79], a[152:155], v[24:31], v1
    s_add_u32 s46, s69, 32768
    global_load_dwordx4 a[232:235], v7, s[46:47] offset:0 sc1
    v_exp_f32 v34, v34
    v_exp_f32 v35, v35
    v_exp_f32 v36, v36
    v_mfma_f32_32x32x16_bf16 v[16:31], a[168:171], a[220:223], 0
    global_load_dwordx4 a[236:239], v7, s[46:47] offset:1024 sc1
    v_exp_f32 v37, v37
    v_exp_f32 v38, v38
    v_exp_f32 v39, v39
    v_exp_f32 v40, v40
    v_exp_f32 v41, v41
    v_smfmac_f32_32x32x32_bf16 v[64:79], a[160:163], v[32:39], v1
    s_waitcnt vmcnt(25)
    s_add_u32 s46, s70, 32768
    global_load_dwordx4 a[208:211], v7, s[46:47] offset:0 sc1
    v_exp_f32 v42, v42
    v_exp_f32 v43, v43
    v_exp_f32 v44, v44
    v_exp_f32 v45, v45
    v_smfmac_f32_16x16x64_bf16 v[108:111], v[112:115], a[16:23], v1 abid:1
    v_exp_f32 v46, v46
    v_exp_f32 v47, v47
    v_exp_f32 v16, v16
    v_exp_f32 v17, v17
    v_smfmac_f32_32x32x32_bf16 v[64:79], a[164:167], v[40:47], v1
    global_load_dwordx4 a[212:215], v7, s[46:47] offset:1024 sc1
    v_exp_f32 v18, v18
    v_exp_f32 v19, v19
    v_exp_f32 v20, v20
    v_mfma_f32_32x32x16_bf16 v[32:47], a[180:183], a[220:223], 0
    s_add_u32 s46, s71, 32768
    global_load_dwordx4 a[240:243], v7, s[46:47] offset:0 sc1
    v_exp_f32 v21, v21
    v_exp_f32 v22, v22
    v_exp_f32 v23, v23
    v_exp_f32 v24, v24
    v_exp_f32 v25, v25
    v_smfmac_f32_32x32x32_bf16 v[64:79], a[172:175], v[16:23], v1
    global_load_dwordx4 a[244:247], v7, s[46:47] offset:1024 sc1
    v_exp_f32 v26, v26
    v_exp_f32 v27, v27
    v_exp_f32 v28, v28
    v_exp_f32 v29, v29
    v_exp_f32 v30, v30
    v_exp_f32 v31, v31
    v_exp_f32 v32, v32
    v_exp_f32 v33, v33
    v_smfmac_f32_32x32x32_bf16 v[64:79], a[176:179], v[24:31], v1
    s_add_u32 s46, s68, 40960
    global_load_dwordx4 a[200:203], v7, s[46:47] offset:0 sc1
    v_exp_f32 v34, v34
    v_exp_f32 v35, v35
    v_exp_f32 v36, v36
    v_exp_f32 v37, v37
    v_exp_f32 v38, v38
    v_exp_f32 v39, v39
    v_exp_f32 v40, v40
    v_exp_f32 v41, v41
    v_smfmac_f32_32x32x32_bf16 v[64:79], a[184:187], v[32:39], v1
    global_load_dwordx4 a[204:207], v7, s[46:47] offset:1024 sc1
    v_exp_f32 v42, v42
    v_exp_f32 v43, v43
    v_exp_f32 v44, v44
    v_exp_f32 v45, v45
    v_exp_f32 v46, v46
    v_exp_f32 v47, v47
    s_waitcnt vmcnt(13)
    v_lshlrev_b32 v16, 16, v48
    v_and_b32 v17, 0xffff0000, v48
    v_smfmac_f32_32x32x32_bf16 v[64:79], a[188:191], v[40:47], v1
    v_lshlrev_b32 v18, 16, v49
    v_and_b32 v19, 0xffff0000, v49
    v_lshlrev_b32 v20, 16, v50
    v_and_b32 v21, 0xffff0000, v50
    v_lshlrev_b32 v22, 16, v51
    v_and_b32 v23, 0xffff0000, v51
    v_lshlrev_b32 v24, 16, v52
    v_and_b32 v25, 0xffff0000, v52
    v_lshlrev_b32 v26, 16, v53
    v_and_b32 v27, 0xffff0000, v53
    v_lshlrev_b32 v28, 16, v54
    v_and_b32 v29, 0xffff0000, v54
    ds_write2st64_b64 v3, v[64:65], v[66:67] offset0:0 offset1:1
    ds_write2st64_b64 v3, v[68:69], v[70:71] offset0:2 offset1:3
    ds_write_b32 v3, v72 offset:2048
    v_lshlrev_b32 v30, 16, v55
    v_and_b32 v31, 0xffff0000, v55
    s_add_u32 s46, s69, 40960
    global_load_dwordx4 a[248:251], v7, s[46:47] offset:0 sc1
    global_load_dwordx4 a[252:255], v7, s[46:47] offset:1024 sc1
    s_waitcnt lgkmcnt(0)
    s_barrier
    ds_read2st64_b32 v[124:125], v2 offset0:8 offset1:24
    ds_read2st64_b32 v[126:127], v2 offset0:40 offset1:56
    ds_read2st64_b64 v[116:119], v4 offset0:0 offset1:8
    ds_read2st64_b64 v[120:123], v4 offset0:16 offset1:24
    ds_read_b128 v[32:35], v129 offset:2048
    ds_read_b128 v[36:39], v129 offset:2064
    ds_read_b128 v[40:43], v129 offset:4096
    ds_read_b128 v[44:47], v129 offset:4112
    s_add_u32 s46, s70, 40960
    global_load_dwordx4 a[160:163], v7, s[46:47] offset:0 sc1
    global_load_dwordx4 a[164:167], v7, s[46:47] offset:1024 sc1
    s_add_u32 s46, s71, 40960
    global_load_dwordx4 a[168:171], v7, s[46:47] offset:0 sc1
    s_waitcnt lgkmcnt(6)
    v_pk_add_f32 v[124:125], v[124:125], v[126:127]
    v_add_f32 v124, v124, v125
    v_rcp_f32 v126, v124
    s_waitcnt lgkmcnt(4)
    v_pk_add_f32 v[116:117], v[116:117], v[118:119]
    v_pk_add_f32 v[120:121], v[120:121], v[122:123]
    v_pk_add_f32 v[116:117], v[116:117], v[120:121]
    v_pk_mul_f32 v[116:117], v[116:117], v[126:127] op_sel_hi:[1,0]
    v_cvt_pk_bf16_f32 v118, v116, v117
    ds_write_b32 v5, v118
    v_add_f32 v124, v124, v126
    v_cmp_ngt_f32 vcc, 0x5f800000, v124
    global_load_dwordx4 a[172:175], v7, s[46:47] offset:1024 sc1
    s_add_u32 s46, s68, 49152
    global_load_dwordx4 a[176:179], v7, s[46:47] offset:0 sc1
    s_or_b64 s[6:7], s[6:7], vcc
    s_waitcnt lgkmcnt(0)
    s_barrier
    ds_read_b128 v[112:115], v6
    global_load_dwordx4 a[180:183], v7, s[46:47] offset:1024 sc1
    s_add_u32 s46, s69, 49152
    global_load_dwordx4 a[184:187], v7, s[46:47] offset:0 sc1
    global_load_dwordx4 a[188:191], v7, s[46:47] offset:1024 sc1
    s_waitcnt vmcnt(25) lgkmcnt(0)
    v_smfmac_f32_16x16x64_bf16 v[80:83], v[112:115], a[24:31], v1 abid:1
    v_smfmac_f32_16x16x64_bf16 v[84:87], v[112:115], a[32:39], v1 abid:1
    v_smfmac_f32_16x16x64_bf16 v[88:91], v[112:115], a[40:47], v1 abid:1
    v_smfmac_f32_16x16x64_bf16 v[92:95], v[112:115], a[48:55], v1 abid:1
    v_smfmac_f32_16x16x64_bf16 v[96:99], v[112:115], a[56:63], v1 abid:1
    v_smfmac_f32_16x16x64_bf16 v[100:103], v[112:115], a[64:71], v1 abid:1
    v_smfmac_f32_16x16x64_bf16 v[104:107], v[112:115], a[72:79], v1 abid:1
    v_smfmac_f32_16x16x64_bf16 v[108:111], v[112:115], a[80:87], v1 abid:1
L_epi:
    s_nop 0
    v_permlane32_swap_b32 v80, v82
    v_permlane32_swap_b32 v81, v83
    v_permlane32_swap_b32 v84, v86
    v_permlane32_swap_b32 v85, v87
    v_permlane32_swap_b32 v88, v90
    v_permlane32_swap_b32 v89, v91
    v_permlane32_swap_b32 v92, v94
    v_permlane32_swap_b32 v93, v95
    v_permlane32_swap_b32 v96, v98
    v_permlane32_swap_b32 v97, v99
    v_permlane32_swap_b32 v100, v102
    v_permlane32_swap_b32 v101, v103
    v_permlane32_swap_b32 v104, v106
    v_permlane32_swap_b32 v105, v107
    v_permlane32_swap_b32 v108, v110
    v_permlane32_swap_b32 v109, v111
    v_add_f32 v64, v80, v82
    v_add_f32 v65, v84, v86
    v_add_f32 v66, v88, v90
    v_add_f32 v67, v92, v94
    v_add_f32 v68, v96, v98
    v_add_f32 v69, v100, v102
    v_add_f32 v70, v104, v106
    v_add_f32 v71, v108, v110
    v_add_f32 v72, v81, v83
    v_add_f32 v73, v85, v87
    v_add_f32 v74, v89, v91
    v_add_f32 v75, v93, v95
    v_add_f32 v76, v97, v99
    v_add_f32 v77, v101, v103
    v_add_f32 v78, v105, v107
    v_add_f32 v79, v109, v111
    v_pk_fma_f32 v[16:17], v[64:65], v[56:57], v[16:17]
    v_pk_fma_f32 v[18:19], v[66:67], v[58:59], v[18:19]
    v_pk_fma_f32 v[20:21], v[68:69], v[60:61], v[20:21]
    v_pk_fma_f32 v[22:23], v[70:71], v[62:63], v[22:23]
    v_pk_fma_f32 v[24:25], v[72:73], v[56:57], v[24:25]
    v_pk_fma_f32 v[26:27], v[74:75], v[58:59], v[26:27]
    v_pk_fma_f32 v[28:29], v[76:77], v[60:61], v[28:29]
    v_pk_fma_f32 v[30:31], v[78:79], v[62:63], v[30:31]
    v_cvt_pk_bf16_f32 v104, v16, v17
    v_cvt_pk_bf16_f32 v105, v18, v19
    v_cvt_pk_bf16_f32 v106, v20, v21
    v_cvt_pk_bf16_f32 v107, v22, v23
    v_cvt_pk_bf16_f32 v108, v24, v25
    v_cvt_pk_bf16_f32 v109, v26, v27
    v_cvt_pk_bf16_f32 v110, v28, v29
    v_cvt_pk_bf16_f32 v111, v30, v31
    s_mov_b32 s33, 0x3f803f80
    v_dot2_f32_bf16 v80, v104, s33, 0
    v_dot2_f32_bf16 v81, v104, v104, 0
    v_dot2_f32_bf16 v82, v108, s33, 0
    v_dot2_f32_bf16 v83, v108, v108, 0
    v_dot2_f32_bf16 v80, v105, s33, v80
    v_dot2_f32_bf16 v81, v105, v105, v81
    v_dot2_f32_bf16 v82, v109, s33, v82
    v_dot2_f32_bf16 v83, v109, v109, v83
    v_dot2_f32_bf16 v80, v106, s33, v80
    v_dot2_f32_bf16 v81, v106, v106, v81
    v_dot2_f32_bf16 v82, v110, s33, v82
    v_dot2_f32_bf16 v83, v110, v110, v83
    v_dot2_f32_bf16 v80, v107, s33, v80
    v_dot2_f32_bf16 v81, v107, v107, v81
    v_dot2_f32_bf16 v82, v111, s33, v82
    v_dot2_f32_bf16 v83, v111, v111, v83
    v_add_f32_dpp v80, v80, v80 row_ror:1 row_mask:0xf bank_mask:0xf
    v_add_f32_dpp v81, v81, v81 row_ror:1 row_mask:0xf bank_mask:0xf
    v_add_f32_dpp v82, v82, v82 row_ror:1 row_mask:0xf bank_mask:0xf
    v_add_f32_dpp v83, v83, v83 row_ror:1 row_mask:0xf bank_mask:0xf
    v_add_f32_dpp v80, v80, v80 row_ror:2 row_mask:0xf bank_mask:0xf
    v_add_f32_dpp v81, v81, v81 row_ror:2 row_mask:0xf bank_mask:0xf
    v_add_f32_dpp v82, v82, v82 row_ror:2 row_mask:0xf bank_mask:0xf
    v_add_f32_dpp v83, v83, v83 row_ror:2 row_mask:0xf bank_mask:0xf
    v_add_f32_dpp v80, v80, v80 row_ror:4 row_mask:0xf bank_mask:0xf
    v_add_f32_dpp v81, v81, v81 row_ror:4 row_mask:0xf bank_mask:0xf
    v_add_f32_dpp v82, v82, v82 row_ror:4 row_mask:0xf bank_mask:0xf
    v_add_f32_dpp v83, v83, v83 row_ror:4 row_mask:0xf bank_mask:0xf
    v_add_f32_dpp v80, v80, v80 row_ror:8 row_mask:0xf bank_mask:0xf
    v_add_f32_dpp v81, v81, v81 row_ror:8 row_mask:0xf bank_mask:0xf
    v_add_f32_dpp v82, v82, v82 row_ror:8 row_mask:0xf bank_mask:0xf
    v_add_f32_dpp v83, v83, v83 row_ror:8 row_mask:0xf bank_mask:0xf
    ds_write_b128 v132, v[80:83]
    v_lshlrev_b32 v16, 16, v104
    v_and_b32 v17, 0xffff0000, v104
    v_lshlrev_b32 v18, 16, v105
    v_and_b32 v19, 0xffff0000, v105
    v_lshlrev_b32 v20, 16, v106
    v_and_b32 v21, 0xffff0000, v106
    v_lshlrev_b32 v22, 16, v107
    v_and_b32 v23, 0xffff0000, v107
    s_waitcnt vmcnt(22) lgkmcnt(0)
    s_barrier
    ds_read_b128 v[84:87], v133 offset:0
    ds_read_b128 v[88:91], v133 offset:16
    ds_read_b128 v[92:95], v133 offset:32
    ds_read_b128 v[96:99], v133 offset:48
    v_lshlrev_b32 v24, 16, v108
    v_and_b32 v25, 0xffff0000, v108
    v_lshlrev_b32 v26, 16, v109
    v_and_b32 v27, 0xffff0000, v109
    v_lshlrev_b32 v28, 16, v110
    v_and_b32 v29, 0xffff0000, v110
    v_lshlrev_b32 v30, 16, v111
    v_and_b32 v31, 0xffff0000, v111
    s_and_b32 s13, s66, 0x7000
    s_add_u32 s33, s67, 131072
    s_add_u32 s44, s13, s33
    s_mov_b32 m0, s15
    s_waitcnt lgkmcnt(2)
    v_pk_add_f32 v[84:85], v[84:85], v[88:89]
    v_pk_add_f32 v[86:87], v[86:87], v[90:91]
    s_waitcnt lgkmcnt(0)
    v_pk_add_f32 v[92:93], v[92:93], v[96:97]
    v_pk_add_f32 v[94:95], v[94:95], v[98:99]
    v_pk_add_f32 v[84:85], v[84:85], v[92:93]
    v_pk_add_f32 v[86:87], v[86:87], v[94:95]
    v_mul_f32 v84, 0x3b000000, v84
    v_mul_f32 v86, 0x3b000000, v86
    v_cmp_u_f32 vcc, v85, v87
    v_mul_f32 v85, 0x3b000000, v85
    v_mul_f32 v87, 0x3b000000, v87
    s_or_b64 vcc, vcc, s[6:7]
    v_fma_f32 v85, -v84, v84, v85
    v_fma_f32 v87, -v86, v86, v87
    s_and_b64 vcc, vcc, s[30:31]
    v_max_f32 v85, 0, v85
    v_max_f32 v87, 0, v87
    v_add_f32 v85, 0x3727c5ac, v85
    v_add_f32 v87, 0x3727c5ac, v87
    v_rsq_f32 v88, v85
    v_rsq_f32 v92, v87
    s_cbranch_scc1 L_slow
    v_mul_f32 v90, -v84, v88
    v_mul_f32 v94, -v86, v92
    v_pk_fma_f32 v[16:17], v[16:17], v[88:89], v[90:91] op_sel_hi:[1,0,0]
    v_pk_fma_f32 v[18:19], v[18:19], v[88:89], v[90:91] op_sel_hi:[1,0,0]
    v_pk_fma_f32 v[20:21], v[20:21], v[88:89], v[90:91] op_sel_hi:[1,0,0]
    v_pk_fma_f32 v[22:23], v[22:23], v[88:89], v[90:91] op_sel_hi:[1,0,0]
    v_pk_fma_f32 v[16:17], v[16:17], v[40:41], v[32:33]
    v_pk_fma_f32 v[18:19], v[18:19], v[42:43], v[34:35]
    v_pk_fma_f32 v[20:21], v[20:21], v[44:45], v[36:37]
    v_pk_fma_f32 v[22:23], v[22:23], v[46:47], v[38:39]
    v_cvt_pk_bf16_f32 v64, v16, v17
    v_cvt_pk_bf16_f32 v65, v18, v19
    v_cvt_pk_bf16_f32 v66, v20, v21
    v_cvt_pk_bf16_f32 v67, v22, v23
    s_cmp_lg_u32 s0, 0
    s_cbranch_scc1 L_d0
    global_store_dwordx4 v131, v[64:67], s[62:63] offset:0
L_d0_b:
    v_pk_fma_f32 v[24:25], v[24:25], v[92:93], v[94:95] op_sel_hi:[1,0,0]
    v_pk_fma_f32 v[26:27], v[26:27], v[92:93], v[94:95] op_sel_hi:[1,0,0]
    v_pk_fma_f32 v[28:29], v[28:29], v[92:93], v[94:95] op_sel_hi:[1,0,0]
    v_pk_fma_f32 v[30:31], v[30:31], v[92:93], v[94:95] op_sel_hi:[1,0,0]
    v_pk_fma_f32 v[24:25], v[24:25], v[40:41], v[32:33]
    v_pk_fma_f32 v[26:27], v[26:27], v[42:43], v[34:35]
    v_pk_fma_f32 v[28:29], v[28:29], v[44:45], v[36:37]
    v_pk_fma_f32 v[30:31], v[30:31], v[46:47], v[38:39]
    v_cvt_pk_bf16_f32 v68, v24, v25
    v_cvt_pk_bf16_f32 v69, v26, v27
    v_cvt_pk_bf16_f32 v70, v28, v29
    v_cvt_pk_bf16_f32 v71, v30, v31
    s_cmp_lg_u32 s0, 0
    s_cbranch_scc1 L_d1
    global_store_dwordx4 v131, v[68:71], s[62:63] offset:256
L_d1_b:
    v_add_u32 v6, 0x10000, v7
    v_add_u32 v9, 0x20000, v7
    v_and_b32 v1, 0xc0, v7
    v_lshrrev_b32 v0, 8, v7
    v_and_b32 v2, 0x30, v7
    v_lshl_add_u32 v1, v1, 2, v2
    v_lshl_add_u32 v1, v0, 6, v1
    v_and_b32 v3, 0x200, v7
L_w7:
    s_cbranch_execz L_wb_B2
    v_add3_u32 v3, v3, v7, s98
    v_xor_b32 v4, 512, v3
    v_xor_b32 v8, 114688, v3
    v_xor_b32 v10, 115200, v3
    v_lshl_add_u32 v5, s15, 3, v7
    v_add_u32 v14, 49152, v5
    v_xor_b32 v11, 0x8000, v5
    v_xor_b32 v12, 0x10000, v5
    v_xor_b32 v13, 0x18000, v5
    v_and_b32 v2, 0xf0, v7
    v_lshl_add_u32 v15, v0, 12, s99
    v_add_u32 v0, s100, v2
    v_lshrrev_b32 v2, 1, v2
    v_add_u32 v15, v2, v15
    ds_read_b128 a[128:131], v7 offset:32768
    ds_read_b128 a[132:135], v6 offset:0
    ds_read_b128 a[136:139], v6 offset:32768
    ds_read_b128 a[140:143], v9 offset:0
    ds_read_b128 a[144:147], v7 offset:33792
    ds_read_b128 a[148:151], v6 offset:1024
L_h0:
    s_xor_b32 s48, s96, 0
    global_load_dwordx4 a[0:3], v1, s[48:49] offset:0 sc1
    global_load_dwordx4 a[4:7], v1, s[48:49] offset:1024 sc1
    global_load_dwordx4 a[8:11], v1, s[48:49] offset:2048 sc1
    global_load_dwordx4 a[12:15], v1, s[48:49] offset:3072 sc1
    s_xor_b32 s48, s96, 4096
    global_load_dwordx4 a[16:19], v1, s[48:49] offset:0 sc1
    global_load_dwordx4 a[20:23], v1, s[48:49] offset:1024 sc1
    global_load_dwordx4 a[24:27], v1, s[48:49] offset:2048 sc1
    global_load_dwordx4 a[28:31], v1, s[48:49] offset:3072 sc1
    s_sub_u32 s74, s74, 1
    s_cselect_b32 s74, 0, s74
    s_cselect_b64 s[34:35], 0, -1
    s_mov_b64 exec, 0
    s_branch L_w8
L_wb_C:
    s_mov_b64 exec, -1
    s_waitcnt vmcnt(4)
    v_accvgpr_read_b32 v112, a0
    v_accvgpr_read_b32 v113, a4
    v_accvgpr_read_b32 v114, a8
    v_accvgpr_read_b32 v115, a12
    v_max3_u32 v112, v112, v113, v114
    v_max_u32 v112, v112, v115
    v_cmp_eq_u32 vcc, -1, v112
    s_nop 0
    s_and_b64 vcc, vcc, s[34:35]
    s_cbranch_scc1 L_h0
    s_waitcnt lgkmcnt(5)
    v_mfma_f32_16x16x32_bf16 v[16:19], a[128:131], a[0:3], 0
    s_waitcnt lgkmcnt(4)
    ds_read_b128 a[152:155], v6 offset:33792
    v_mfma_f32_16x16x32_bf16 v[20:23], a[128:131], a[4:7], 0
    s_xor_b32 s48, s96, 8192
    global_load_dwordx4 a[32:35], v1, s[48:49] offset:0 sc1
    v_mfma_f32_16x16x32_bf16 v[32:35], a[132:135], a[0:3], 0
    s_waitcnt lgkmcnt(4)
    ds_read_b128 a[156:159], v9 offset:1024
    v_mfma_f32_16x16x32_bf16 v[36:39], a[132:135], a[4:7], 0
    v_mfma_f32_16x16x32_bf16 v[48:51], a[136:139], a[0:3], 0
    s_waitcnt lgkmcnt(4)
    ds_read_b128 a[128:131], v7 offset:34816
    global_load_dwordx4 a[36:39], v1, s[48:49] offset:1024 sc1
    v_mfma_f32_16x16x32_bf16 v[52:55], a[136:139], a[4:7], 0
    v_mfma_f32_16x16x32_bf16 v[64:67], a[140:143], a[0:3], 0
    s_waitcnt lgkmcnt(4)
    ds_read_b128 a[132:135], v6 offset:2048
    v_mfma_f32_16x16x32_bf16 v[68:71], a[140:143], a[4:7], 0
    v_mfma_f32_16x16x32_bf16 v[24:27], a[144:147], a[0:3], 0
    s_waitcnt lgkmcnt(4)
    ds_read_b128 a[136:139], v6 offset:34816
    global_load_dwordx4 a[40:43], v1, s[48:49] offset:2048 sc1
    v_mfma_f32_16x16x32_bf16 v[28:31], a[144:147], a[4:7], 0
    v_mfma_f32_16x16x32_bf16 v[40:43], a[148:151], a[0:3], 0
    s_waitcnt lgkmcnt(4)
    ds_read_b128 a[140:143], v9 offset:2048
    v_mfma_f32_16x16x32_bf16 v[44:47], a[148:151], a[4:7], 0
    v_mfma_f32_16x16x32_bf16 v[56:59], a[152:155], a[0:3], 0
    s_waitcnt lgkmcnt(4)
    ds_read_b128 a[144:147], v7 offset:35840
    global_load_dwordx4 a[44:47], v1, s[48:49] offset:3072 sc1
    v_mfma_f32_16x16x32_bf16 v[60:63], a[152:155], a[4:7], 0
    v_mfma_f32_16x16x32_bf16 v[72:75], a[156:159], a[0:3], 0
    s_waitcnt lgkmcnt(4)
    ds_read_b128 a[148:151], v6 offset:3072
    v_mfma_f32_16x16x32_bf16 v[76:79], a[156:159], a[4:7], 0
    v_mfma_f32_16x16x32_bf16 v[16:19], a[128:131], a[8:11], v[16:19]
    s_waitcnt lgkmcnt(4)
    ds_read_b128 a[152:155], v6 offset:35840
    v_mfma_f32_16x16x32_bf16 v[20:23], a[128:131], a[12:15], v[20:23]
    s_xor_b32 s48, s96, 12288
    global_load_dwordx4 a[48:51], v1, s[48:49] offset:0 sc1
    v_mfma_f32_16x16x32_bf16 v[32:35], a[132:135], a[8:11], v[32:35]
    s_waitcnt lgkmcnt(4)
    ds_read_b128 a[156:159], v9 offset:3072
    v_mfma_f32_16x16x32_bf16 v[36:39], a[132:135], a[12:15], v[36:39]
    v_mfma_f32_16x16x32_bf16 v[48:51], a[136:139], a[8:11], v[48:51]
    s_waitcnt lgkmcnt(4)
    ds_read_b128 a[128:131], v7 offset:36864
    global_load_dwordx4 a[52:55], v1, s[48:49] offset:1024 sc1
    v_mfma_f32_16x16x32_bf16 v[52:55], a[136:139], a[12:15], v[52:55]
    v_mfma_f32_16x16x32_bf16 v[64:67], a[140:143], a[8:11], v[64:67]
    s_waitcnt lgkmcnt(4)
    ds_read_b128 a[132:135], v6 offset:4096
    v_mfma_f32_16x16x32_bf16 v[68:71], a[140:143], a[12:15], v[68:71]
    v_mfma_f32_16x16x32_bf16 v[24:27], a[144:147], a[8:11], v[24:27]
    s_waitcnt vmcnt(6) lgkmcnt(4)
    ds_read_b128 a[136:139], v6 offset:36864
    v_accvgpr_read_b32 v112, a16
    v_mfma_f32_16x16x32_bf16 v[28:31], a[144:147], a[12:15], v[28:31]
    v_accvgpr_read_b32 v113, a20
    v_accvgpr_read_b32 v114, a24
    v_mfma_f32_16x16x32_bf16 v[40:43], a[148:151], a[8:11], v[40:43]
    s_waitcnt lgkmcnt(4)
    ds_read_b128 a[140:143], v9 offset:4096
    global_load_dwordx4 a[56:59], v1, s[48:49] offset:2048 sc1
    v_mfma_f32_16x16x32_bf16 v[44:47], a[148:151], a[12:15], v[44:47]
    v_accvgpr_read_b32 v115, a28
    v_max3_u32 v112, v112, v113, v114
    v_mfma_f32_16x16x32_bf16 v[56:59], a[152:155], a[8:11], v[56:59]
    s_waitcnt lgkmcnt(4)
    ds_read_b128 a[144:147], v7 offset:37888
    v_max_u32 v112, v112, v115
    v_mfma_f32_16x16x32_bf16 v[60:63], a[152:155], a[12:15], v[60:63]
    v_cmp_eq_u32 vcc, -1, v112
    v_mfma_f32_16x16x32_bf16 v[72:75], a[156:159], a[8:11], v[72:75]
    s_waitcnt lgkmcnt(4)
    s_cbranch_vccnz L_h1_r
L_h1_ok:
    ds_read_b128 a[148:151], v6 offset:5120
    global_load_dwordx4 a[60:63], v1, s[48:49] offset:3072 sc1
    v_mfma_f32_16x16x32_bf16 v[76:79], a[156:159], a[12:15], v[76:79]
    v_mfma_f32_16x16x32_bf16 v[16:19], a[128:131], a[16:19], v[16:19]
    s_waitcnt lgkmcnt(4)
    ds_read_b128 a[152:155], v6 offset:37888
    v_mfma_f32_16x16x32_bf16 v[20:23], a[128:131], a[20:23], v[20:23]
    v_mfma_f32_16x16x32_bf16 v[32:35], a[132:135], a[16:19], v[32:35]
    s_waitcnt lgkmcnt(4)
    ds_read_b128 a[156:159], v9 offset:5120
    v_mfma_f32_16x16x32_bf16 v[36:39], a[132:135], a[20:23], v[36:39]
    s_xor_b32 s48, s96, 16384
    global_load_dwordx4 a[64:67], v1, s[48:49] offset:0 sc1
    v_mfma_f32_16x16x32_bf16 v[48:51], a[136:139], a[16:19], v[48:51]
    s_waitcnt lgkmcnt(4)
    ds_read_b128 a[128:131], v7 offset:38912
    v_mfma_f32_16x16x32_bf16 v[52:55], a[136:139], a[20:23], v[52:55]
    v_mfma_f32_16x16x32_bf16 v[64:67], a[140:143], a[16:19], v[64:67]
    s_waitcnt lgkmcnt(4)
    ds_read_b128 a[132:135], v6 offset:6144
    global_load_dwordx4 a[68:71], v1, s[48:49] offset:1024 sc1
    v_mfma_f32_16x16x32_bf16 v[68:71], a[140:143], a[20:23], v[68:71]
    v_mfma_f32_16x16x32_bf16 v[24:27], a[144:147], a[16:19], v[24:27]
    s_waitcnt lgkmcnt(4)
    ds_read_b128 a[136:139], v6 offset:38912
    v_mfma_f32_16x16x32_bf16 v[28:31], a[144:147], a[20:23], v[28:31]
    v_mfma_f32_16x16x32_bf16 v[40:43], a[148:151], a[16:19], v[40:43]
    s_waitcnt lgkmcnt(4)
    ds_read_b128 a[140:143], v9 offset:6144
    global_load_dwordx4 a[72:75], v1, s[48:49] offset:2048 sc1
    v_mfma_f32_16x16x32_bf16 v[44:47], a[148:151], a[20:23], v[44:47]
    v_mfma_f32_16x16x32_bf16 v[56:59], a[152:155], a[16:19], v[56:59]
    s_waitcnt lgkmcnt(4)
    ds_read_b128 a[144:147], v7 offset:39936
    v_mfma_f32_16x16x32_bf16 v[60:63], a[152:155], a[20:23], v[60:63]
    v_mfma_f32_16x16x32_bf16 v[72:75], a[156:159], a[16:19], v[72:75]
    s_waitcnt lgkmcnt(4)
    ds_read_b128 a[148:151], v6 offset:7168
    global_load_dwordx4 a[76:79], v1, s[48:49] offset:3072 sc1
    v_mfma_f32_16x16x32_bf16 v[76:79], a[156:159], a[20:23], v[76:79]
    v_mfma_f32_16x16x32_bf16 v[16:19], a[128:131], a[24:27], v[16:19]
    s_waitcnt lgkmcnt(4)
    ds_read_b128 a[152:155], v6 offset:39936
    v_mfma_f32_16x16x32_bf16 v[20:23], a[128:131], a[28:31], v[20:23]
    v_mfma_f32_16x16x32_bf16 v[32:35], a[132:135], a[24:27], v[32:35]
    s_waitcnt lgkmcnt(4)
    ds_read_b128 a[156:159], v9 offset:7168
    s_cmp_lg_u32 s0, 0
    s_cbranch_scc1 L_dx0
    global_store_dwordx4 v128, v[104:107], s[58:59] offset:-2048
L_dx0_b:
    v_mfma_f32_16x16x32_bf16 v[36:39], a[132:135], a[28:31], v[36:39]
    v_mfma_f32_16x16x32_bf16 v[48:51], a[136:139], a[24:27], v[48:51]
    s_waitcnt lgkmcnt(4)
    ds_read_b128 a[128:131], v7 offset:40960
    v_mfma_f32_16x16x32_bf16 v[52:55], a[136:139], a[28:31], v[52:55]
    v_mfma_f32_16x16x32_bf16 v[64:67], a[140:143], a[24:27], v[64:67]
    s_waitcnt lgkmcnt(4)
    ds_read_b128 a[132:135], v6 offset:8192
    s_cmp_lg_u32 s0, 0
    s_cbranch_scc1 L_dx1
    global_store_dwordx4 v128, v[108:111], s[58:59] offset:2048
L_dx1_b:
    v_mfma_f32_16x16x32_bf16 v[68:71], a[140:143], a[28:31], v[68:71]
    v_mfma_f32_16x16x32_bf16 v[24:27], a[144:147], a[24:27], v[24:27]
    s_waitcnt vmcnt(10) lgkmcnt(4)
    ds_read_b128 a[136:139], v6 offset:40960
    v_accvgpr_read_b32 v112, a32
    v_mfma_f32_16x16x32_bf16 v[28:31], a[144:147], a[28:31], v[28:31]
    v_accvgpr_read_b32 v113, a36
    v_accvgpr_read_b32 v114, a40
    v_mfma_f32_16x16x32_bf16 v[40:43], a[148:151], a[24:27], v[40:43]
    s_waitcnt lgkmcnt(4)
    ds_read_b128 a[140:143], v9 offset:8192
    global_load_lds_dwordx4 v7, s[44:45] offset:0 sc1
    v_mfma_f32_16x16x32_bf16 v[44:47], a[148:151], a[28:31], v[44:47]
    v_accvgpr_read_b32 v115, a44
    v_max3_u32 v112, v112, v113, v114
    v_mfma_f32_16x16x32_bf16 v[56:59], a[152:155], a[24:27], v[56:59]
    s_waitcnt lgkmcnt(4)
    ds_read_b128 a[144:147], v7 offset:41984
    v_max_u32 v112, v112, v115
    v_mfma_f32_16x16x32_bf16 v[60:63], a[152:155], a[28:31], v[60:63]
    v_cmp_eq_u32 vcc, -1, v112
    v_mfma_f32_16x16x32_bf16 v[72:75], a[156:159], a[24:27], v[72:75]
    s_waitcnt lgkmcnt(4)
    s_cbranch_vccnz L_h2_r
L_h2_ok:
    ds_read_b128 a[148:151], v6 offset:9216
    v_mfma_f32_16x16x32_bf16 v[76:79], a[156:159], a[28:31], v[76:79]
    s_xor_b32 s48, s96, 20480
    global_load_dwordx4 a[80:83], v1, s[48:49] offset:0 sc1
    v_mfma_f32_16x16x32_bf16 v[16:19], a[128:131], a[32:35], v[16:19]
    s_waitcnt lgkmcnt(4)
    ds_read_b128 a[152:155], v6 offset:41984
    v_mfma_f32_16x16x32_bf16 v[20:23], a[128:131], a[36:39], v[20:23]
    v_mfma_f32_16x16x32_bf16 v[32:35], a[132:135], a[32:35], v[32:35]
    s_waitcnt lgkmcnt(4)
    ds_read_b128 a[156:159], v9 offset:9216
    global_load_lds_dwordx4 v7, s[44:45] offset:1024 sc1
    v_mfma_f32_16x16x32_bf16 v[36:39], a[132:135], a[36:39], v[36:39]
    v_mfma_f32_16x16x32_bf16 v[48:51], a[136:139], a[32:35], v[48:51]
    s_waitcnt lgkmcnt(4)
    ds_read_b128 a[128:131], v7 offset:43008
    v_mfma_f32_16x16x32_bf16 v[52:55], a[136:139], a[36:39], v[52:55]
    v_mfma_f32_16x16x32_bf16 v[64:67], a[140:143], a[32:35], v[64:67]
    s_waitcnt lgkmcnt(4)
    ds_read_b128 a[132:135], v6 offset:10240
    global_load_dwordx4 a[84:87], v1, s[48:49] offset:1024 sc1
    v_mfma_f32_16x16x32_bf16 v[68:71], a[140:143], a[36:39], v[68:71]
    v_mfma_f32_16x16x32_bf16 v[24:27], a[144:147], a[32:35], v[24:27]
    s_waitcnt lgkmcnt(4)
    ds_read_b128 a[136:139], v6 offset:43008
    v_mfma_f32_16x16x32_bf16 v[28:31], a[144:147], a[36:39], v[28:31]
    v_mfma_f32_16x16x32_bf16 v[40:43], a[148:151], a[32:35], v[40:43]
    s_waitcnt lgkmcnt(4)
    ds_read_b128 a[140:143], v9 offset:10240
    global_load_lds_dwordx4 v7, s[44:45] offset:2048 sc1
    v_mfma_f32_16x16x32_bf16 v[44:47], a[148:151], a[36:39], v[44:47]
    v_mfma_f32_16x16x32_bf16 v[56:59], a[152:155], a[32:35], v[56:59]
    s_waitcnt lgkmcnt(4)
    ds_read_b128 a[144:147], v7 offset:44032
    v_mfma_f32_16x16x32_bf16 v[60:63], a[152:155], a[36:39], v[60:63]
    v_mfma_f32_16x16x32_bf16 v[72:75], a[156:159], a[32:35], v[72:75]
    s_waitcnt lgkmcnt(4)
    ds_read_b128 a[148:151], v6 offset:11264
    global_load_dwordx4 a[88:91], v1, s[48:49] offset:2048 sc1
    v_mfma_f32_16x16x32_bf16 v[76:79], a[156:159], a[36:39], v[76:79]
    v_mfma_f32_16x16x32_bf16 v[16:19], a[128:131], a[40:43], v[16:19]
    s_waitcnt lgkmcnt(4)
    ds_read_b128 a[152:155], v6 offset:44032
    v_mfma_f32_16x16x32_bf16 v[20:23], a[128:131], a[44:47], v[20:23]
    v_mfma_f32_16x16x32_bf16 v[32:35], a[132:135], a[40:43], v[32:35]
    s_waitcnt lgkmcnt(4)
    ds_read_b128 a[156:159], v9 offset:11264
    global_load_lds_dwordx4 v7, s[44:45] offset:3072 sc1
    v_mfma_f32_16x16x32_bf16 v[36:39], a[132:135], a[44:47], v[36:39]
    v_mfma_f32_16x16x32_bf16 v[48:51], a[136:139], a[40:43], v[48:51]
    s_waitcnt lgkmcnt(4)
    ds_read_b128 a[128:131], v7 offset:45056
    v_mfma_f32_16x16x32_bf16 v[52:55], a[136:139], a[44:47], v[52:55]
    v_mfma_f32_16x16x32_bf16 v[64:67], a[140:143], a[40:43], v[64:67]
    s_waitcnt lgkmcnt(4)
    ds_read_b128 a[132:135], v6 offset:12288
    global_load_dwordx4 a[92:95], v1, s[48:49] offset:3072 sc1
    v_mfma_f32_16x16x32_bf16 v[68:71], a[140:143], a[44:47], v[68:71]
    s_add_u32 m0, s15, 16384
    v_mfma_f32_16x16x32_bf16 v[24:27], a[144:147], a[40:43], v[24:27]
    s_waitcnt vmcnt(14) lgkmcnt(4)
    ds_read_b128 a[136:139], v6 offset:45056
    v_accvgpr_read_b32 v112, a48
    v_mfma_f32_16x16x32_bf16 v[28:31], a[144:147], a[44:47], v[28:31]
    s_xor_b32 s13, s13, 16384
    v_accvgpr_read_b32 v113, a52
    v_accvgpr_read_b32 v114, a56
    v_mfma_f32_16x16x32_bf16 v[40:43], a[148:151], a[40:43], v[40:43]
    s_waitcnt lgkmcnt(4)
    ds_read_b128 a[140:143], v9 offset:12288
    v_accvgpr_read_b32 v115, a60
    v_mfma_f32_16x16x32_bf16 v[44:47], a[148:151], a[44:47], v[44:47]
    s_add_u32 s44, s13, s33
    global_load_lds_dwordx4 v7, s[44:45] offset:0 sc1
    v_max3_u32 v112, v112, v113, v114
    v_mfma_f32_16x16x32_bf16 v[56:59], a[152:155], a[40:43], v[56:59]
    s_waitcnt lgkmcnt(4)
    ds_read_b128 a[144:147], v7 offset:46080
    v_max_u32 v112, v112, v115
    v_mfma_f32_16x16x32_bf16 v[60:63], a[152:155], a[44:47], v[60:63]
    v_cmp_eq_u32 vcc, -1, v112
    v_mfma_f32_16x16x32_bf16 v[72:75], a[156:159], a[40:43], v[72:75]
    s_waitcnt lgkmcnt(4)
    s_cbranch_vccnz L_h3_r
L_h3_ok:
    ds_read_b128 a[148:151], v6 offset:13312
    v_mfma_f32_16x16x32_bf16 v[76:79], a[156:159], a[44:47], v[76:79]
    s_xor_b32 s48, s96, 24576
    global_load_dwordx4 a[96:99], v1, s[48:49] offset:0 sc1
    v_mfma_f32_16x16x32_bf16 v[16:19], a[128:131], a[48:51], v[16:19]
    s_waitcnt lgkmcnt(4)
    ds_read_b128 a[152:155], v6 offset:46080
    v_mfma_f32_16x16x32_bf16 v[20:23], a[128:131], a[52:55], v[20:23]
    v_mfma_f32_16x16x32_bf16 v[32:35], a[132:135], a[48:51], v[32:35]
    s_waitcnt lgkmcnt(4)
    ds_read_b128 a[156:159], v9 offset:13312
    global_load_lds_dwordx4 v7, s[44:45] offset:1024 sc1
    v_mfma_f32_16x16x32_bf16 v[36:39], a[132:135], a[52:55], v[36:39]
    v_mfma_f32_16x16x32_bf16 v[48:51], a[136:139], a[48:51], v[48:51]
    s_waitcnt lgkmcnt(4)
    ds_read_b128 a[128:131], v7 offset:47104
    v_mfma_f32_16x16x32_bf16 v[52:55], a[136:139], a[52:55], v[52:55]
    v_mfma_f32_16x16x32_bf16 v[64:67], a[140:143], a[48:51], v[64:67]
    s_waitcnt lgkmcnt(4)
    ds_read_b128 a[132:135], v6 offset:14336
    global_load_dwordx4 a[100:103], v1, s[48:49] offset:1024 sc1
    v_mfma_f32_16x16x32_bf16 v[68:71], a[140:143], a[52:55], v[68:71]
    v_mfma_f32_16x16x32_bf16 v[24:27], a[144:147], a[48:51], v[24:27]
    s_waitcnt lgkmcnt(4)
    ds_read_b128 a[136:139], v6 offset:47104
    v_mfma_f32_16x16x32_bf16 v[28:31], a[144:147], a[52:55], v[28:31]
    v_mfma_f32_16x16x32_bf16 v[40:43], a[148:151], a[48:51], v[40:43]
    s_waitcnt lgkmcnt(4)
    ds_read_b128 a[140:143], v9 offset:14336
    global_load_lds_dwordx4 v7, s[44:45] offset:2048 sc1
    v_mfma_f32_16x16x32_bf16 v[44:47], a[148:151], a[52:55], v[44:47]
    v_mfma_f32_16x16x32_bf16 v[56:59], a[152:155], a[48:51], v[56:59]
    s_waitcnt lgkmcnt(4)
    ds_read_b128 a[144:147], v7 offset:48128
    v_mfma_f32_16x16x32_bf16 v[60:63], a[152:155], a[52:55], v[60:63]
    v_mfma_f32_16x16x32_bf16 v[72:75], a[156:159], a[48:51], v[72:75]
    s_waitcnt lgkmcnt(4)
    ds_read_b128 a[148:151], v6 offset:15360
    global_load_dwordx4 a[104:107], v1, s[48:49] offset:2048 sc1
    v_mfma_f32_16x16x32_bf16 v[76:79], a[156:159], a[52:55], v[76:79]
    v_mfma_f32_16x16x32_bf16 v[16:19], a[128:131], a[56:59], v[16:19]
    s_waitcnt lgkmcnt(4)
    ds_read_b128 a[152:155], v6 offset:48128
    v_mfma_f32_16x16x32_bf16 v[20:23], a[128:131], a[60:63], v[20:23]
    v_mfma_f32_16x16x32_bf16 v[32:35], a[132:135], a[56:59], v[32:35]
    s_waitcnt lgkmcnt(4)
    ds_read_b128 a[156:159], v9 offset:15360
    global_load_lds_dwordx4 v7, s[44:45] offset:3072 sc1
    v_mfma_f32_16x16x32_bf16 v[36:39], a[132:135], a[60:63], v[36:39]
    v_mfma_f32_16x16x32_bf16 v[48:51], a[136:139], a[56:59], v[48:51]
    s_waitcnt lgkmcnt(4)
    ds_read_b128 a[128:131], v7 offset:49152
    v_mfma_f32_16x16x32_bf16 v[52:55], a[136:139], a[60:63], v[52:55]
    v_mfma_f32_16x16x32_bf16 v[64:67], a[140:143], a[56:59], v[64:67]
    s_waitcnt lgkmcnt(4)
    ds_read_b128 a[132:135], v6 offset:16384
    global_load_dwordx4 a[108:111], v1, s[48:49] offset:3072 sc1
    v_mfma_f32_16x16x32_bf16 v[68:71], a[140:143], a[60:63], v[68:71]
    v_mfma_f32_16x16x32_bf16 v[24:27], a[144:147], a[56:59], v[24:27]
    s_waitcnt vmcnt(18) lgkmcnt(4)
    ds_read_b128 a[136:139], v6 offset:49152
    v_accvgpr_read_b32 v112, a64
    v_mfma_f32_16x16x32_bf16 v[28:31], a[144:147], a[60:63], v[28:31]
    v_accvgpr_read_b32 v113, a68
    v_accvgpr_read_b32 v114, a72
    v_mfma_f32_16x16x32_bf16 v[40:43], a[148:151], a[56:59], v[40:43]
    s_waitcnt lgkmcnt(4)
    ds_read_b128 a[140:143], v9 offset:16384
    v_accvgpr_read_b32 v115, a76
    v_mfma_f32_16x16x32_bf16 v[44:47], a[148:151], a[60:63], v[44:47]
    s_xor_b32 s48, s96, 28672
    global_load_dwordx4 a[112:115], v1, s[48:49] offset:0 sc1
    v_max3_u32 v112, v112, v113, v114
    v_mfma_f32_16x16x32_bf16 v[56:59], a[152:155], a[56:59], v[56:59]
    s_waitcnt lgkmcnt(4)
    ds_read_b128 a[144:147], v7 offset:50176
    v_max_u32 v112, v112, v115
    v_mfma_f32_16x16x32_bf16 v[60:63], a[152:155], a[60:63], v[60:63]
    v_cmp_eq_u32 vcc, -1, v112
    v_mfma_f32_16x16x32_bf16 v[72:75], a[156:159], a[56:59], v[72:75]
    s_waitcnt vmcnt(17) lgkmcnt(4)
    s_barrier
    s_cbranch_vccnz L_h4_r
L_h4_ok:
    ds_read_b128 a[148:151], v6 offset:17408
    global_load_dwordx4 a[116:119], v1, s[48:49] offset:1024 sc1
    v_mfma_f32_16x16x32_bf16 v[76:79], a[156:159], a[60:63], v[76:79]
    v_mfma_f32_16x16x32_bf16 v[16:19], a[128:131], a[64:67], v[16:19]
    s_waitcnt lgkmcnt(4)
    ds_read_b128 a[152:155], v6 offset:50176
    v_mfma_f32_16x16x32_bf16 v[20:23], a[128:131], a[68:71], v[20:23]
    v_mfma_f32_16x16x32_bf16 v[32:35], a[132:135], a[64:67], v[32:35]
    s_waitcnt lgkmcnt(4)
    ds_read_b128 a[156:159], v9 offset:17408
    global_load_dwordx4 a[120:123], v1, s[48:49] offset:2048 sc1
    v_mfma_f32_16x16x32_bf16 v[36:39], a[132:135], a[68:71], v[36:39]
    v_mfma_f32_16x16x32_bf16 v[48:51], a[136:139], a[64:67], v[48:51]
    s_waitcnt lgkmcnt(4)
    ds_read_b128 a[128:131], v7 offset:51200
    v_mfma_f32_16x16x32_bf16 v[52:55], a[136:139], a[68:71], v[52:55]
    v_mfma_f32_16x16x32_bf16 v[64:67], a[140:143], a[64:67], v[64:67]
    s_waitcnt lgkmcnt(4)
    ds_read_b128 a[132:135], v6 offset:18432
    global_load_dwordx4 a[124:127], v1, s[48:49] offset:3072 sc1
    v_mfma_f32_16x16x32_bf16 v[68:71], a[140:143], a[68:71], v[68:71]
    s_xor_b32 s13, s65, 0
    v_mfma_f32_16x16x32_bf16 v[24:27], a[144:147], a[64:67], v[24:27]
    s_waitcnt lgkmcnt(4)
    ds_read_b128 a[136:139], v6 offset:51200
    v_mfma_f32_16x16x32_bf16 v[28:31], a[144:147], a[68:71], v[28:31]
    s_add_u32 m0, s13, 32768
    v_mfma_f32_16x16x32_bf16 v[40:43], a[148:151], a[64:67], v[40:43]
    s_waitcnt lgkmcnt(4)
    ds_read_b128 a[140:143], v9 offset:18432
    v_mfma_f32_16x16x32_bf16 v[44:47], a[148:151], a[68:71], v[44:47]
    s_xor_b32 s13, s73, 0
    v_mfma_f32_16x16x32_bf16 v[56:59], a[152:155], a[64:67], v[56:59]
    s_waitcnt lgkmcnt(4)
    ds_read_b128 a[144:147], v7 offset:52224
    v_mfma_f32_16x16x32_bf16 v[60:63], a[152:155], a[68:71], v[60:63]
    s_add_u32 s44, s13, s101
    global_load_lds_dwordx4 v7, s[44:45] offset:0 sc1
    v_mfma_f32_16x16x32_bf16 v[72:75], a[156:159], a[64:67], v[72:75]
    s_waitcnt lgkmcnt(4)
    ds_read_b128 a[148:151], v6 offset:19456
    v_mfma_f32_16x16x32_bf16 v[76:79], a[156:159], a[68:71], v[76:79]
    v_mfma_f32_16x16x32_bf16 v[16:19], a[128:131], a[72:75], v[16:19]
    s_waitcnt lgkmcnt(4)
    ds_read_b128 a[152:155], v6 offset:52224
    global_load_lds_dwordx4 v7, s[44:45] offset:1024 sc1
    v_mfma_f32_16x16x32_bf16 v[20:23], a[128:131], a[76:79], v[20:23]
    v_mfma_f32_16x16x32_bf16 v[32:35], a[132:135], a[72:75], v[32:35]
    s_waitcnt lgkmcnt(4)
    ds_read_b128 a[156:159], v9 offset:19456
    v_mfma_f32_16x16x32_bf16 v[36:39], a[132:135], a[76:79], v[36:39]
    v_mfma_f32_16x16x32_bf16 v[48:51], a[136:139], a[72:75], v[48:51]
    s_waitcnt lgkmcnt(4)
    ds_read_b128 a[128:131], v7 offset:53248
    global_load_lds_dwordx4 v7, s[44:45] offset:2048 sc1
    v_mfma_f32_16x16x32_bf16 v[52:55], a[136:139], a[76:79], v[52:55]
    v_mfma_f32_16x16x32_bf16 v[64:67], a[140:143], a[72:75], v[64:67]
    s_waitcnt lgkmcnt(4)
    ds_read_b128 a[132:135], v7 offset:54272
    v_mfma_f32_16x16x32_bf16 v[68:71], a[140:143], a[76:79], v[68:71]
    v_mfma_f32_16x16x32_bf16 v[24:27], a[144:147], a[72:75], v[24:27]
    s_waitcnt vmcnt(15) lgkmcnt(4)
    ds_read_b128 a[136:139], v7 offset:55296
    v_accvgpr_read_b32 v112, a80
    v_mfma_f32_16x16x32_bf16 v[28:31], a[144:147], a[76:79], v[28:31]
    v_accvgpr_read_b32 v113, a84
    v_accvgpr_read_b32 v114, a88
    v_mfma_f32_16x16x32_bf16 v[40:43], a[148:151], a[72:75], v[40:43]
    s_waitcnt lgkmcnt(4)
    ds_read_b128 a[140:143], v7 offset:56320
    global_load_lds_dwordx4 v7, s[44:45] offset:3072 sc1
    v_mfma_f32_16x16x32_bf16 v[44:47], a[148:151], a[76:79], v[44:47]
    s_xor_b32 s13, s65, 32768
    v_accvgpr_read_b32 v115, a92
    v_max3_u32 v112, v112, v113, v114
    v_mfma_f32_16x16x32_bf16 v[56:59], a[152:155], a[72:75], v[56:59]
    s_waitcnt lgkmcnt(4)
    ds_read_b128 a[144:147], v7 offset:57344
    v_max_u32 v112, v112, v115
    v_mfma_f32_16x16x32_bf16 v[60:63], a[152:155], a[76:79], v[60:63]
    s_add_u32 m0, s13, 32768
    v_cmp_eq_u32 vcc, -1, v112
    v_mfma_f32_16x16x32_bf16 v[72:75], a[156:159], a[72:75], v[72:75]
    s_waitcnt lgkmcnt(4)
    s_cbranch_vccnz L_h5_r
L_h5_ok:
    ds_read_b128 a[148:151], v7 offset:58368
    v_mfma_f32_16x16x32_bf16 v[76:79], a[156:159], a[76:79], v[76:79]
    s_xor_b32 s13, s73, 16384
    v_mfma_f32_16x16x32_bf16 v[16:19], a[128:131], a[80:83], v[16:19]
    s_waitcnt vmcnt(8) lgkmcnt(4)
    ds_read_b128 a[152:155], v7 offset:59392
    v_accvgpr_read_b32 v112, a96
    v_mfma_f32_16x16x32_bf16 v[20:23], a[128:131], a[84:87], v[20:23]
    s_add_u32 s44, s13, s101
    v_accvgpr_read_b32 v113, a100
    v_accvgpr_read_b32 v114, a104
    v_mfma_f32_16x16x32_bf16 v[24:27], a[132:135], a[80:83], v[24:27]
    s_waitcnt lgkmcnt(4)
    ds_read_b128 a[156:159], v7 offset:60416
    global_load_lds_dwordx4 v7, s[44:45] offset:0 sc1
    v_mfma_f32_16x16x32_bf16 v[28:31], a[132:135], a[84:87], v[28:31]
    v_accvgpr_read_b32 v115, a108
    v_max3_u32 v112, v112, v113, v114
    v_mfma_f32_16x16x32_bf16 v[16:19], a[136:139], a[88:91], v[16:19]
    s_waitcnt lgkmcnt(4)
    ds_read_b128 a[128:131], v7 offset:61440
    v_max_u32 v112, v112, v115
    v_mfma_f32_16x16x32_bf16 v[20:23], a[136:139], a[92:95], v[20:23]
    v_cmp_eq_u32 vcc, -1, v112
    v_mfma_f32_16x16x32_bf16 v[24:27], a[140:143], a[88:91], v[24:27]
    s_waitcnt lgkmcnt(4)
    s_cbranch_vccnz L_h6_r
L_h6_ok:
    ds_read_b128 a[132:135], v7 offset:62464
    v_mfma_f32_16x16x32_bf16 v[28:31], a[140:143], a[92:95], v[28:31]
    v_mfma_f32_16x16x32_bf16 v[16:19], a[144:147], a[96:99], v[16:19]
    s_waitcnt vmcnt(5) lgkmcnt(4)
    ds_read_b128 a[136:139], v7 offset:63488
    v_accvgpr_read_b32 v112, a112
    v_mfma_f32_16x16x32_bf16 v[20:23], a[144:147], a[100:103], v[20:23]
    v_accvgpr_read_b32 v113, a116
    v_accvgpr_read_b32 v114, a120
    v_mfma_f32_16x16x32_bf16 v[24:27], a[148:151], a[96:99], v[24:27]
    s_waitcnt lgkmcnt(4)
    ds_read_b128 a[140:143], v7 offset:64512
    global_load_lds_dwordx4 v7, s[44:45] offset:1024 sc1
    v_mfma_f32_16x16x32_bf16 v[28:31], a[148:151], a[100:103], v[28:31]
    v_accvgpr_read_b32 v115, a124
    v_max3_u32 v112, v112, v113, v114
    v_mfma_f32_16x16x32_bf16 v[16:19], a[152:155], a[104:107], v[16:19]
    s_waitcnt lgkmcnt(4)
    ds_read_b128 a[144:147], v6 offset:20480
    v_max_u32 v112, v112, v115
    v_mfma_f32_16x16x32_bf16 v[20:23], a[152:155], a[108:111], v[20:23]
    v_cmp_eq_u32 vcc, -1, v112
    v_mfma_f32_16x16x32_bf16 v[24:27], a[156:159], a[104:107], v[24:27]
    s_waitcnt lgkmcnt(4)
    s_cbranch_vccnz L_h7_r
L_h7_ok:
    ds_read_b128 a[148:151], v6 offset:21504
    v_mfma_f32_16x16x32_bf16 v[28:31], a[156:159], a[108:111], v[28:31]
    v_mfma_f32_16x16x32_bf16 v[16:19], a[128:131], a[112:115], v[16:19]
    s_waitcnt lgkmcnt(4)
    ds_read_b128 a[152:155], v6 offset:22528
    global_load_lds_dwordx4 v7, s[44:45] offset:2048 sc1
    v_mfma_f32_16x16x32_bf16 v[20:23], a[128:131], a[116:119], v[20:23]
    v_mfma_f32_16x16x32_bf16 v[24:27], a[132:135], a[112:115], v[24:27]
    s_waitcnt lgkmcnt(4)
    ds_read_b128 a[156:159], v6 offset:23552
    v_mfma_f32_16x16x32_bf16 v[28:31], a[132:135], a[116:119], v[28:31]
    v_mfma_f32_16x16x32_bf16 v[16:19], a[136:139], a[120:123], v[16:19]
    s_waitcnt lgkmcnt(4)
    ds_read_b128 a[128:131], v6 offset:24576
    v_mfma_f32_16x16x32_bf16 v[20:23], a[136:139], a[124:127], v[20:23]
    v_mfma_f32_16x16x32_bf16 v[24:27], a[140:143], a[120:123], v[24:27]
    s_waitcnt lgkmcnt(4)
    ds_read_b128 a[132:135], v6 offset:25600
    v_mfma_f32_16x16x32_bf16 v[28:31], a[140:143], a[124:127], v[28:31]
    v_mfma_f32_16x16x32_bf16 v[32:35], a[144:147], a[80:83], v[32:35]
    s_waitcnt lgkmcnt(4)
    ds_read_b128 a[136:139], v6 offset:26624
    global_load_lds_dwordx4 v7, s[44:45] offset:3072 sc1
    v_mfma_f32_16x16x32_bf16 v[36:39], a[144:147], a[84:87], v[36:39]
    s_xor_b32 s13, s65, 65536
    v_mfma_f32_16x16x32_bf16 v[40:43], a[148:151], a[80:83], v[40:43]
    s_waitcnt lgkmcnt(4)
    ds_read_b128 a[140:143], v6 offset:27648
    v_mfma_f32_16x16x32_bf16 v[44:47], a[148:151], a[84:87], v[44:47]
    s_add_u32 m0, s13, 32768
    v_exp_f32 v16, -v16
    v_mfma_f32_16x16x32_bf16 v[32:35], a[152:155], a[88:91], v[32:35]
    s_waitcnt lgkmcnt(4)
    ds_read_b128 a[144:147], v6 offset:28672
    v_add_f32 v16, 1.0, v16
    v_mfma_f32_16x16x32_bf16 v[36:39], a[152:155], a[92:95], v[36:39]
    s_xor_b32 s13, s73, 32768
    v_exp_f32 v17, -v17
    v_mfma_f32_16x16x32_bf16 v[40:43], a[156:159], a[88:91], v[40:43]
    s_waitcnt lgkmcnt(4)
    ds_read_b128 a[148:151], v6 offset:29696
    v_add_f32 v17, 1.0, v17
    v_mfma_f32_16x16x32_bf16 v[44:47], a[156:159], a[92:95], v[44:47]
    s_add_u32 s44, s13, s101
    v_exp_f32 v18, -v18
    v_mfma_f32_16x16x32_bf16 v[32:35], a[128:131], a[96:99], v[32:35]
    s_waitcnt lgkmcnt(4)
    ds_read_b128 a[152:155], v6 offset:30720
    global_load_lds_dwordx4 v7, s[44:45] offset:0 sc1
    v_mfma_f32_16x16x32_bf16 v[36:39], a[128:131], a[100:103], v[36:39]
    v_exp_f32 v19, -v19
    v_mfma_f32_16x16x32_bf16 v[40:43], a[132:135], a[96:99], v[40:43]
    s_waitcnt lgkmcnt(4)
    ds_read_b128 a[156:159], v6 offset:31744
    v_add_f32 v18, 1.0, v18
    v_mfma_f32_16x16x32_bf16 v[44:47], a[132:135], a[100:103], v[44:47]
    v_exp_f32 v20, -v20
    v_mfma_f32_16x16x32_bf16 v[32:35], a[136:139], a[104:107], v[32:35]
    s_waitcnt lgkmcnt(4)
    ds_read_b128 a[128:131], v6 offset:53248
    v_add_f32 v19, 1.0, v19
    v_mfma_f32_16x16x32_bf16 v[36:39], a[136:139], a[108:111], v[36:39]
    v_exp_f32 v21, -v21
    v_mfma_f32_16x16x32_bf16 v[40:43], a[140:143], a[104:107], v[40:43]
    s_waitcnt lgkmcnt(4)
    ds_read_b128 a[132:135], v6 offset:54272
    v_add_f32 v20, 1.0, v20
    v_mfma_f32_16x16x32_bf16 v[44:47], a[140:143], a[108:111], v[44:47]
    v_exp_f32 v22, -v22
    v_mfma_f32_16x16x32_bf16 v[32:35], a[144:147], a[112:115], v[32:35]
    s_waitcnt lgkmcnt(4)
    ds_read_b128 a[136:139], v6 offset:55296
    global_load_lds_dwordx4 v7, s[44:45] offset:1024 sc1
    v_mfma_f32_16x16x32_bf16 v[36:39], a[144:147], a[116:119], v[36:39]
L_w8:
    s_cbranch_execz L_w9
    v_exp_f32 v23, -v23
    v_mfma_f32_16x16x32_bf16 v[40:43], a[148:151], a[112:115], v[40:43]
    s_waitcnt lgkmcnt(4)
    ds_read_b128 a[140:143], v6 offset:56320
    v_add_f32 v21, 1.0, v21
    v_mfma_f32_16x16x32_bf16 v[44:47], a[148:151], a[116:119], v[44:47]
    v_rcp_f32 v16, v16
    v_mfma_f32_16x16x32_bf16 v[32:35], a[152:155], a[120:123], v[32:35]
    s_waitcnt lgkmcnt(4)
    ds_read_b128 a[144:147], v6 offset:57344
    v_add_f32 v22, 1.0, v22
    v_mfma_f32_16x16x32_bf16 v[36:39], a[152:155], a[124:127], v[36:39]
    v_rcp_f32 v17, v17
    v_mfma_f32_16x16x32_bf16 v[40:43], a[156:159], a[120:123], v[40:43]
    s_waitcnt lgkmcnt(4)
    ds_read_b128 a[148:151], v6 offset:58368
    v_add_f32 v23, 1.0, v23
    v_mfma_f32_16x16x32_bf16 v[44:47], a[156:159], a[124:127], v[44:47]
    v_rcp_f32 v18, v18
    v_mfma_f32_16x16x32_bf16 v[48:51], a[128:131], a[80:83], v[48:51]
    s_waitcnt lgkmcnt(4)
    ds_read_b128 a[152:155], v6 offset:59392
    global_load_lds_dwordx4 v7, s[44:45] offset:2048 sc1
    v_mfma_f32_16x16x32_bf16 v[52:55], a[128:131], a[84:87], v[52:55]
    v_rcp_f32 v19, v19
    v_mfma_f32_16x16x32_bf16 v[56:59], a[132:135], a[80:83], v[56:59]
    s_waitcnt lgkmcnt(4)
    ds_read_b128 a[156:159], v6 offset:60416
    v_mul_f32 v16, v16, v24
    v_mfma_f32_16x16x32_bf16 v[60:63], a[132:135], a[84:87], v[60:63]
    v_rcp_f32 v20, v20
    v_mfma_f32_16x16x32_bf16 v[48:51], a[136:139], a[88:91], v[48:51]
    s_waitcnt lgkmcnt(4)
    ds_read_b128 a[128:131], v6 offset:61440
    v_mul_f32 v17, v17, v25
    v_mfma_f32_16x16x32_bf16 v[52:55], a[136:139], a[92:95], v[52:55]
    v_mul_f32 v18, v18, v26
    v_mul_f32 v19, v19, v27
    v_mfma_f32_16x16x32_bf16 v[56:59], a[140:143], a[88:91], v[56:59]
    s_waitcnt lgkmcnt(4)
    ds_read_b128 a[132:135], v6 offset:62464
    v_mul_f32 v20, v20, v28
    v_mfma_f32_16x16x32_bf16 v[60:63], a[140:143], a[92:95], v[60:63]
    v_rcp_f32 v21, v21
    v_mfma_f32_16x16x32_bf16 v[48:51], a[144:147], a[96:99], v[48:51]
    s_waitcnt lgkmcnt(4)
    ds_read_b128 a[136:139], v6 offset:63488
    global_load_lds_dwordx4 v7, s[44:45] offset:3072 sc1
    v_mfma_f32_16x16x32_bf16 v[52:55], a[144:147], a[100:103], v[52:55]
    s_xor_b32 s13, s65, 98304
    v_rcp_f32 v22, v22
    v_mfma_f32_16x16x32_bf16 v[56:59], a[148:151], a[96:99], v[56:59]
    s_waitcnt lgkmcnt(4)
    ds_read_b128 a[140:143], v6 offset:64512
    v_mul_f32 v21, v21, v29
    v_mfma_f32_16x16x32_bf16 v[60:63], a[148:151], a[100:103], v[60:63]
    s_add_u32 m0, s13, 32768
    v_rcp_f32 v23, v23
    v_mfma_f32_16x16x32_bf16 v[48:51], a[152:155], a[104:107], v[48:51]
    s_waitcnt lgkmcnt(4)
    ds_read_b128 a[144:147], v9 offset:20480
    v_mul_f32 v22, v22, v30
    v_mfma_f32_16x16x32_bf16 v[52:55], a[152:155], a[108:111], v[52:55]
    s_xor_b32 s13, s73, 49152
    v_mul_f32 v23, v23, v31
    v_cvt_pk_bf16_f32 v16, v16, v17
    v_mfma_f32_16x16x32_bf16 v[56:59], a[156:159], a[104:107], v[56:59]
    s_waitcnt lgkmcnt(4)
    ds_read_b128 a[148:151], v9 offset:21504
    v_cvt_pk_bf16_f32 v17, v18, v19
    v_mfma_f32_16x16x32_bf16 v[60:63], a[156:159], a[108:111], v[60:63]
    s_add_u32 s44, s13, s101
    v_cvt_pk_bf16_f32 v18, v20, v21
    v_mfma_f32_16x16x32_bf16 v[48:51], a[128:131], a[112:115], v[48:51]
    s_waitcnt lgkmcnt(4)
    ds_read_b128 a[152:155], v9 offset:22528
    global_load_lds_dwordx4 v7, s[44:45] offset:0 sc1
    v_mfma_f32_16x16x32_bf16 v[52:55], a[128:131], a[116:119], v[52:55]
    v_cvt_pk_bf16_f32 v19, v22, v23
    v_permlane32_swap_b32 v16, v18
    v_mfma_f32_16x16x32_bf16 v[56:59], a[132:135], a[112:115], v[56:59]
    s_waitcnt lgkmcnt(4)
    ds_read_b128 a[156:159], v9 offset:23552
    v_permlane32_swap_b32 v17, v19
    v_mfma_f32_16x16x32_bf16 v[60:63], a[132:135], a[116:119], v[60:63]
    v_exp_f32 v32, -v32
    v_mfma_f32_16x16x32_bf16 v[48:51], a[136:139], a[120:123], v[48:51]
    s_waitcnt lgkmcnt(4)
    ds_read_b128 a[128:131], v9 offset:24576
    v_add_f32 v32, 1.0, v32
    v_mfma_f32_16x16x32_bf16 v[52:55], a[136:139], a[124:127], v[52:55]
    s_add_u32 s52, s97, 0
    global_store_dwordx4 v7, v[16:19], s[52:53] sc1
    v_mfma_f32_16x16x32_bf16 v[56:59], a[140:143], a[120:123], v[56:59]
    s_waitcnt lgkmcnt(4)
    ds_read_b128 a[132:135], v9 offset:25600
    v_mfma_f32_16x16x32_bf16 v[60:63], a[140:143], a[124:127], v[60:63]
    v_exp_f32 v33, -v33
    v_mfma_f32_16x16x32_bf16 v[64:67], a[144:147], a[80:83], v[64:67]
    s_waitcnt lgkmcnt(4)
    ds_read_b128 a[136:139], v9 offset:26624
    global_load_lds_dwordx4 v7, s[44:45] offset:1024 sc1
    v_mfma_f32_16x16x32_bf16 v[68:71], a[144:147], a[84:87], v[68:71]
    v_exp_f32 v34, -v34
    v_mfma_f32_16x16x32_bf16 v[72:75], a[148:151], a[80:83], v[72:75]
    s_waitcnt lgkmcnt(4)
    ds_read_b128 a[140:143], v9 offset:27648
    v_add_f32 v33, 1.0, v33
    v_mfma_f32_16x16x32_bf16 v[76:79], a[148:151], a[84:87], v[76:79]
    v_exp_f32 v35, -v35
    v_mfma_f32_16x16x32_bf16 v[64:67], a[152:155], a[88:91], v[64:67]
    s_waitcnt lgkmcnt(4)
    ds_read_b128 a[144:147], v9 offset:28672
    v_add_f32 v34, 1.0, v34
    v_mfma_f32_16x16x32_bf16 v[68:71], a[152:155], a[92:95], v[68:71]
    v_exp_f32 v36, -v36
    v_mfma_f32_16x16x32_bf16 v[72:75], a[156:159], a[88:91], v[72:75]
    s_waitcnt lgkmcnt(4)
    ds_read_b128 a[148:151], v9 offset:29696
    v_add_f32 v35, 1.0, v35
    v_mfma_f32_16x16x32_bf16 v[76:79], a[156:159], a[92:95], v[76:79]
    v_exp_f32 v37, -v37
    v_mfma_f32_16x16x32_bf16 v[64:67], a[128:131], a[96:99], v[64:67]
    s_waitcnt lgkmcnt(4)
    ds_read_b128 a[152:155], v9 offset:30720
    global_load_lds_dwordx4 v7, s[44:45] offset:2048 sc1
    v_mfma_f32_16x16x32_bf16 v[68:71], a[128:131], a[100:103], v[68:71]
    v_exp_f32 v38, -v38
    v_mfma_f32_16x16x32_bf16 v[72:75], a[132:135], a[96:99], v[72:75]
    s_waitcnt lgkmcnt(4)
    ds_read_b128 a[156:159], v9 offset:31744
    v_add_f32 v36, 1.0, v36
    v_mfma_f32_16x16x32_bf16 v[76:79], a[132:135], a[100:103], v[76:79]
    v_exp_f32 v39, -v39
    v_mfma_f32_16x16x32_bf16 v[64:67], a[136:139], a[104:107], v[64:67]
    s_waitcnt vmcnt(21) lgkmcnt(4)
    s_barrier
    ds_read_b128 a[128:131], v7 offset:0
    v_add_f32 v37, 1.0, v37
    v_mfma_f32_16x16x32_bf16 v[68:71], a[136:139], a[108:111], v[68:71]
    v_rcp_f32 v32, v32
    v_mfma_f32_16x16x32_bf16 v[72:75], a[140:143], a[104:107], v[72:75]
    s_waitcnt lgkmcnt(4)
    ds_read_b128 a[132:135], v7 offset:1024
    v_add_f32 v38, 1.0, v38
    v_mfma_f32_16x16x32_bf16 v[76:79], a[140:143], a[108:111], v[76:79]
    v_rcp_f32 v33, v33
    v_mfma_f32_16x16x32_bf16 v[64:67], a[144:147], a[112:115], v[64:67]
    s_waitcnt lgkmcnt(4)
    ds_read_b128 a[136:139], v7 offset:2048
    global_load_lds_dwordx4 v7, s[44:45] offset:3072 sc1
    v_mfma_f32_16x16x32_bf16 v[68:71], a[144:147], a[116:119], v[68:71]
    s_add_u32 s46, s70, 49152
    v_rcp_f32 v34, v34
    v_mfma_f32_16x16x32_bf16 v[72:75], a[148:151], a[112:115], v[72:75]
    s_waitcnt lgkmcnt(4)
    ds_read_b128 a[140:143], v7 offset:3072
    v_add_f32 v39, 1.0, v39
    v_mfma_f32_16x16x32_bf16 v[76:79], a[148:151], a[116:119], v[76:79]
    v_rcp_f32 v35, v35
    v_mfma_f32_16x16x32_bf16 v[64:67], a[152:155], a[120:123], v[64:67]
    s_waitcnt lgkmcnt(4)
    ds_read_b128 a[144:147], v7 offset:4096
    global_load_dwordx4 a[216:219], v7, s[46:47] offset:0 sc1
    v_mfma_f32_16x16x32_bf16 v[68:71], a[152:155], a[124:127], v[68:71]
    v_mul_f32 v32, v32, v40
    v_mul_f32 v33, v33, v41
    v_mfma_f32_16x16x32_bf16 v[72:75], a[156:159], a[120:123], v[72:75]
    s_waitcnt lgkmcnt(4)
    ds_read_b128 a[148:151], v7 offset:5120
    v_mul_f32 v34, v34, v42
    v_mfma_f32_16x16x32_bf16 v[76:79], a[156:159], a[124:127], v[76:79]
    v_rcp_f32 v36, v36
    v_mfma_f32_16x16x32_bf16 v[80:83], a[128:131], a[0:3], 0
    s_waitcnt lgkmcnt(4)
    ds_read_b128 a[152:155], v7 offset:6144
    global_load_dwordx4 a[220:223], v7, s[46:47] offset:1024 sc1
    v_mfma_f32_16x16x32_bf16 v[84:87], a[128:131], a[4:7], 0
    s_add_u32 s46, s71, 49152
    v_rcp_f32 v37, v37
    v_mfma_f32_16x16x32_bf16 v[88:91], a[132:135], a[0:3], 0
    s_waitcnt lgkmcnt(4)
    ds_read_b128 a[156:159], v7 offset:7168
    v_mul_f32 v35, v35, v43
    v_mfma_f32_16x16x32_bf16 v[92:95], a[132:135], a[4:7], 0
    v_rcp_f32 v38, v38
    v_mfma_f32_16x16x32_bf16 v[80:83], a[136:139], a[8:11], v[80:83]
    s_waitcnt lgkmcnt(4)
    ds_read_b128 a[128:131], v7 offset:8192
    global_load_dwordx4 v[120:123], v7, s[46:47] offset:0 sc1
    v_mfma_f32_16x16x32_bf16 v[84:87], a[136:139], a[12:15], v[84:87]
    v_mul_f32 v36, v36, v44
    v_mul_f32 v37, v37, v45
    v_mfma_f32_16x16x32_bf16 v[88:91], a[140:143], a[8:11], v[88:91]
    s_waitcnt lgkmcnt(4)
    ds_read_b128 a[132:135], v7 offset:9216
    v_mul_f32 v38, v38, v46
    v_mfma_f32_16x16x32_bf16 v[92:95], a[140:143], a[12:15], v[92:95]
    v_rcp_f32 v39, v39
    v_mfma_f32_16x16x32_bf16 v[80:83], a[144:147], a[16:19], v[80:83]
    s_waitcnt lgkmcnt(4)
    ds_read_b128 a[136:139], v7 offset:10240
    global_load_dwordx4 v[124:127], v7, s[46:47] offset:1024 sc1
    v_mfma_f32_16x16x32_bf16 v[84:87], a[144:147], a[20:23], v[84:87]
    v_mul_f32 v39, v39, v47
    v_cvt_pk_bf16_f32 v32, v32, v33
    v_mfma_f32_16x16x32_bf16 v[88:91], a[148:151], a[16:19], v[88:91]
    s_waitcnt lgkmcnt(4)
    ds_read_b128 a[140:143], v7 offset:11264
    v_cvt_pk_bf16_f32 v33, v34, v35
    v_mfma_f32_16x16x32_bf16 v[92:95], a[148:151], a[20:23], v[92:95]
    v_cvt_pk_bf16_f32 v34, v36, v37
    v_mfma_f32_16x16x32_bf16 v[80:83], a[152:155], a[24:27], v[80:83]
    s_waitcnt lgkmcnt(4)
    ds_read_b128 a[144:147], v7 offset:12288
    v_cvt_pk_bf16_f32 v35, v38, v39
    v_mfma_f32_16x16x32_bf16 v[84:87], a[152:155], a[28:31], v[84:87]
    v_permlane32_swap_b32 v32, v34
    v_permlane32_swap_b32 v33, v35
    v_mfma_f32_16x16x32_bf16 v[88:91], a[156:159], a[24:27], v[88:91]
    s_waitcnt lgkmcnt(4)
    ds_read_b128 a[148:151], v7 offset:13312
    v_mfma_f32_16x16x32_bf16 v[92:95], a[156:159], a[28:31], v[92:95]
    s_add_u32 s52, s97, 4096
    global_store_dwordx4 v7, v[32:35], s[52:53] sc1
    v_mfma_f32_16x16x32_bf16 v[80:83], a[128:131], a[32:35], v[80:83]
    s_waitcnt lgkmcnt(4)
    ds_read_b128 a[152:155], v7 offset:14336
    v_mfma_f32_16x16x32_bf16 v[84:87], a[128:131], a[36:39], v[84:87]
    v_exp_f32 v48, -v48
    v_mfma_f32_16x16x32_bf16 v[88:91], a[132:135], a[32:35], v[88:91]
    s_waitcnt lgkmcnt(4)
    ds_read_b128 a[156:159], v7 offset:15360
    v_add_f32 v48, 1.0, v48
    v_mfma_f32_16x16x32_bf16 v[92:95], a[132:135], a[36:39], v[92:95]
    v_exp_f32 v49, -v49
    v_mfma_f32_16x16x32_bf16 v[80:83], a[136:139], a[40:43], v[80:83]
    s_waitcnt lgkmcnt(4)
    ds_read_b128 a[128:131], v7 offset:16384
    v_add_f32 v49, 1.0, v49
    v_mfma_f32_16x16x32_bf16 v[84:87], a[136:139], a[44:47], v[84:87]
    v_exp_f32 v50, -v50
    v_mfma_f32_16x16x32_bf16 v[88:91], a[140:143], a[40:43], v[88:91]
    s_waitcnt lgkmcnt(4)
    ds_read_b128 a[132:135], v7 offset:17408
    v_add_f32 v50, 1.0, v50
    v_mfma_f32_16x16x32_bf16 v[92:95], a[140:143], a[44:47], v[92:95]
    v_exp_f32 v51, -v51
    v_mfma_f32_16x16x32_bf16 v[80:83], a[144:147], a[48:51], v[80:83]
    s_waitcnt lgkmcnt(4)
    ds_read_b128 a[136:139], v7 offset:18432
    v_add_f32 v51, 1.0, v51
    v_mfma_f32_16x16x32_bf16 v[84:87], a[144:147], a[52:55], v[84:87]
    v_exp_f32 v52, -v52
    v_mfma_f32_16x16x32_bf16 v[88:91], a[148:151], a[48:51], v[88:91]
    s_waitcnt lgkmcnt(4)
    ds_read_b128 a[140:143], v7 offset:19456
    v_add_f32 v52, 1.0, v52
    v_mfma_f32_16x16x32_bf16 v[92:95], a[148:151], a[52:55], v[92:95]
    v_exp_f32 v53, -v53
    v_mfma_f32_16x16x32_bf16 v[80:83], a[152:155], a[56:59], v[80:83]
    s_waitcnt lgkmcnt(4)
    ds_read_b128 a[144:147], v7 offset:20480
    v_add_f32 v53, 1.0, v53
    v_mfma_f32_16x16x32_bf16 v[84:87], a[152:155], a[60:63], v[84:87]
    v_exp_f32 v54, -v54
    v_mfma_f32_16x16x32_bf16 v[88:91], a[156:159], a[56:59], v[88:91]
    s_waitcnt lgkmcnt(4)
    ds_read_b128 a[148:151], v7 offset:21504
    v_add_f32 v54, 1.0, v54
    v_mfma_f32_16x16x32_bf16 v[92:95], a[156:159], a[60:63], v[92:95]
    v_exp_f32 v55, -v55
    v_mfma_f32_16x16x32_bf16 v[80:83], a[128:131], a[64:67], v[80:83]
    s_waitcnt lgkmcnt(4)
    ds_read_b128 a[152:155], v7 offset:22528
    v_add_f32 v55, 1.0, v55
    v_mfma_f32_16x16x32_bf16 v[84:87], a[128:131], a[68:71], v[84:87]
    v_rcp_f32 v48, v48
    v_mfma_f32_16x16x32_bf16 v[88:91], a[132:135], a[64:67], v[88:91]
    s_waitcnt lgkmcnt(4)
    ds_read_b128 a[156:159], v7 offset:23552
    v_mul_f32 v48, v48, v56
    v_mfma_f32_16x16x32_bf16 v[92:95], a[132:135], a[68:71], v[92:95]
    v_rcp_f32 v49, v49
    v_mfma_f32_16x16x32_bf16 v[80:83], a[136:139], a[72:75], v[80:83]
    s_waitcnt lgkmcnt(4)
    ds_read_b128 a[128:131], v7 offset:24576
    v_mul_f32 v49, v49, v57
    v_mfma_f32_16x16x32_bf16 v[84:87], a[136:139], a[76:79], v[84:87]
    v_rcp_f32 v50, v50
    v_mfma_f32_16x16x32_bf16 v[88:91], a[140:143], a[72:75], v[88:91]
    s_waitcnt lgkmcnt(4)
    ds_read_b128 a[132:135], v7 offset:25600
    v_mul_f32 v50, v50, v58
    v_mfma_f32_16x16x32_bf16 v[92:95], a[140:143], a[76:79], v[92:95]
    v_rcp_f32 v51, v51
    v_mfma_f32_16x16x32_bf16 v[80:83], a[144:147], a[80:83], v[80:83]
    s_waitcnt lgkmcnt(4)
    ds_read_b128 a[136:139], v7 offset:26624
    v_mul_f32 v51, v51, v59
    v_mfma_f32_16x16x32_bf16 v[84:87], a[144:147], a[84:87], v[84:87]
    v_rcp_f32 v52, v52
    v_mfma_f32_16x16x32_bf16 v[88:91], a[148:151], a[80:83], v[88:91]
    s_waitcnt lgkmcnt(4)
    ds_read_b128 a[140:143], v7 offset:27648
    v_mul_f32 v52, v52, v60
    v_mfma_f32_16x16x32_bf16 v[92:95], a[148:151], a[84:87], v[92:95]
    v_rcp_f32 v53, v53
    v_mfma_f32_16x16x32_bf16 v[80:83], a[152:155], a[88:91], v[80:83]
    s_waitcnt lgkmcnt(4)
    ds_read_b128 a[144:147], v7 offset:28672
    v_mul_f32 v53, v53, v61
    v_mfma_f32_16x16x32_bf16 v[84:87], a[152:155], a[92:95], v[84:87]
    v_rcp_f32 v54, v54
    v_mfma_f32_16x16x32_bf16 v[88:91], a[156:159], a[88:91], v[88:91]
    s_waitcnt lgkmcnt(4)
    ds_read_b128 a[148:151], v7 offset:29696
    v_mul_f32 v54, v54, v62
    v_mfma_f32_16x16x32_bf16 v[92:95], a[156:159], a[92:95], v[92:95]
    v_rcp_f32 v55, v55
    v_mfma_f32_16x16x32_bf16 v[80:83], a[128:131], a[96:99], v[80:83]
    s_waitcnt lgkmcnt(4)
    ds_read_b128 a[152:155], v7 offset:30720
    v_mul_f32 v55, v55, v63
    v_mfma_f32_16x16x32_bf16 v[84:87], a[128:131], a[100:103], v[84:87]
    s_add_u32 s50, s24, 0
    global_load_dwordx4 v[16:19], v3, s[50:51] sc1
    v_cvt_pk_bf16_f32 v48, v48, v49
    v_mfma_f32_16x16x32_bf16 v[88:91], a[132:135], a[96:99], v[88:91]
    s_waitcnt lgkmcnt(4)
    ds_read_b128 a[156:159], v7 offset:31744
    v_cvt_pk_bf16_f32 v49, v50, v51
    v_mfma_f32_16x16x32_bf16 v[92:95], a[132:135], a[100:103], v[92:95]
    v_cvt_pk_bf16_f32 v50, v52, v53
    v_mfma_f32_16x16x32_bf16 v[80:83], a[136:139], a[104:107], v[80:83]
    s_waitcnt vmcnt(6) lgkmcnt(4)
    s_barrier
    ds_read_b128 a[128:131], v7 offset:32768
    global_load_dwordx4 v[20:23], v4, s[50:51] sc1
    v_mfma_f32_16x16x32_bf16 v[84:87], a[136:139], a[108:111], v[84:87]
    v_cvt_pk_bf16_f32 v51, v54, v55
    v_permlane32_swap_b32 v48, v50
    v_mfma_f32_16x16x32_bf16 v[88:91], a[140:143], a[104:107], v[88:91]
    s_waitcnt lgkmcnt(4)
    ds_read_b128 a[132:135], v7 offset:33792
    v_permlane32_swap_b32 v49, v51
    v_mfma_f32_16x16x32_bf16 v[92:95], a[140:143], a[108:111], v[92:95]
    v_exp_f32 v64, -v64
    v_mfma_f32_16x16x32_bf16 v[80:83], a[144:147], a[112:115], v[80:83]
    s_waitcnt lgkmcnt(4)
    ds_read_b128 a[136:139], v7 offset:34816
    v_add_f32 v64, 1.0, v64
    v_mfma_f32_16x16x32_bf16 v[84:87], a[144:147], a[116:119], v[84:87]
    s_add_u32 s52, s97, 8192
    global_store_dwordx4 v7, v[48:51], s[52:53] sc1
    v_mfma_f32_16x16x32_bf16 v[88:91], a[148:151], a[112:115], v[88:91]
    s_waitcnt lgkmcnt(4)
    ds_read_b128 a[140:143], v6 offset:32768
    v_mfma_f32_16x16x32_bf16 v[92:95], a[148:151], a[116:119], v[92:95]
    v_exp_f32 v65, -v65
    v_mfma_f32_16x16x32_bf16 v[80:83], a[152:155], a[120:123], v[80:83]
    s_waitcnt lgkmcnt(4)
    ds_read_b128 a[144:147], v7 offset:35840
    global_load_dwordx4 v[24:27], v8, s[50:51] sc1
    v_mfma_f32_16x16x32_bf16 v[84:87], a[152:155], a[124:127], v[84:87]
    v_exp_f32 v66, -v66
    v_mfma_f32_16x16x32_bf16 v[88:91], a[156:159], a[120:123], v[88:91]
    s_waitcnt lgkmcnt(4)
    ds_read_b128 a[148:151], v6 offset:33792
    v_add_f32 v65, 1.0, v65
    v_mfma_f32_16x16x32_bf16 v[92:95], a[156:159], a[124:127], v[92:95]
    v_exp_f32 v67, -v67
    v_mfma_f32_16x16x32_bf16 v[96:99], a[128:131], a[0:3], 0
    s_waitcnt lgkmcnt(4)
    ds_read_b128 a[152:155], v7 offset:36864
    global_load_dwordx4 v[28:31], v10, s[50:51] sc1
    v_mfma_f32_16x16x32_bf16 v[100:103], a[128:131], a[4:7], 0
    v_exp_f32 v68, -v68
    v_mfma_f32_16x16x32_bf16 v[104:107], a[132:135], a[0:3], 0
    s_waitcnt lgkmcnt(4)
    ds_read_b128 a[156:159], v6 offset:34816
    v_add_f32 v66, 1.0, v66
    v_mfma_f32_16x16x32_bf16 v[108:111], a[132:135], a[4:7], 0
    v_exp_f32 v69, -v69
    v_mfma_f32_16x16x32_bf16 v[96:99], a[136:139], a[8:11], v[96:99]
    s_waitcnt lgkmcnt(4)
    ds_read_b128 a[128:131], v7 offset:37888
    v_add_f32 v67, 1.0, v67
    v_mfma_f32_16x16x32_bf16 v[100:103], a[136:139], a[12:15], v[100:103]
    s_add_u32 s50, s25, 0
    global_load_dwordx4 v[32:35], v3, s[50:51] sc1
    v_add_f32 v68, 1.0, v68
    v_mfma_f32_16x16x32_bf16 v[48:51], a[140:143], a[0:3], 0
    s_waitcnt lgkmcnt(4)
    ds_read_b128 a[132:135], v6 offset:35840
    v_add_f32 v69, 1.0, v69
    v_mfma_f32_16x16x32_bf16 v[52:55], a[140:143], a[4:7], 0
    v_exp_f32 v70, -v70
    v_mfma_f32_16x16x32_bf16 v[104:107], a[144:147], a[8:11], v[104:107]
    s_waitcnt lgkmcnt(4)
    ds_read_b128 a[136:139], v7 offset:38912
    global_load_dwordx4 v[36:39], v4, s[50:51] sc1
    v_mfma_f32_16x16x32_bf16 v[108:111], a[144:147], a[12:15], v[108:111]
    v_exp_f32 v71, -v71
    v_mfma_f32_16x16x32_bf16 v[56:59], a[148:151], a[0:3], 0
    s_waitcnt lgkmcnt(4)
    ds_read_b128 a[140:143], v6 offset:36864
    v_add_f32 v70, 1.0, v70
    v_mfma_f32_16x16x32_bf16 v[60:63], a[148:151], a[4:7], 0
    v_rcp_f32 v64, v64
    v_mfma_f32_16x16x32_bf16 v[96:99], a[152:155], a[16:19], v[96:99]
    s_waitcnt lgkmcnt(4)
    ds_read_b128 a[144:147], v7 offset:39936
    global_load_dwordx4 v[40:43], v8, s[50:51] sc1
    v_mfma_f32_16x16x32_bf16 v[100:103], a[152:155], a[20:23], v[100:103]
    v_rcp_f32 v65, v65
    v_mfma_f32_16x16x32_bf16 v[48:51], a[156:159], a[8:11], v[48:51]
    s_waitcnt lgkmcnt(4)
    ds_read_b128 a[148:151], v6 offset:37888
    v_add_f32 v71, 1.0, v71
    v_mfma_f32_16x16x32_bf16 v[52:55], a[156:159], a[12:15], v[52:55]
    v_rcp_f32 v66, v66
    v_mfma_f32_16x16x32_bf16 v[104:107], a[128:131], a[16:19], v[104:107]
    s_waitcnt lgkmcnt(4)
    ds_read_b128 a[152:155], v7 offset:40960
    global_load_dwordx4 v[44:47], v10, s[50:51] sc1
    v_mfma_f32_16x16x32_bf16 v[108:111], a[128:131], a[20:23], v[108:111]
    v_rcp_f32 v67, v67
    v_mfma_f32_16x16x32_bf16 v[56:59], a[132:135], a[8:11], v[56:59]
    s_waitcnt lgkmcnt(4)
    ds_read_b128 a[156:159], v6 offset:38912
    v_mul_f32 v64, v64, v72
    v_mfma_f32_16x16x32_bf16 v[60:63], a[132:135], a[12:15], v[60:63]
    v_rcp_f32 v68, v68
    v_mfma_f32_16x16x32_bf16 v[96:99], a[136:139], a[24:27], v[96:99]
    s_waitcnt lgkmcnt(4)
    ds_read_b128 a[128:131], v7 offset:41984
    v_mul_f32 v65, v65, v73
    v_mfma_f32_16x16x32_bf16 v[100:103], a[136:139], a[28:31], v[100:103]
    v_mul_f32 v66, v66, v74
    v_mul_f32 v67, v67, v75
    v_mfma_f32_16x16x32_bf16 v[48:51], a[140:143], a[16:19], v[48:51]
    s_waitcnt lgkmcnt(4)
    ds_read_b128 a[132:135], v6 offset:39936
    v_mul_f32 v68, v68, v76
    v_mfma_f32_16x16x32_bf16 v[52:55], a[140:143], a[20:23], v[52:55]
    v_rcp_f32 v69, v69
    v_mfma_f32_16x16x32_bf16 v[104:107], a[144:147], a[24:27], v[104:107]
    s_waitcnt lgkmcnt(4)
    ds_read_b128 a[136:139], v7 offset:43008
    v_mul_f32 v69, v69, v77
    v_mfma_f32_16x16x32_bf16 v[108:111], a[144:147], a[28:31], v[108:111]
    v_rcp_f32 v70, v70
    v_mfma_f32_16x16x32_bf16 v[56:59], a[148:151], a[16:19], v[56:59]
    s_waitcnt lgkmcnt(4)
    ds_read_b128 a[140:143], v6 offset:40960
    v_mul_f32 v70, v70, v78
    v_mfma_f32_16x16x32_bf16 v[60:63], a[148:151], a[20:23], v[60:63]
    s_add_u32 s50, s24, 4096
    global_load_dwordx4 a[0:3], v3, s[50:51] sc1
    v_cvt_pk_bf16_f32 v64, v64, v65
    v_mfma_f32_16x16x32_bf16 v[96:99], a[152:155], a[32:35], v[96:99]
    s_waitcnt lgkmcnt(4)
    ds_read_b128 a[144:147], v7 offset:44032
    v_cvt_pk_bf16_f32 v65, v66, v67
    v_mfma_f32_16x16x32_bf16 v[100:103], a[152:155], a[36:39], v[100:103]
    v_rcp_f32 v71, v71
    v_mfma_f32_16x16x32_bf16 v[48:51], a[156:159], a[24:27], v[48:51]
    s_waitcnt lgkmcnt(4)
    ds_read_b128 a[148:151], v6 offset:41984
    global_load_dwordx4 a[4:7], v4, s[50:51] sc1
    v_mfma_f32_16x16x32_bf16 v[52:55], a[156:159], a[28:31], v[52:55]
    v_mul_f32 v71, v71, v79
    v_cvt_pk_bf16_f32 v66, v68, v69
    v_mfma_f32_16x16x32_bf16 v[104:107], a[128:131], a[32:35], v[104:107]
    s_waitcnt lgkmcnt(4)
    ds_read_b128 a[152:155], v7 offset:45056
    v_cvt_pk_bf16_f32 v67, v70, v71
    v_mfma_f32_16x16x32_bf16 v[108:111], a[128:131], a[36:39], v[108:111]
    v_permlane32_swap_b32 v64, v66
    v_permlane32_swap_b32 v65, v67
    v_mfma_f32_16x16x32_bf16 v[56:59], a[132:135], a[24:27], v[56:59]
    s_waitcnt lgkmcnt(4)
    ds_read_b128 a[156:159], v6 offset:43008
    v_mfma_f32_16x16x32_bf16 v[60:63], a[132:135], a[28:31], v[60:63]
    s_add_u32 s52, s97, 12288
    global_store_dwordx4 v7, v[64:67], s[52:53] sc1
    v_mfma_f32_16x16x32_bf16 v[96:99], a[136:139], a[40:43], v[96:99]
    s_waitcnt lgkmcnt(4)
    ds_read_b128 a[128:131], v7 offset:46080
    v_mfma_f32_16x16x32_bf16 v[100:103], a[136:139], a[44:47], v[100:103]
    v_exp_f32 v80, -v80
    v_mfma_f32_16x16x32_bf16 v[48:51], a[140:143], a[32:35], v[48:51]
    s_waitcnt lgkmcnt(4)
    ds_read_b128 a[132:135], v6 offset:44032
    global_load_dwordx4 a[8:11], v8, s[50:51] sc1
    v_mfma_f32_16x16x32_bf16 v[52:55], a[140:143], a[36:39], v[52:55]
    v_exp_f32 v81, -v81
    v_mfma_f32_16x16x32_bf16 v[104:107], a[144:147], a[40:43], v[104:107]
    s_waitcnt lgkmcnt(4)
    ds_read_b128 a[136:139], v7 offset:47104
    v_add_f32 v80, 1.0, v80
    v_mfma_f32_16x16x32_bf16 v[108:111], a[144:147], a[44:47], v[108:111]
    v_exp_f32 v82, -v82
    v_mfma_f32_16x16x32_bf16 v[56:59], a[148:151], a[32:35], v[56:59]
    s_waitcnt lgkmcnt(4)
    ds_read_b128 a[140:143], v6 offset:45056
    global_load_dwordx4 a[12:15], v10, s[50:51] sc1
    v_mfma_f32_16x16x32_bf16 v[60:63], a[148:151], a[36:39], v[60:63]
    v_exp_f32 v83, -v83
    v_mfma_f32_16x16x32_bf16 v[96:99], a[152:155], a[48:51], v[96:99]
    s_waitcnt lgkmcnt(4)
    ds_read_b128 a[144:147], v7 offset:48128
    v_add_f32 v81, 1.0, v81
    v_mfma_f32_16x16x32_bf16 v[100:103], a[152:155], a[52:55], v[100:103]
    v_exp_f32 v84, -v84
    v_mfma_f32_16x16x32_bf16 v[48:51], a[156:159], a[40:43], v[48:51]
    s_waitcnt lgkmcnt(4)
    ds_read_b128 a[148:151], v6 offset:46080
    v_add_f32 v82, 1.0, v82
    v_mfma_f32_16x16x32_bf16 v[52:55], a[156:159], a[44:47], v[52:55]
    s_add_u32 s50, s25, 4096
    global_load_dwordx4 a[16:19], v3, s[50:51] sc1
    v_add_f32 v83, 1.0, v83
    v_mfma_f32_16x16x32_bf16 v[104:107], a[128:131], a[48:51], v[104:107]
    s_waitcnt lgkmcnt(4)
    ds_read_b128 a[152:155], v6 offset:0
    v_add_f32 v84, 1.0, v84
    v_mfma_f32_16x16x32_bf16 v[108:111], a[128:131], a[52:55], v[108:111]
    v_exp_f32 v85, -v85
    v_mfma_f32_16x16x32_bf16 v[56:59], a[132:135], a[40:43], v[56:59]
    s_waitcnt lgkmcnt(4)
    ds_read_b128 a[156:159], v6 offset:47104
    global_load_dwordx4 a[20:23], v4, s[50:51] sc1
    v_mfma_f32_16x16x32_bf16 v[60:63], a[132:135], a[44:47], v[60:63]
    v_exp_f32 v86, -v86
    v_mfma_f32_16x16x32_bf16 v[96:99], a[136:139], a[56:59], v[96:99]
    s_waitcnt lgkmcnt(4)
    ds_read_b128 a[128:131], v6 offset:1024
    v_add_f32 v85, 1.0, v85
    v_mfma_f32_16x16x32_bf16 v[100:103], a[136:139], a[60:63], v[100:103]
    v_exp_f32 v87, -v87
    v_mfma_f32_16x16x32_bf16 v[48:51], a[140:143], a[48:51], v[48:51]
    s_waitcnt lgkmcnt(4)
    ds_read_b128 a[132:135], v6 offset:48128
    global_load_dwordx4 a[24:27], v8, s[50:51] sc1
    v_mfma_f32_16x16x32_bf16 v[52:55], a[140:143], a[52:55], v[52:55]
    v_rcp_f32 v80, v80
    v_mfma_f32_16x16x32_bf16 v[104:107], a[144:147], a[56:59], v[104:107]
    s_waitcnt lgkmcnt(4)
    ds_read_b128 a[136:139], v6 offset:2048
    v_add_f32 v86, 1.0, v86
    v_mfma_f32_16x16x32_bf16 v[108:111], a[144:147], a[60:63], v[108:111]
    v_rcp_f32 v81, v81
    v_mfma_f32_16x16x32_bf16 v[56:59], a[148:151], a[48:51], v[56:59]
    s_waitcnt lgkmcnt(4)
    ds_read_b128 a[140:143], v9 offset:0
    global_load_dwordx4 a[28:31], v10, s[50:51] sc1
    v_mfma_f32_16x16x32_bf16 v[60:63], a[148:151], a[52:55], v[60:63]
    v_rcp_f32 v82, v82
    v_mfma_f32_16x16x32_bf16 v[96:99], a[152:155], a[64:67], v[96:99]
    s_waitcnt lgkmcnt(4)
    ds_read_b128 a[144:147], v6 offset:3072
    v_add_f32 v87, 1.0, v87
    v_mfma_f32_16x16x32_bf16 v[100:103], a[152:155], a[68:71], v[100:103]
    v_rcp_f32 v83, v83
    v_mfma_f32_16x16x32_bf16 v[48:51], a[156:159], a[56:59], v[48:51]
    s_waitcnt lgkmcnt(4)
    ds_read_b128 a[148:151], v9 offset:1024
    v_mul_f32 v80, v80, v88
    v_mfma_f32_16x16x32_bf16 v[52:55], a[156:159], a[60:63], v[52:55]
    v_rcp_f32 v84, v84
    v_mfma_f32_16x16x32_bf16 v[104:107], a[128:131], a[64:67], v[104:107]
    s_waitcnt lgkmcnt(4)
    ds_read_b128 a[152:155], v6 offset:4096
    v_mul_f32 v81, v81, v89
    v_mfma_f32_16x16x32_bf16 v[108:111], a[128:131], a[68:71], v[108:111]
    v_mul_f32 v82, v82, v90
    v_mul_f32 v83, v83, v91
    v_mfma_f32_16x16x32_bf16 v[56:59], a[132:135], a[56:59], v[56:59]
    s_waitcnt lgkmcnt(4)
    ds_read_b128 a[156:159], v9 offset:2048
    v_mul_f32 v84, v84, v92
    v_mfma_f32_16x16x32_bf16 v[60:63], a[132:135], a[60:63], v[60:63]
    v_rcp_f32 v85, v85
    v_mfma_f32_16x16x32_bf16 v[96:99], a[136:139], a[72:75], v[96:99]
    s_waitcnt lgkmcnt(4)
    ds_read_b128 a[128:131], v6 offset:5120
    v_mul_f32 v85, v85, v93
    v_mfma_f32_16x16x32_bf16 v[100:103], a[136:139], a[76:79], v[100:103]
    s_add_u32 s50, s24, 8192
    global_load_dwordx4 a[32:35], v3, s[50:51] sc1
    v_cvt_pk_bf16_f32 v80, v80, v81
    v_mfma_f32_16x16x32_bf16 v[48:51], a[140:143], a[64:67], v[48:51]
    s_waitcnt lgkmcnt(4)
    ds_read_b128 a[132:135], v9 offset:3072
    v_cvt_pk_bf16_f32 v81, v82, v83
    v_mfma_f32_16x16x32_bf16 v[52:55], a[140:143], a[68:71], v[52:55]
    v_rcp_f32 v86, v86
    v_mfma_f32_16x16x32_bf16 v[104:107], a[144:147], a[72:75], v[104:107]
    s_waitcnt lgkmcnt(4)
    ds_read_b128 a[136:139], v6 offset:6144
    global_load_dwordx4 a[36:39], v4, s[50:51] sc1
    v_mfma_f32_16x16x32_bf16 v[108:111], a[144:147], a[76:79], v[108:111]
    v_rcp_f32 v87, v87
    v_mfma_f32_16x16x32_bf16 v[56:59], a[148:151], a[64:67], v[56:59]
    s_waitcnt lgkmcnt(4)
    ds_read_b128 a[140:143], v9 offset:4096
    v_mul_f32 v86, v86, v94
    v_mfma_f32_16x16x32_bf16 v[60:63], a[148:151], a[68:71], v[60:63]
    v_mul_f32 v87, v87, v95
    v_cvt_pk_bf16_f32 v82, v84, v85
    v_mfma_f32_16x16x32_bf16 v[96:99], a[152:155], a[80:83], v[96:99]
    s_waitcnt lgkmcnt(4)
    ds_read_b128 a[144:147], v6 offset:7168
    global_load_dwordx4 a[40:43], v8, s[50:51] sc1
    v_mfma_f32_16x16x32_bf16 v[100:103], a[152:155], a[84:87], v[100:103]
    v_cvt_pk_bf16_f32 v83, v86, v87
    v_permlane32_swap_b32 v80, v82
    v_mfma_f32_16x16x32_bf16 v[48:51], a[156:159], a[72:75], v[48:51]
    s_waitcnt lgkmcnt(4)
    ds_read_b128 a[148:151], v9 offset:5120
    v_permlane32_swap_b32 v81, v83
    v_mfma_f32_16x16x32_bf16 v[52:55], a[156:159], a[76:79], v[52:55]
    v_mfma_f32_16x16x32_bf16 v[104:107], a[128:131], a[80:83], v[104:107]
    s_waitcnt lgkmcnt(4)
L_w9:
    s_cbranch_execz L_w10
    ds_read_b128 a[152:155], v6 offset:8192
    v_mfma_f32_16x16x32_bf16 v[108:111], a[128:131], a[84:87], v[108:111]
    s_add_u32 s52, s97, 16384
    global_store_dwordx4 v7, v[80:83], s[52:53] sc1
    v_mfma_f32_16x16x32_bf16 v[56:59], a[132:135], a[72:75], v[56:59]
    s_waitcnt lgkmcnt(4)
    ds_read_b128 a[156:159], v9 offset:6144
    v_mfma_f32_16x16x32_bf16 v[60:63], a[132:135], a[76:79], v[60:63]
    v_mfma_f32_16x16x32_bf16 v[96:99], a[136:139], a[88:91], v[96:99]
    s_waitcnt lgkmcnt(4)
    ds_read_b128 a[128:131], v6 offset:9216
    global_load_dwordx4 a[44:47], v10, s[50:51] sc1
    v_mfma_f32_16x16x32_bf16 v[100:103], a[136:139], a[92:95], v[100:103]
    v_mfma_f32_16x16x32_bf16 v[48:51], a[140:143], a[80:83], v[48:51]
    s_waitcnt lgkmcnt(4)
    ds_read_b128 a[132:135], v9 offset:7168
    v_mfma_f32_16x16x32_bf16 v[52:55], a[140:143], a[84:87], v[52:55]
    v_mfma_f32_16x16x32_bf16 v[104:107], a[144:147], a[88:91], v[104:107]
    s_waitcnt lgkmcnt(4)
    ds_read_b128 a[136:139], v6 offset:10240
    v_mfma_f32_16x16x32_bf16 v[108:111], a[144:147], a[92:95], v[108:111]
    s_add_u32 s50, s25, 8192
    global_load_dwordx4 a[48:51], v3, s[50:51] sc1
    v_mfma_f32_16x16x32_bf16 v[56:59], a[148:151], a[80:83], v[56:59]
    s_waitcnt lgkmcnt(4)
    ds_read_b128 a[140:143], v9 offset:8192
    v_mfma_f32_16x16x32_bf16 v[60:63], a[148:151], a[84:87], v[60:63]
    v_mfma_f32_16x16x32_bf16 v[96:99], a[152:155], a[96:99], v[96:99]
    s_waitcnt lgkmcnt(4)
    ds_read_b128 a[144:147], v6 offset:11264
    global_load_dwordx4 a[52:55], v4, s[50:51] sc1
    v_mfma_f32_16x16x32_bf16 v[100:103], a[152:155], a[100:103], v[100:103]
    v_mfma_f32_16x16x32_bf16 v[48:51], a[156:159], a[88:91], v[48:51]
    s_waitcnt lgkmcnt(4)
    ds_read_b128 a[148:151], v9 offset:9216
    v_mfma_f32_16x16x32_bf16 v[52:55], a[156:159], a[92:95], v[52:55]
    v_mfma_f32_16x16x32_bf16 v[104:107], a[128:131], a[96:99], v[104:107]
    s_waitcnt lgkmcnt(4)
    ds_read_b128 a[152:155], v6 offset:12288
    global_load_dwordx4 a[56:59], v8, s[50:51] sc1
    v_mfma_f32_16x16x32_bf16 v[108:111], a[128:131], a[100:103], v[108:111]
    v_mfma_f32_16x16x32_bf16 v[56:59], a[132:135], a[88:91], v[56:59]
    s_waitcnt lgkmcnt(4)
    ds_read_b128 a[156:159], v9 offset:10240
    v_mfma_f32_16x16x32_bf16 v[60:63], a[132:135], a[92:95], v[60:63]
    v_mfma_f32_16x16x32_bf16 v[96:99], a[136:139], a[104:107], v[96:99]
    s_waitcnt lgkmcnt(4)
    ds_read_b128 a[128:131], v6 offset:13312
    global_load_dwordx4 a[60:63], v10, s[50:51] sc1
    v_mfma_f32_16x16x32_bf16 v[100:103], a[136:139], a[108:111], v[100:103]
    v_mfma_f32_16x16x32_bf16 v[48:51], a[140:143], a[96:99], v[48:51]
    s_waitcnt lgkmcnt(4)
    ds_read_b128 a[132:135], v9 offset:11264
    v_mfma_f32_16x16x32_bf16 v[52:55], a[140:143], a[100:103], v[52:55]
    v_mfma_f32_16x16x32_bf16 v[104:107], a[144:147], a[104:107], v[104:107]
    s_waitcnt lgkmcnt(4)
    ds_read_b128 a[136:139], v6 offset:14336
    v_mfma_f32_16x16x32_bf16 v[108:111], a[144:147], a[108:111], v[108:111]
    v_mfma_f32_16x16x32_bf16 v[56:59], a[148:151], a[96:99], v[56:59]
    s_waitcnt lgkmcnt(4)
    ds_read_b128 a[140:143], v9 offset:12288
    v_mfma_f32_16x16x32_bf16 v[60:63], a[148:151], a[100:103], v[60:63]
    v_mfma_f32_16x16x32_bf16 v[96:99], a[152:155], a[112:115], v[96:99]
    s_waitcnt lgkmcnt(4)
    ds_read_b128 a[144:147], v6 offset:15360
    v_mfma_f32_16x16x32_bf16 v[100:103], a[152:155], a[116:119], v[100:103]
    v_mfma_f32_16x16x32_bf16 v[48:51], a[156:159], a[104:107], v[48:51]
    s_waitcnt lgkmcnt(4)
    ds_read_b128 a[148:151], v9 offset:13312
    v_mfma_f32_16x16x32_bf16 v[52:55], a[156:159], a[108:111], v[52:55]
    s_add_u32 s50, s24, 12288
    global_load_dwordx4 a[64:67], v3, s[50:51] sc1
    v_mfma_f32_16x16x32_bf16 v[104:107], a[128:131], a[112:115], v[104:107]
    s_waitcnt lgkmcnt(4)
    ds_read_b128 a[152:155], v9 offset:14336
    v_mfma_f32_16x16x32_bf16 v[108:111], a[128:131], a[116:119], v[108:111]
    v_mfma_f32_16x16x32_bf16 v[56:59], a[132:135], a[104:107], v[56:59]
    s_waitcnt lgkmcnt(4)
    ds_read_b128 a[156:159], v9 offset:15360
    global_load_dwordx4 a[68:71], v4, s[50:51] sc1
    v_mfma_f32_16x16x32_bf16 v[60:63], a[132:135], a[108:111], v[60:63]
    v_mfma_f32_16x16x32_bf16 v[96:99], a[136:139], a[120:123], v[96:99]
    s_waitcnt lgkmcnt(4)
    v_mfma_f32_16x16x32_bf16 v[100:103], a[136:139], a[124:127], v[100:103]
    v_mfma_f32_16x16x32_bf16 v[48:51], a[140:143], a[112:115], v[48:51]
    s_waitcnt lgkmcnt(3)
    global_load_dwordx4 a[72:75], v8, s[50:51] sc1
    v_mfma_f32_16x16x32_bf16 v[52:55], a[140:143], a[116:119], v[52:55]
    v_mfma_f32_16x16x32_bf16 v[104:107], a[144:147], a[120:123], v[104:107]
    s_waitcnt vmcnt(25) lgkmcnt(2)
    v_max3_u32 v112, v16, v20, v24
    v_max_u32 v112, v112, v28
    v_cmp_eq_u32 vcc, -1, v112
    v_mfma_f32_16x16x32_bf16 v[108:111], a[144:147], a[124:127], v[108:111]
    v_mfma_f32_16x16x32_bf16 v[56:59], a[148:151], a[112:115], v[56:59]
    s_waitcnt lgkmcnt(1)
    s_cbranch_vccnz L_hh0_r
L_hh0_ok:
    global_load_dwordx4 a[76:79], v10, s[50:51] sc1
    v_mfma_f32_16x16x32_bf16 v[60:63], a[148:151], a[116:119], v[60:63]
    v_mfma_f32_16x16x32_bf16 v[48:51], a[152:155], a[120:123], v[48:51]
    s_waitcnt lgkmcnt(0)
    v_exp_f32 v96, -v96
    v_mfma_f32_16x16x32_bf16 v[52:55], a[152:155], a[124:127], v[52:55]
    v_exp_f32 v97, -v97
    v_mfma_f32_16x16x32_bf16 v[56:59], a[156:159], a[120:123], v[56:59]
    s_waitcnt vmcnt(32)
    v_exp_f32 v98, -v98
    v_add_f32 v96, 1.0, v96
    v_mfma_f32_16x16x32_bf16 v[60:63], a[156:159], a[124:127], v[60:63]
    s_add_u32 s50, s25, 12288
    global_load_dwordx4 a[80:83], v3, s[50:51] sc1
    v_add_f32 v97, 1.0, v97
    v_mfma_f32_16x16x32_bf16 v[64:67], v[16:19], v[152:155], 0
    v_exp_f32 v99, -v99
    v_add_f32 v98, 1.0, v98
    v_mfma_f32_16x16x32_bf16 v[68:71], v[16:19], v[156:159], 0
    v_exp_f32 v100, -v100
    v_add_f32 v99, 1.0, v99
    v_mfma_f32_16x16x32_bf16 v[72:75], v[16:19], v[160:163], 0
    global_load_dwordx4 a[84:87], v4, s[50:51] sc1
    v_exp_f32 v101, -v101
    v_mfma_f32_16x16x32_bf16 v[76:79], v[16:19], v[164:167], 0
    v_exp_f32 v102, -v102
    v_add_f32 v100, 1.0, v100
    v_mfma_f32_16x16x32_bf16 v[80:83], v[20:23], v[152:155], 0
    v_exp_f32 v103, -v103
    v_add_f32 v101, 1.0, v101
    v_mfma_f32_16x16x32_bf16 v[84:87], v[20:23], v[156:159], 0
    v_rcp_f32 v96, v96
    v_add_f32 v102, 1.0, v102
    v_mfma_f32_16x16x32_bf16 v[88:91], v[20:23], v[160:163], 0
    global_load_dwordx4 a[88:91], v8, s[50:51] sc1
    v_rcp_f32 v97, v97
    v_mfma_f32_16x16x32_bf16 v[92:95], v[20:23], v[164:167], 0
    v_rcp_f32 v98, v98
    v_add_f32 v103, 1.0, v103
    v_mfma_f32_16x16x32_bf16 a[96:99], v[24:27], v[152:155], 0
    s_waitcnt vmcnt(25)
    v_max3_u32 v112, v32, v36, v40
    v_max_u32 v112, v112, v44
    v_cmp_eq_u32 vcc, -1, v112
    v_mfma_f32_16x16x32_bf16 a[100:103], v[24:27], v[156:159], 0
    v_rcp_f32 v99, v99
    v_mul_f32 v96, v96, v104
    v_mfma_f32_16x16x32_bf16 a[104:107], v[24:27], v[160:163], 0
    s_cbranch_vccnz L_hh1_r
L_hh1_ok:
    global_load_dwordx4 a[92:95], v10, s[50:51] sc1
    v_rcp_f32 v100, v100
    v_mfma_f32_16x16x32_bf16 a[108:111], v[24:27], v[164:167], 0
    v_rcp_f32 v101, v101
    v_mul_f32 v97, v97, v105
    v_mfma_f32_16x16x32_bf16 a[112:115], v[28:31], v[152:155], 0
    v_rcp_f32 v102, v102
    v_mul_f32 v98, v98, v106
    v_mfma_f32_16x16x32_bf16 a[116:119], v[28:31], v[156:159], 0
    v_rcp_f32 v103, v103
    v_mul_f32 v99, v99, v107
    v_mfma_f32_16x16x32_bf16 a[120:123], v[28:31], v[160:163], 0
    v_mul_f32 v100, v100, v108
    v_mul_f32 v101, v101, v109
    v_mul_f32 v102, v102, v110
    v_mfma_f32_16x16x32_bf16 a[124:127], v[28:31], v[164:167], 0
    v_mul_f32 v103, v103, v111
    v_cvt_pk_bf16_f32 v96, v96, v97
    v_mfma_f32_16x16x32_bf16 v[64:67], v[32:35], v[168:171], v[64:67]
    v_cvt_pk_bf16_f32 v97, v98, v99
    v_exp_f32 v48, -v48
    v_mfma_f32_16x16x32_bf16 v[68:71], v[32:35], v[172:175], v[68:71]
    v_cvt_pk_bf16_f32 v98, v100, v101
    v_exp_f32 v49, -v49
    v_mfma_f32_16x16x32_bf16 v[72:75], v[32:35], v[200:203], v[72:75]
    v_cvt_pk_bf16_f32 v99, v102, v103
    v_permlane32_swap_b32 v96, v98
    v_add_f32 v48, 1.0, v48
    v_mfma_f32_16x16x32_bf16 v[76:79], v[32:35], v[204:207], v[76:79]
    v_permlane32_swap_b32 v97, v99
    v_exp_f32 v50, -v50
    v_mfma_f32_16x16x32_bf16 v[80:83], v[36:39], v[168:171], v[80:83]
    s_add_u32 s52, s97, 20480
    global_store_dwordx4 v7, v[96:99], s[52:53] sc1
    v_exp_f32 v51, -v51
    v_mfma_f32_16x16x32_bf16 v[84:87], v[36:39], v[172:175], v[84:87]
    v_exp_f32 v52, -v52
    v_add_f32 v49, 1.0, v49
    v_mfma_f32_16x16x32_bf16 v[88:91], v[36:39], v[200:203], v[88:91]
    v_exp_f32 v53, -v53
    v_add_f32 v50, 1.0, v50
    v_mfma_f32_16x16x32_bf16 v[92:95], v[36:39], v[204:207], v[92:95]
    v_exp_f32 v54, -v54
    v_add_f32 v51, 1.0, v51
    v_mfma_f32_16x16x32_bf16 a[96:99], v[40:43], v[168:171], a[96:99]
    s_waitcnt vmcnt(22)
    v_accvgpr_read_b32 v112, a0
    v_accvgpr_read_b32 v113, a4
    v_accvgpr_read_b32 v114, a8
    v_mfma_f32_16x16x32_bf16 a[100:103], v[40:43], v[172:175], a[100:103]
    v_accvgpr_read_b32 v115, a12
    v_max3_u32 v112, v112, v113, v114
    v_max_u32 v112, v112, v115
    v_mfma_f32_16x16x32_bf16 a[104:107], v[40:43], v[200:203], a[104:107]
    v_cmp_eq_u32 vcc, -1, v112
    v_exp_f32 v55, -v55
    v_mfma_f32_16x16x32_bf16 a[108:111], v[40:43], v[204:207], a[108:111]
    v_rcp_f32 v48, v48
    v_add_f32 v52, 1.0, v52
    v_mfma_f32_16x16x32_bf16 a[112:115], v[44:47], v[168:171], a[112:115]
    s_cbranch_vccnz L_hh2_r
L_hh2_ok:
    s_add_u32 s50, s24, 16384
    global_load_dwordx4 a[128:131], v3, s[50:51] sc1
    v_add_f32 v53, 1.0, v53
    v_add_f32 v54, 1.0, v54
    v_mfma_f32_16x16x32_bf16 a[116:119], v[44:47], v[172:175], a[116:119]
    v_rcp_f32 v49, v49
    v_add_f32 v55, 1.0, v55
    v_mfma_f32_16x16x32_bf16 a[120:123], v[44:47], v[200:203], a[120:123]
    v_rcp_f32 v50, v50
    v_mul_f32 v48, v48, v56
    v_mfma_f32_16x16x32_bf16 a[124:127], v[44:47], v[204:207], a[124:127]
    v_rcp_f32 v51, v51
    v_mul_f32 v49, v49, v57
    v_mfma_f32_16x16x32_bf16 v[64:67], a[0:3], v[208:211], v[64:67]
    global_load_dwordx4 a[132:135], v4, s[50:51] sc1
    v_rcp_f32 v52, v52
    v_mfma_f32_16x16x32_bf16 v[68:71], a[0:3], v[212:215], v[68:71]
    v_rcp_f32 v53, v53
    v_mul_f32 v50, v50, v58
    v_mfma_f32_16x16x32_bf16 v[72:75], a[0:3], v[216:219], v[72:75]
    v_rcp_f32 v54, v54
    v_mul_f32 v51, v51, v59
    v_mfma_f32_16x16x32_bf16 v[76:79], a[0:3], v[220:223], v[76:79]
    v_rcp_f32 v55, v55
    v_mul_f32 v52, v52, v60
    v_mfma_f32_16x16x32_bf16 v[80:83], a[4:7], v[208:211], v[80:83]
    global_load_dwordx4 a[136:139], v8, s[50:51] sc1
    v_mul_f32 v53, v53, v61
    v_mul_f32 v54, v54, v62
    v_mfma_f32_16x16x32_bf16 v[84:87], a[4:7], v[212:215], v[84:87]
    v_mul_f32 v55, v55, v63
    v_cvt_pk_bf16_f32 v48, v48, v49
    v_mfma_f32_16x16x32_bf16 v[88:91], a[4:7], v[216:219], v[88:91]
    v_cvt_pk_bf16_f32 v49, v50, v51
    v_mfma_f32_16x16x32_bf16 v[92:95], a[4:7], v[220:223], v[92:95]
    v_cvt_pk_bf16_f32 v50, v52, v53
    v_mfma_f32_16x16x32_bf16 a[96:99], a[8:11], v[208:211], a[96:99]
    s_waitcnt vmcnt(21)
    v_accvgpr_read_b32 v112, a16
    v_accvgpr_read_b32 v113, a20
    v_accvgpr_read_b32 v114, a24
    v_mfma_f32_16x16x32_bf16 a[100:103], a[8:11], v[212:215], a[100:103]
    v_accvgpr_read_b32 v115, a28
    v_max3_u32 v112, v112, v113, v114
    v_max_u32 v112, v112, v115
    v_mfma_f32_16x16x32_bf16 a[104:107], a[8:11], v[216:219], a[104:107]
    global_load_dwordx4 a[140:143], v10, s[50:51] sc1
    v_cmp_eq_u32 vcc, -1, v112
    v_cvt_pk_bf16_f32 v51, v54, v55
    v_mfma_f32_16x16x32_bf16 a[108:111], a[8:11], v[220:223], a[108:111]
    v_permlane32_swap_b32 v48, v50
    v_permlane32_swap_b32 v49, v51
    v_mfma_f32_16x16x32_bf16 a[112:115], a[12:15], v[208:211], a[112:115]
    s_cbranch_vccnz L_hh3_r
L_hh3_ok:
    s_add_u32 s52, s97, 24576
    global_store_dwordx4 v7, v[48:51], s[52:53] sc1
    v_mfma_f32_16x16x32_bf16 a[116:119], a[12:15], v[212:215], a[116:119]
    v_mfma_f32_16x16x32_bf16 a[120:123], a[12:15], v[216:219], a[120:123]
    v_mfma_f32_16x16x32_bf16 a[124:127], a[12:15], v[220:223], a[124:127]
    v_mfma_f32_16x16x32_bf16 v[64:67], a[16:19], v[224:227], v[64:67]
    s_add_u32 s50, s25, 16384
    global_load_dwordx4 a[144:147], v3, s[50:51] sc1
    v_mfma_f32_16x16x32_bf16 v[68:71], a[16:19], v[228:231], v[68:71]
    v_mfma_f32_16x16x32_bf16 v[72:75], a[16:19], v[232:235], v[72:75]
    v_mfma_f32_16x16x32_bf16 v[76:79], a[16:19], v[236:239], v[76:79]
    v_mfma_f32_16x16x32_bf16 v[80:83], a[20:23], v[224:227], v[80:83]
    s_barrier
    global_load_dwordx4 a[148:151], v4, s[50:51] sc1
    v_mfma_f32_16x16x32_bf16 v[84:87], a[20:23], v[228:231], v[84:87]
    v_mfma_f32_16x16x32_bf16 v[88:91], a[20:23], v[232:235], v[88:91]
    global_load_dwordx4 v[116:119], v0, s[62:63]
    v_mfma_f32_16x16x32_bf16 v[92:95], a[20:23], v[236:239], v[92:95]
    v_mfma_f32_16x16x32_bf16 a[96:99], a[24:27], v[224:227], a[96:99]
    s_waitcnt vmcnt(21)
    v_accvgpr_read_b32 v112, a32
    v_accvgpr_read_b32 v113, a36
    v_accvgpr_read_b32 v114, a40
    v_mfma_f32_16x16x32_bf16 a[100:103], a[24:27], v[228:231], a[100:103]
    v_accvgpr_read_b32 v115, a44
    v_max3_u32 v112, v112, v113, v114
    v_max_u32 v112, v112, v115
    v_mfma_f32_16x16x32_bf16 a[104:107], a[24:27], v[232:235], a[104:107]
    global_load_dwordx4 a[152:155], v8, s[50:51] sc1
    v_cmp_eq_u32 vcc, -1, v112
    v_mfma_f32_16x16x32_bf16 a[108:111], a[24:27], v[236:239], a[108:111]
    v_mfma_f32_16x16x32_bf16 a[112:115], a[28:31], v[224:227], a[112:115]
    s_cbranch_vccnz L_hh4_r
L_hh4_ok:
    global_load_dwordx2 v[128:129], v15, s[58:59] offset:0 sc1
    v_mfma_f32_16x16x32_bf16 a[116:119], a[28:31], v[228:231], a[116:119]
    v_mfma_f32_16x16x32_bf16 a[120:123], a[28:31], v[232:235], a[120:123]
    global_load_dwordx4 a[156:159], v10, s[50:51] sc1
    v_mfma_f32_16x16x32_bf16 a[124:127], a[28:31], v[236:239], a[124:127]
    v_mfma_f32_16x16x32_bf16 v[64:67], a[32:35], v[240:243], v[64:67]
    global_load_dwordx2 v[130:131], v15, s[58:59] offset:1024 sc1
    v_mfma_f32_16x16x32_bf16 v[68:71], a[32:35], v[244:247], v[68:71]
    v_mfma_f32_16x16x32_bf16 v[72:75], a[32:35], v[176:179], v[72:75]
    global_load_dwordx2 v[132:133], v15, s[58:59] offset:2048 sc1
    v_mfma_f32_16x16x32_bf16 v[76:79], a[32:35], v[180:183], v[76:79]
    v_mfma_f32_16x16x32_bf16 v[80:83], a[36:39], v[240:243], v[80:83]
    global_load_dwordx2 v[134:135], v15, s[58:59] offset:3072 sc1
    v_mfma_f32_16x16x32_bf16 v[84:87], a[36:39], v[244:247], v[84:87]
    v_mfma_f32_16x16x32_bf16 v[88:91], a[36:39], v[176:179], v[88:91]
    v_mfma_f32_16x16x32_bf16 v[92:95], a[36:39], v[180:183], v[92:95]
    v_mfma_f32_16x16x32_bf16 a[96:99], a[40:43], v[240:243], a[96:99]
    s_waitcnt vmcnt(23)
    v_accvgpr_read_b32 v112, a48
    v_accvgpr_read_b32 v113, a52
    v_accvgpr_read_b32 v114, a56
    v_mfma_f32_16x16x32_bf16 a[100:103], a[40:43], v[244:247], a[100:103]
    v_accvgpr_read_b32 v115, a60
    v_max3_u32 v112, v112, v113, v114
    v_max_u32 v112, v112, v115
    v_mfma_f32_16x16x32_bf16 a[104:107], a[40:43], v[176:179], a[104:107]
    v_cmp_eq_u32 vcc, -1, v112
    v_mfma_f32_16x16x32_bf16 a[108:111], a[40:43], v[180:183], a[108:111]
    v_mfma_f32_16x16x32_bf16 a[112:115], a[44:47], v[240:243], a[112:115]
    s_cbranch_vccnz L_hh5_r
L_hh5_ok:
    v_mfma_f32_16x16x32_bf16 a[116:119], a[44:47], v[244:247], a[116:119]
    v_mfma_f32_16x16x32_bf16 a[120:123], a[44:47], v[176:179], a[120:123]
    v_mfma_f32_16x16x32_bf16 a[124:127], a[44:47], v[180:183], a[124:127]
    v_mfma_f32_16x16x32_bf16 v[64:67], a[48:51], v[184:187], v[64:67]
    s_add_u32 s50, s24, 20480
    global_load_dwordx4 a[0:3], v3, s[50:51] sc1
    v_mfma_f32_16x16x32_bf16 v[68:71], a[48:51], v[188:191], v[68:71]
    v_mfma_f32_16x16x32_bf16 v[72:75], a[48:51], v[192:195], v[72:75]
    v_mfma_f32_16x16x32_bf16 v[76:79], a[48:51], v[196:199], v[76:79]
    v_mfma_f32_16x16x32_bf16 v[80:83], a[52:55], v[184:187], v[80:83]
    global_load_dwordx4 a[4:7], v4, s[50:51] sc1
    v_mfma_f32_16x16x32_bf16 v[84:87], a[52:55], v[188:191], v[84:87]
    v_mfma_f32_16x16x32_bf16 v[88:91], a[52:55], v[192:195], v[88:91]
    v_mfma_f32_16x16x32_bf16 v[92:95], a[52:55], v[196:199], v[92:95]
    v_mfma_f32_16x16x32_bf16 a[96:99], a[56:59], v[184:187], a[96:99]
    s_waitcnt vmcnt(21)
    v_accvgpr_read_b32 v112, a64
    v_accvgpr_read_b32 v113, a68
    v_accvgpr_read_b32 v114, a72
    v_mfma_f32_16x16x32_bf16 a[100:103], a[56:59], v[188:191], a[100:103]
    v_accvgpr_read_b32 v115, a76
    v_max3_u32 v112, v112, v113, v114
    v_max_u32 v112, v112, v115
    v_mfma_f32_16x16x32_bf16 a[104:107], a[56:59], v[192:195], a[104:107]
    global_load_dwordx4 a[8:11], v8, s[50:51] sc1
    v_cmp_eq_u32 vcc, -1, v112
    v_mfma_f32_16x16x32_bf16 a[108:111], a[56:59], v[196:199], a[108:111]
    v_mfma_f32_16x16x32_bf16 a[112:115], a[60:63], v[184:187], a[112:115]
    s_cbranch_vccnz L_hh6_r
L_hh6_ok:
    v_mfma_f32_16x16x32_bf16 a[116:119], a[60:63], v[188:191], a[116:119]
    v_mfma_f32_16x16x32_bf16 a[120:123], a[60:63], v[192:195], a[120:123]
    global_load_dwordx4 a[12:15], v10, s[50:51] sc1
    v_mfma_f32_16x16x32_bf16 a[124:127], a[60:63], v[196:199], a[124:127]
    v_mfma_f32_16x16x32_bf16 v[64:67], a[64:67], v[136:139], v[64:67]
    v_mfma_f32_16x16x32_bf16 v[68:71], a[64:67], v[140:143], v[68:71]
    v_mfma_f32_16x16x32_bf16 v[72:75], a[64:67], v[144:147], v[72:75]
    s_add_u32 s50, s25, 20480
    global_load_dwordx4 a[16:19], v3, s[50:51] sc1
    v_mfma_f32_16x16x32_bf16 v[76:79], a[64:67], v[148:151], v[76:79]
    v_mfma_f32_16x16x32_bf16 v[80:83], a[68:71], v[136:139], v[80:83]
    v_mfma_f32_16x16x32_bf16 v[84:87], a[68:71], v[140:143], v[84:87]
    v_mfma_f32_16x16x32_bf16 v[88:91], a[68:71], v[144:147], v[88:91]
    global_load_dwordx4 a[20:23], v4, s[50:51] sc1
    v_mfma_f32_16x16x32_bf16 v[92:95], a[68:71], v[148:151], v[92:95]
    v_mfma_f32_16x16x32_bf16 a[96:99], a[72:75], v[136:139], a[96:99]
    s_waitcnt vmcnt(21)
    v_accvgpr_read_b32 v112, a80
    v_accvgpr_read_b32 v113, a84
    v_accvgpr_read_b32 v114, a88
    v_mfma_f32_16x16x32_bf16 a[100:103], a[72:75], v[140:143], a[100:103]
    v_accvgpr_read_b32 v115, a92
    v_max3_u32 v112, v112, v113, v114
    v_max_u32 v112, v112, v115
    v_mfma_f32_16x16x32_bf16 a[104:107], a[72:75], v[144:147], a[104:107]
    global_load_dwordx4 a[24:27], v8, s[50:51] sc1
    v_cmp_eq_u32 vcc, -1, v112
    v_mfma_f32_16x16x32_bf16 a[108:111], a[72:75], v[148:151], a[108:111]
    v_mfma_f32_16x16x32_bf16 a[112:115], a[76:79], v[136:139], a[112:115]
    s_cbranch_vccnz L_hh7_r
L_hh7_ok:
    v_mfma_f32_16x16x32_bf16 a[116:119], a[76:79], v[140:143], a[116:119]
    v_mfma_f32_16x16x32_bf16 a[120:123], a[76:79], v[144:147], a[120:123]
    global_load_dwordx4 a[28:31], v10, s[50:51] sc1
    v_mfma_f32_16x16x32_bf16 a[124:127], a[76:79], v[148:151], a[124:127]
    v_mfma_f32_16x16x32_bf16 v[64:67], a[80:83], v[248:251], v[64:67]
    v_mfma_f32_16x16x32_bf16 v[68:71], a[80:83], v[252:255], v[68:71]
    v_mfma_f32_16x16x32_bf16 v[72:75], a[80:83], a[192:195], v[72:75]
    s_add_u32 s50, s24, 24576
    global_load_dwordx4 a[32:35], v3, s[50:51] sc1
    v_mfma_f32_16x16x32_bf16 v[76:79], a[80:83], a[196:199], v[76:79]
    v_mfma_f32_16x16x32_bf16 v[80:83], a[84:87], v[248:251], v[80:83]
    v_mfma_f32_16x16x32_bf16 v[84:87], a[84:87], v[252:255], v[84:87]
    v_mfma_f32_16x16x32_bf16 v[88:91], a[84:87], a[192:195], v[88:91]
    global_load_dwordx4 a[36:39], v4, s[50:51] sc1
    v_mfma_f32_16x16x32_bf16 v[92:95], a[84:87], a[196:199], v[92:95]
    v_mfma_f32_16x16x32_bf16 a[96:99], a[88:91], v[248:251], a[96:99]
    s_waitcnt vmcnt(20)
    v_accvgpr_read_b32 v112, a128
    v_accvgpr_read_b32 v113, a132
    v_accvgpr_read_b32 v114, a136
    v_mfma_f32_16x16x32_bf16 a[100:103], a[88:91], v[252:255], a[100:103]
    v_accvgpr_read_b32 v115, a140
    v_max3_u32 v112, v112, v113, v114
    v_max_u32 v112, v112, v115
    v_mfma_f32_16x16x32_bf16 a[104:107], a[88:91], a[192:195], a[104:107]
    global_load_dwordx4 a[40:43], v8, s[50:51] sc1
    v_cmp_eq_u32 vcc, -1, v112
    v_mfma_f32_16x16x32_bf16 a[108:111], a[88:91], a[196:199], a[108:111]
    v_mfma_f32_16x16x32_bf16 a[112:115], a[92:95], v[248:251], a[112:115]
    s_cbranch_vccnz L_hh8_r
L_hh8_ok:
    v_mfma_f32_16x16x32_bf16 a[116:119], a[92:95], v[252:255], a[116:119]
    v_mfma_f32_16x16x32_bf16 a[120:123], a[92:95], a[192:195], a[120:123]
    global_load_dwordx4 a[44:47], v10, s[50:51] sc1
    v_mfma_f32_16x16x32_bf16 a[124:127], a[92:95], a[196:199], a[124:127]
    v_mfma_f32_16x16x32_bf16 v[64:67], a[128:131], a[224:227], v[64:67]
    v_mfma_f32_16x16x32_bf16 v[68:71], a[128:131], a[228:231], v[68:71]
    v_mfma_f32_16x16x32_bf16 v[72:75], a[128:131], a[232:235], v[72:75]
    s_add_u32 s50, s25, 24576
    global_load_dwordx4 a[48:51], v3, s[50:51] sc1
    v_mfma_f32_16x16x32_bf16 v[76:79], a[128:131], a[236:239], v[76:79]
    v_mfma_f32_16x16x32_bf16 v[80:83], a[132:135], a[224:227], v[80:83]
    v_mfma_f32_16x16x32_bf16 v[84:87], a[132:135], a[228:231], v[84:87]
    v_mfma_f32_16x16x32_bf16 v[88:91], a[132:135], a[232:235], v[88:91]
    global_load_dwordx4 a[52:55], v4, s[50:51] sc1
    v_mfma_f32_16x16x32_bf16 v[92:95], a[132:135], a[236:239], v[92:95]
    v_mfma_f32_16x16x32_bf16 a[96:99], a[136:139], a[224:227], a[96:99]
    s_waitcnt vmcnt(17)
    v_accvgpr_read_b32 v112, a144
    v_accvgpr_read_b32 v113, a148
    v_accvgpr_read_b32 v114, a152
    v_mfma_f32_16x16x32_bf16 a[100:103], a[136:139], a[228:231], a[100:103]
    v_accvgpr_read_b32 v115, a156
    v_max3_u32 v112, v112, v113, v114
    v_max_u32 v112, v112, v115
    v_mfma_f32_16x16x32_bf16 a[104:107], a[136:139], a[232:235], a[104:107]
    global_load_dwordx4 a[56:59], v8, s[50:51] sc1
    v_cmp_eq_u32 vcc, -1, v112
    v_mfma_f32_16x16x32_bf16 a[108:111], a[136:139], a[236:239], a[108:111]
    v_mfma_f32_16x16x32_bf16 a[112:115], a[140:143], a[224:227], a[112:115]
    s_cbranch_vccnz L_hh9_r
L_hh9_ok:
    v_mfma_f32_16x16x32_bf16 a[116:119], a[140:143], a[228:231], a[116:119]
    v_mfma_f32_16x16x32_bf16 a[120:123], a[140:143], a[232:235], a[120:123]
    global_load_dwordx4 a[60:63], v10, s[50:51] sc1
    v_mfma_f32_16x16x32_bf16 a[124:127], a[140:143], a[236:239], a[124:127]
    v_mfma_f32_16x16x32_bf16 v[64:67], a[144:147], a[208:211], v[64:67]
    v_mfma_f32_16x16x32_bf16 v[68:71], a[144:147], a[212:215], v[68:71]
    v_mfma_f32_16x16x32_bf16 v[72:75], a[144:147], a[240:243], v[72:75]
    v_mfma_f32_16x16x32_bf16 v[76:79], a[144:147], a[244:247], v[76:79]
    v_mfma_f32_16x16x32_bf16 v[80:83], a[148:151], a[208:211], v[80:83]
    v_mfma_f32_16x16x32_bf16 v[84:87], a[148:151], a[212:215], v[84:87]
    v_mfma_f32_16x16x32_bf16 v[88:91], a[148:151], a[240:243], v[88:91]
    v_mfma_f32_16x16x32_bf16 v[92:95], a[148:151], a[244:247], v[92:95]
    v_mfma_f32_16x16x32_bf16 a[96:99], a[152:155], a[208:211], a[96:99]
    s_waitcnt vmcnt(12)
    v_accvgpr_read_b32 v112, a0
    v_accvgpr_read_b32 v113, a4
    v_accvgpr_read_b32 v114, a8
    v_mfma_f32_16x16x32_bf16 a[100:103], a[152:155], a[212:215], a[100:103]
    v_accvgpr_read_b32 v115, a12
    v_max3_u32 v112, v112, v113, v114
    v_max_u32 v112, v112, v115
    v_mfma_f32_16x16x32_bf16 a[104:107], a[152:155], a[240:243], a[104:107]
    v_cmp_eq_u32 vcc, -1, v112
    v_mfma_f32_16x16x32_bf16 a[108:111], a[152:155], a[244:247], a[108:111]
    v_mfma_f32_16x16x32_bf16 a[112:115], a[156:159], a[208:211], a[112:115]
    s_cbranch_vccnz L_hh10_r
L_hh10_ok:
    v_mfma_f32_16x16x32_bf16 a[116:119], a[156:159], a[212:215], a[116:119]
    v_mfma_f32_16x16x32_bf16 a[120:123], a[156:159], a[240:243], a[120:123]
    v_mfma_f32_16x16x32_bf16 a[124:127], a[156:159], a[244:247], a[124:127]
    v_mfma_f32_16x16x32_bf16 v[80:83], a[4:7], a[200:203], v[80:83]
    v_mfma_f32_16x16x32_bf16 v[84:87], a[4:7], a[204:207], v[84:87]
    v_mfma_f32_16x16x32_bf16 v[88:91], a[4:7], a[248:251], v[88:91]
    s_waitcnt vmcnt(16)
    v_lshlrev_b32 v16, 16, v128
    v_and_b32 v17, 0xffff0000, v128
    v_lshlrev_b32 v18, 16, v129
    v_mfma_f32_16x16x32_bf16 v[92:95], a[4:7], a[252:255], v[92:95]
    v_and_b32 v19, 0xffff0000, v129
    v_lshlrev_b32 v20, 16, v130
    v_and_b32 v21, 0xffff0000, v130
    v_mfma_f32_16x16x32_bf16 a[96:99], a[8:11], a[200:203], a[96:99]
    s_waitcnt vmcnt(8)
    v_accvgpr_read_b32 v112, a16
    v_accvgpr_read_b32 v113, a20
    v_accvgpr_read_b32 v114, a24
    v_mfma_f32_16x16x32_bf16 a[100:103], a[8:11], a[204:207], a[100:103]
    v_accvgpr_read_b32 v115, a28
    v_max3_u32 v112, v112, v113, v114
    v_max_u32 v112, v112, v115
    v_mfma_f32_16x16x32_bf16 a[104:107], a[8:11], a[248:251], a[104:107]
    v_cmp_eq_u32 vcc, -1, v112
    v_lshlrev_b32 v22, 16, v131
    v_and_b32 v23, 0xffff0000, v131
    v_mfma_f32_16x16x32_bf16 a[108:111], a[8:11], a[252:255], a[108:111]
    v_lshlrev_b32 v24, 16, v132
    v_and_b32 v25, 0xffff0000, v132
    v_lshlrev_b32 v26, 16, v133
    v_mfma_f32_16x16x32_bf16 a[112:115], a[12:15], a[200:203], a[112:115]
    s_cbranch_vccnz L_hh11_r
L_hh11_ok:
    v_and_b32 v27, 0xffff0000, v133
    v_lshlrev_b32 v28, 16, v134
    v_and_b32 v29, 0xffff0000, v134
    v_mfma_f32_16x16x32_bf16 a[116:119], a[12:15], a[204:207], a[116:119]
    v_lshlrev_b32 v30, 16, v135
    v_and_b32 v31, 0xffff0000, v135
    v_mfma_f32_16x16x32_bf16 a[120:123], a[12:15], a[248:251], a[120:123]
    v_mfma_f32_16x16x32_bf16 a[124:127], a[12:15], a[252:255], a[124:127]
    v_mfma_f32_16x16x32_bf16 v[80:83], a[20:23], a[160:163], v[80:83]
    v_mfma_f32_16x16x32_bf16 v[84:87], a[20:23], a[164:167], v[84:87]
    v_mfma_f32_16x16x32_bf16 v[88:91], a[20:23], a[168:171], v[88:91]
    v_mfma_f32_16x16x32_bf16 v[92:95], a[20:23], a[172:175], v[92:95]
    v_mfma_f32_16x16x32_bf16 a[96:99], a[24:27], a[160:163], a[96:99]
    s_waitcnt vmcnt(4)
    v_accvgpr_read_b32 v112, a32
    v_accvgpr_read_b32 v113, a36
    v_accvgpr_read_b32 v114, a40
    v_mfma_f32_16x16x32_bf16 a[100:103], a[24:27], a[164:167], a[100:103]
    v_accvgpr_read_b32 v115, a44
    v_max3_u32 v112, v112, v113, v114
    v_max_u32 v112, v112, v115
    v_mfma_f32_16x16x32_bf16 a[104:107], a[24:27], a[168:171], a[104:107]
    v_cmp_eq_u32 vcc, -1, v112
    v_mfma_f32_16x16x32_bf16 a[108:111], a[24:27], a[172:175], a[108:111]
    v_mfma_f32_16x16x32_bf16 a[112:115], a[28:31], a[160:163], a[112:115]
    s_waitcnt vmcnt(0)
    s_cbranch_vccnz L_hh12_r
L_hh12_ok:
    v_accvgpr_read_b32 v112, a48
    v_accvgpr_read_b32 v113, a52
    v_accvgpr_read_b32 v114, a56
    v_mfma_f32_16x16x32_bf16 a[116:119], a[28:31], a[164:167], a[116:119]
    v_accvgpr_read_b32 v115, a60
    v_max3_u32 v112, v112, v113, v114
    v_max_u32 v112, v112, v115
    v_mfma_f32_16x16x32_bf16 a[120:123], a[28:31], a[168:171], a[120:123]
    v_cmp_eq_u32 vcc, -1, v112
    v_mfma_f32_16x16x32_bf16 a[124:127], a[28:31], a[172:175], a[124:127]
    v_mfma_f32_16x16x32_bf16 a[112:115], a[44:47], a[176:179], a[112:115]
    s_cbranch_vccnz L_hh13_r
L_hh13_ok:
    v_mfma_f32_16x16x32_bf16 a[116:119], a[44:47], a[180:183], a[116:119]
    v_mfma_f32_16x16x32_bf16 a[120:123], a[44:47], a[184:187], a[120:123]
    v_mfma_f32_16x16x32_bf16 a[124:127], a[44:47], a[188:191], a[124:127]
    v_mfma_f32_16x16x32_bf16 a[112:115], a[60:63], a[216:219], a[112:115]
    v_mfma_f32_16x16x32_bf16 a[116:119], a[60:63], a[220:223], a[116:119]
    v_mfma_f32_16x16x32_bf16 a[120:123], a[60:63], v[120:123], a[120:123]
    v_mfma_f32_16x16x32_bf16 a[124:127], a[60:63], v[124:127], a[124:127]
    v_mfma_f32_16x16x32_bf16 a[96:99], a[40:43], a[176:179], a[96:99]
    v_mfma_f32_16x16x32_bf16 a[100:103], a[40:43], a[180:183], a[100:103]
    s_nop 2
    ds_write_b128 v13, a[112:115] offset:57344
    v_mfma_f32_16x16x32_bf16 a[104:107], a[40:43], a[184:187], a[104:107]
    v_mfma_f32_16x16x32_bf16 a[108:111], a[40:43], a[188:191], a[108:111]
    ds_write_b128 v13, a[116:119] offset:58368
    v_mfma_f32_16x16x32_bf16 a[96:99], a[56:59], a[216:219], a[96:99]
    v_mfma_f32_16x16x32_bf16 a[100:103], a[56:59], a[220:223], a[100:103]
    ds_write_b128 v13, a[120:123] offset:59392
    v_mfma_f32_16x16x32_bf16 a[104:107], a[56:59], v[120:123], a[104:107]
    v_mfma_f32_16x16x32_bf16 a[108:111], a[56:59], v[124:127], a[108:111]
    ds_write_b128 v13, a[124:127] offset:60416
    v_mfma_f32_16x16x32_bf16 v[80:83], a[36:39], a[176:179], v[80:83]
    v_mfma_f32_16x16x32_bf16 v[84:87], a[36:39], a[180:183], v[84:87]
    s_nop 0
    ds_write_b128 v12, a[96:99] offset:53248
    v_mfma_f32_16x16x32_bf16 v[88:91], a[36:39], a[184:187], v[88:91]
    v_mfma_f32_16x16x32_bf16 v[92:95], a[36:39], a[188:191], v[92:95]
    ds_write_b128 v12, a[100:103] offset:54272
    v_mfma_f32_16x16x32_bf16 v[80:83], a[52:55], a[216:219], v[80:83]
    v_mfma_f32_16x16x32_bf16 v[84:87], a[52:55], a[220:223], v[84:87]
    ds_write_b128 v12, a[104:107] offset:55296
    v_mfma_f32_16x16x32_bf16 v[88:91], a[52:55], v[120:123], v[88:91]
    v_mfma_f32_16x16x32_bf16 v[92:95], a[52:55], v[124:127], v[92:95]
    ds_write_b128 v12, a[108:111] offset:56320
    v_mfma_f32_16x16x32_bf16 v[64:67], a[0:3], a[200:203], v[64:67]
    v_mfma_f32_16x16x32_bf16 v[68:71], a[0:3], a[204:207], v[68:71]
    s_nop 0
    ds_write_b128 v11, v[80:83] offset:49152
    v_mfma_f32_16x16x32_bf16 v[72:75], a[0:3], a[248:251], v[72:75]
    v_mfma_f32_16x16x32_bf16 v[76:79], a[0:3], a[252:255], v[76:79]
    ds_write_b128 v11, v[84:87] offset:50176
    v_mfma_f32_16x16x32_bf16 v[64:67], a[16:19], a[160:163], v[64:67]
    v_mfma_f32_16x16x32_bf16 v[68:71], a[16:19], a[164:167], v[68:71]
    ds_write_b128 v11, v[88:91] offset:51200
    v_mfma_f32_16x16x32_bf16 v[72:75], a[16:19], a[168:171], v[72:75]
L_w10:
    s_cbranch_execz L_wb_C
    v_mfma_f32_16x16x32_bf16 v[76:79], a[16:19], a[172:175], v[76:79]
    ds_write_b128 v11, v[92:95] offset:52224
    v_mfma_f32_16x16x32_bf16 v[64:67], a[32:35], a[176:179], v[64:67]
    v_mfma_f32_16x16x32_bf16 v[68:71], a[32:35], a[180:183], v[68:71]
    v_mfma_f32_16x16x32_bf16 v[72:75], a[32:35], a[184:187], v[72:75]
    v_mfma_f32_16x16x32_bf16 v[76:79], a[32:35], a[188:191], v[76:79]
    v_mfma_f32_16x16x32_bf16 v[64:67], a[48:51], a[216:219], v[64:67]
    v_mfma_f32_16x16x32_bf16 v[68:71], a[48:51], a[220:223], v[68:71]
    v_mfma_f32_16x16x32_bf16 v[72:75], a[48:51], v[120:123], v[72:75]
    v_mfma_f32_16x16x32_bf16 v[76:79], a[48:51], v[124:127], v[76:79]
    s_waitcnt lgkmcnt(0)
    s_barrier
    ds_read_b128 v[176:179], v14 offset:4096
    ds_read_b128 v[180:183], v14 offset:5120
    ds_read_b128 v[184:187], v14 offset:6144
    ds_read_b128 v[188:191], v14 offset:7168
    ds_read_b128 v[192:195], v14 offset:8192
    ds_read_b128 v[196:199], v14 offset:9216
    ds_read_b128 v[200:203], v14 offset:10240
    ds_read_b128 v[204:207], v14 offset:11264
    ds_read_b128 v[160:163], v14 offset:0
    ds_read_b128 v[164:167], v14 offset:1024
    ds_read_b128 v[168:171], v14 offset:2048
    ds_read_b128 v[172:175], v14 offset:3072
    s_waitcnt lgkmcnt(8)
    v_pk_add_f32 v[176:177], v[176:177], v[64:65]
    v_pk_add_f32 v[178:179], v[178:179], v[66:67]
    v_pk_add_f32 v[180:181], v[180:181], v[68:69]
    v_pk_add_f32 v[182:183], v[182:183], v[70:71]
    v_pk_add_f32 v[184:185], v[184:185], v[72:73]
    v_pk_add_f32 v[186:187], v[186:187], v[74:75]
    v_pk_add_f32 v[188:189], v[188:189], v[76:77]
    v_pk_add_f32 v[190:191], v[190:191], v[78:79]
    s_waitcnt lgkmcnt(4)
    v_pk_add_f32 v[176:177], v[176:177], v[192:193]
    v_pk_add_f32 v[178:179], v[178:179], v[194:195]
    v_pk_add_f32 v[180:181], v[180:181], v[196:197]
    v_pk_add_f32 v[182:183], v[182:183], v[198:199]
    v_pk_add_f32 v[184:185], v[184:185], v[200:201]
    v_pk_add_f32 v[186:187], v[186:187], v[202:203]
    v_pk_add_f32 v[188:189], v[188:189], v[204:205]
    v_pk_add_f32 v[190:191], v[190:191], v[206:207]
    s_waitcnt lgkmcnt(0)
    v_pk_add_f32 v[160:161], v[160:161], v[176:177]
    v_pk_add_f32 v[162:163], v[162:163], v[178:179]
    v_pk_add_f32 v[164:165], v[164:165], v[180:181]
    v_pk_add_f32 v[166:167], v[166:167], v[182:183]
    v_pk_add_f32 v[168:169], v[168:169], v[184:185]
    v_pk_add_f32 v[170:171], v[170:171], v[186:187]
    v_pk_add_f32 v[172:173], v[172:173], v[188:189]
    v_pk_add_f32 v[174:175], v[174:175], v[190:191]
    v_fmac_f32 v16, v116, v160
    v_fmac_f32 v17, v117, v164
    v_fmac_f32 v18, v118, v168
    v_fmac_f32 v19, v119, v172
    v_cvt_pk_bf16_f32 v64, v16, v17
    v_cvt_pk_bf16_f32 v65, v18, v19
    global_store_dwordx2 v15, v[64:65], s[58:59] offset:0
    v_fmac_f32 v20, v116, v161
    v_fmac_f32 v21, v117, v165
    v_fmac_f32 v22, v118, v169
    v_fmac_f32 v23, v119, v173
    v_cvt_pk_bf16_f32 v66, v20, v21
    v_cvt_pk_bf16_f32 v67, v22, v23
    global_store_dwordx2 v15, v[66:67], s[58:59] offset:1024
    v_fmac_f32 v24, v116, v162
    v_fmac_f32 v25, v117, v166
    v_fmac_f32 v26, v118, v170
    v_fmac_f32 v27, v119, v174
    v_cvt_pk_bf16_f32 v68, v24, v25
    v_cvt_pk_bf16_f32 v69, v26, v27
    global_store_dwordx2 v15, v[68:69], s[58:59] offset:2048
    v_fmac_f32 v28, v116, v163
    v_fmac_f32 v29, v117, v167
    v_fmac_f32 v30, v118, v171
    v_fmac_f32 v31, v119, v175
    v_cvt_pk_bf16_f32 v70, v28, v29
    v_cvt_pk_bf16_f32 v71, v30, v31
    global_store_dwordx2 v15, v[70:71], s[58:59] offset:3072
    s_endpgm
L_dx1:
    global_store_dwordx4 v128, v[108:111], s[58:59] offset:2048 sc1
    s_branch L_dx1_b
L_dx0:
    global_store_dwordx4 v128, v[104:107], s[58:59] offset:-2048 sc1
    s_branch L_dx0_b
L_d1:
    global_store_dwordx4 v131, v[68:71], s[62:63] offset:256 sc1
    s_branch L_d1_b
L_d0:
    global_store_dwordx4 v131, v[64:67], s[62:63] offset:0 sc1
    s_branch L_d0_b
L_s1_r:
    s_sleep 2
    global_load_dwordx4 v[152:155], v7, s[28:29] offset:-4096 sc1
    global_load_dwordx4 v[156:159], v7, s[28:29] offset:-3072 sc1
    global_load_dwordx4 v[160:163], v7, s[28:29] offset:-2048 sc1
    global_load_dwordx4 v[164:167], v7, s[28:29] offset:-1024 sc1
    global_load_dwordx4 v[168:171], v7, s[28:29] offset:0 sc1
    global_load_dwordx4 v[172:175], v7, s[28:29] offset:1024 sc1
    global_load_dwordx4 v[176:179], v7, s[28:29] offset:2048 sc1
    global_load_dwordx4 v[180:183], v7, s[28:29] offset:3072 sc1
    s_waitcnt vmcnt(0)
    v_add_f32 v152, v152, v160
    v_add3_u32 v153, v153, v161, v169
    v_add_f32 v154, v154, v162
    v_add3_u32 v155, v155, v163, v171
    v_add_f32 v156, v156, v164
    v_add3_u32 v157, v157, v165, v173
    v_add_f32 v158, v158, v166
    v_add3_u32 v159, v159, v167, v175
    v_add_f32 v168, v168, v176
    v_add_f32 v170, v170, v178
    v_add_f32 v172, v172, v180
    v_add_f32 v174, v174, v182
    v_add3_u32 v153, v153, v155, v177
    v_add3_u32 v157, v157, v159, v179
    v_add_f32 v152, v152, v168
    v_add_f32 v154, v154, v170
    v_add_f32 v156, v156, v172
    v_add_f32 v158, v158, v174
    v_add3_u32 v153, v153, v181, v183
    v_cvt_pk_bf16_f32 v161, v156, v158
    v_add_u32 v153, v153, v157
    v_cvt_pk_bf16_f32 v160, v152, v154
    v_cmp_ne_u32 vcc, s75, v153
    s_cbranch_vccz L_s1_ok
    s_sub_u32 s74, s74, 1
    s_cbranch_scc0 L_s1_r
    s_mov_b32 s74, 0
    s_branch L_s1_ok
L_kv0_r:
    s_sleep 2
    s_mov_b32 s13, s40
    s_xor_b32 s40, s60, 0
    global_load_dwordx4 a[0:3], v7, s[40:41] offset:-4096 sc1
    global_load_dwordx4 a[4:7], v9, s[40:41] offset:-3072 sc1
    global_load_dwordx4 a[8:11], v9, s[40:41] offset:-2048 sc1
    global_load_dwordx4 a[12:15], v7, s[40:41] offset:0 sc1
    global_load_dwordx4 a[16:19], v9, s[40:41] offset:1024 sc1
    global_load_dwordx4 a[20:23], v9, s[40:41] offset:2048 sc1
    s_mov_b32 s40, s13
    s_waitcnt vmcnt(0)
    v_accvgpr_read_b32 v113, a0
    v_accvgpr_read_b32 v114, a4
    v_accvgpr_read_b32 v115, a8
    v_max3_u32 v113, v113, v114, v115
    v_accvgpr_read_b32 v114, a12
    v_accvgpr_read_b32 v115, a16
    v_accvgpr_read_b32 v116, a20
    v_max3_u32 v113, v113, v114, v115
    v_max_u32 v113, v113, v116
    v_cmp_eq_u32 vcc, -1, v113
    s_cbranch_vccz L_kv0_ok
    s_sub_u32 s74, s74, 1
    s_cbranch_scc0 L_kv0_r
    s_mov_b32 s74, 0
    s_branch L_kv0_ok
L_kv1_r:
    s_sleep 2
    s_mov_b32 s13, s40
    s_xor_b32 s40, s60, 8192
    global_load_dwordx4 a[24:27], v7, s[40:41] offset:-4096 sc1
    global_load_dwordx4 a[28:31], v9, s[40:41] offset:-3072 sc1
    global_load_dwordx4 a[32:35], v9, s[40:41] offset:-2048 sc1
    global_load_dwordx4 a[36:39], v7, s[40:41] offset:0 sc1
    global_load_dwordx4 a[40:43], v9, s[40:41] offset:1024 sc1
    global_load_dwordx4 a[44:47], v9, s[40:41] offset:2048 sc1
    s_mov_b32 s40, s13
    s_waitcnt vmcnt(0)
    v_accvgpr_read_b32 v113, a24
    v_accvgpr_read_b32 v114, a28
    v_accvgpr_read_b32 v115, a32
    v_max3_u32 v113, v113, v114, v115
    v_accvgpr_read_b32 v114, a36
    v_accvgpr_read_b32 v115, a40
    v_accvgpr_read_b32 v116, a44
    v_max3_u32 v113, v113, v114, v115
    v_max_u32 v113, v113, v116
    v_cmp_eq_u32 vcc, -1, v113
    s_cbranch_vccz L_kv1_ok
    s_sub_u32 s74, s74, 1
    s_cbranch_scc0 L_kv1_r
    s_mov_b32 s74, 0
    s_branch L_kv1_ok
L_kp_r:
    s_sleep 2
    s_mov_b32 exec_lo, 0xff000000
    global_load_dword v112, v253, s[62:63] sc1
    s_mov_b32 exec_lo, -1
    s_waitcnt vmcnt(0)
    v_cmp_eq_u32 vcc, -1, v112
    s_cbranch_vccz L_kp_ok
    s_sub_u32 s74, s74, 1
    s_cbranch_scc0 L_kp_r
    s_mov_b32 s74, 0
    s_branch L_kp_ok
L_kv2_r:
    s_sleep 2
    s_mov_b32 s13, s40
    s_xor_b32 s40, s60, 16384
    global_load_dwordx4 a[48:51], v7, s[40:41] offset:-4096 sc1
    global_load_dwordx4 a[52:55], v9, s[40:41] offset:-3072 sc1
    global_load_dwordx4 a[56:59], v9, s[40:41] offset:-2048 sc1
    global_load_dwordx4 a[60:63], v7, s[40:41] offset:0 sc1
    global_load_dwordx4 a[64:67], v9, s[40:41] offset:1024 sc1
    global_load_dwordx4 a[68:71], v9, s[40:41] offset:2048 sc1
    s_mov_b32 s40, s13
    s_waitcnt vmcnt(0)
    v_accvgpr_read_b32 v113, a48
    v_accvgpr_read_b32 v114, a52
    v_accvgpr_read_b32 v115, a56
    v_max3_u32 v113, v113, v114, v115
    v_accvgpr_read_b32 v114, a60
    v_accvgpr_read_b32 v115, a64
    v_accvgpr_read_b32 v116, a68
    v_max3_u32 v113, v113, v114, v115
    v_max_u32 v113, v113, v116
    v_cmp_eq_u32 vcc, -1, v113
    s_cbranch_vccz L_kv2_ok
    s_sub_u32 s74, s74, 1
    s_cbranch_scc0 L_kv2_r
    s_mov_b32 s74, 0
    s_branch L_kv2_ok
L_f0_r:
    s_sleep 8
    s_mov_b64 exec, s[26:27]
    buffer_load_dwordx4 v[116:119], v7, s[20:23], s18 offen offset:0 sc1
    s_mov_b64 exec, -1
    s_waitcnt vmcnt(0)
    v_add3_u32 v116, v116, v117, v118
    v_add_u32 v116, v116, v119
    v_cmp_ne_u32 vcc, s4, v116
    s_nop 0
    s_and_b64 vcc, vcc, s[26:27]
    s_cbranch_vccz L_f0_ok
    s_sub_u32 s74, s74, 1
    s_cbranch_scc0 L_f0_r
    s_mov_b32 s74, 0
    s_branch L_f0_ok
L_f1_r:
    s_sleep 8
    s_mov_b64 exec, s[54:55]
    buffer_load_dwordx4 v[116:119], v7, s[20:23], s18 offen offset:1024 sc1
    s_mov_b64 exec, -1
    s_waitcnt vmcnt(0)
    v_add3_u32 v116, v116, v117, v118
    v_add_u32 v116, v116, v119
    v_cmp_ne_u32 vcc, s4, v116
    s_nop 0
    s_and_b64 vcc, vcc, s[54:55]
    s_cbranch_vccz L_f1_ok
    s_sub_u32 s74, s74, 1
    s_cbranch_scc0 L_f1_r
    s_mov_b32 s74, 0
    s_branch L_f1_ok
L_f2_r:
    s_sleep 8
    s_mov_b64 exec, s[54:55]
    buffer_load_dwordx4 v[116:119], v7, s[20:23], s18 offen offset:2048 sc1
    s_mov_b64 exec, -1
    s_waitcnt vmcnt(0)
    v_add3_u32 v116, v116, v117, v118
    v_add_u32 v116, v116, v119
    v_cmp_ne_u32 vcc, s4, v116
    s_nop 0
    s_and_b64 vcc, vcc, s[54:55]
    s_cbranch_vccz L_f2_ok
    s_sub_u32 s74, s74, 1
    s_cbranch_scc0 L_f2_r
    s_mov_b32 s74, 0
    s_branch L_f2_ok
L_h1_r:
    s_xor_b32 s48, s96, 4096
    global_load_dwordx4 a[16:19], v1, s[48:49] offset:0 sc1
    global_load_dwordx4 a[20:23], v1, s[48:49] offset:1024 sc1
    global_load_dwordx4 a[24:27], v1, s[48:49] offset:2048 sc1
    global_load_dwordx4 a[28:31], v1, s[48:49] offset:3072 sc1
    s_xor_b32 s48, s96, 8192
    global_load_dwordx4 a[32:35], v1, s[48:49] offset:0 sc1
    global_load_dwordx4 a[36:39], v1, s[48:49] offset:1024 sc1
    global_load_dwordx4 a[40:43], v1, s[48:49] offset:2048 sc1
    global_load_dwordx4 a[44:47], v1, s[48:49] offset:3072 sc1
    s_xor_b32 s48, s96, 12288
    global_load_dwordx4 a[48:51], v1, s[48:49] offset:0 sc1
    global_load_dwordx4 a[52:55], v1, s[48:49] offset:1024 sc1
    global_load_dwordx4 a[56:59], v1, s[48:49] offset:2048 sc1
    s_waitcnt vmcnt(0)
    v_accvgpr_read_b32 v112, a16
    v_accvgpr_read_b32 v113, a20
    v_accvgpr_read_b32 v114, a24
    v_accvgpr_read_b32 v115, a28
    v_max3_u32 v112, v112, v113, v114
    v_max_u32 v112, v112, v115
    v_cmp_eq_u32 vcc, -1, v112
    s_cbranch_vccz L_h1_ok
    s_sub_u32 s74, s74, 1
    s_cbranch_scc0 L_h1_r
    s_mov_b32 s74, 0
    s_branch L_h1_ok
L_h2_r:
    s_xor_b32 s48, s96, 8192
    global_load_dwordx4 a[32:35], v1, s[48:49] offset:0 sc1
    global_load_dwordx4 a[36:39], v1, s[48:49] offset:1024 sc1
    global_load_dwordx4 a[40:43], v1, s[48:49] offset:2048 sc1
    global_load_dwordx4 a[44:47], v1, s[48:49] offset:3072 sc1
    s_xor_b32 s48, s96, 12288
    global_load_dwordx4 a[48:51], v1, s[48:49] offset:0 sc1
    global_load_dwordx4 a[52:55], v1, s[48:49] offset:1024 sc1
    global_load_dwordx4 a[56:59], v1, s[48:49] offset:2048 sc1
    global_load_dwordx4 a[60:63], v1, s[48:49] offset:3072 sc1
    s_xor_b32 s48, s96, 16384
    global_load_dwordx4 a[64:67], v1, s[48:49] offset:0 sc1
    global_load_dwordx4 a[68:71], v1, s[48:49] offset:1024 sc1
    global_load_dwordx4 a[72:75], v1, s[48:49] offset:2048 sc1
    global_load_dwordx4 a[76:79], v1, s[48:49] offset:3072 sc1
    s_waitcnt vmcnt(0)
    v_accvgpr_read_b32 v112, a32
    v_accvgpr_read_b32 v113, a36
    v_accvgpr_read_b32 v114, a40
    v_accvgpr_read_b32 v115, a44
    v_max3_u32 v112, v112, v113, v114
    v_max_u32 v112, v112, v115
    v_cmp_eq_u32 vcc, -1, v112
    s_cbranch_vccz L_h2_ok
    s_sub_u32 s74, s74, 1
    s_cbranch_scc0 L_h2_r
    s_mov_b32 s74, 0
    s_branch L_h2_ok
L_h3_r:
    s_xor_b32 s48, s96, 12288
    global_load_dwordx4 a[48:51], v1, s[48:49] offset:0 sc1
    global_load_dwordx4 a[52:55], v1, s[48:49] offset:1024 sc1
    global_load_dwordx4 a[56:59], v1, s[48:49] offset:2048 sc1
    global_load_dwordx4 a[60:63], v1, s[48:49] offset:3072 sc1
    s_xor_b32 s48, s96, 16384
    global_load_dwordx4 a[64:67], v1, s[48:49] offset:0 sc1
    global_load_dwordx4 a[68:71], v1, s[48:49] offset:1024 sc1
    global_load_dwordx4 a[72:75], v1, s[48:49] offset:2048 sc1
    global_load_dwordx4 a[76:79], v1, s[48:49] offset:3072 sc1
    s_xor_b32 s48, s96, 20480
    global_load_dwordx4 a[80:83], v1, s[48:49] offset:0 sc1
    global_load_dwordx4 a[84:87], v1, s[48:49] offset:1024 sc1
    global_load_dwordx4 a[88:91], v1, s[48:49] offset:2048 sc1
    global_load_dwordx4 a[92:95], v1, s[48:49] offset:3072 sc1
    s_waitcnt vmcnt(0)
    v_accvgpr_read_b32 v112, a48
    v_accvgpr_read_b32 v113, a52
    v_accvgpr_read_b32 v114, a56
    v_accvgpr_read_b32 v115, a60
    v_max3_u32 v112, v112, v113, v114
    v_max_u32 v112, v112, v115
    v_cmp_eq_u32 vcc, -1, v112
    s_cbranch_vccz L_h3_ok
    s_sub_u32 s74, s74, 1
    s_cbranch_scc0 L_h3_r
    s_mov_b32 s74, 0
    s_branch L_h3_ok
L_h4_r:
    s_xor_b32 s48, s96, 16384
    global_load_dwordx4 a[64:67], v1, s[48:49] offset:0 sc1
    global_load_dwordx4 a[68:71], v1, s[48:49] offset:1024 sc1
    global_load_dwordx4 a[72:75], v1, s[48:49] offset:2048 sc1
    global_load_dwordx4 a[76:79], v1, s[48:49] offset:3072 sc1
    s_xor_b32 s48, s96, 20480
    global_load_dwordx4 a[80:83], v1, s[48:49] offset:0 sc1
    global_load_dwordx4 a[84:87], v1, s[48:49] offset:1024 sc1
    global_load_dwordx4 a[88:91], v1, s[48:49] offset:2048 sc1
    global_load_dwordx4 a[92:95], v1, s[48:49] offset:3072 sc1
    s_xor_b32 s48, s96, 24576
    global_load_dwordx4 a[96:99], v1, s[48:49] offset:0 sc1
    global_load_dwordx4 a[100:103], v1, s[48:49] offset:1024 sc1
    global_load_dwordx4 a[104:107], v1, s[48:49] offset:2048 sc1
    global_load_dwordx4 a[108:111], v1, s[48:49] offset:3072 sc1
    s_xor_b32 s48, s96, 28672
    global_load_dwordx4 a[112:115], v1, s[48:49] offset:0 sc1
    s_waitcnt vmcnt(0)
    v_accvgpr_read_b32 v112, a64
    v_accvgpr_read_b32 v113, a68
    v_accvgpr_read_b32 v114, a72
    v_accvgpr_read_b32 v115, a76
    v_max3_u32 v112, v112, v113, v114
    v_max_u32 v112, v112, v115
    v_cmp_eq_u32 vcc, -1, v112
    s_cbranch_vccz L_h4_ok
    s_sub_u32 s74, s74, 1
    s_cbranch_scc0 L_h4_r
    s_mov_b32 s74, 0
    s_branch L_h4_ok
L_h5_r:
    s_xor_b32 s48, s96, 20480
    global_load_dwordx4 a[80:83], v1, s[48:49] offset:0 sc1
    global_load_dwordx4 a[84:87], v1, s[48:49] offset:1024 sc1
    global_load_dwordx4 a[88:91], v1, s[48:49] offset:2048 sc1
    global_load_dwordx4 a[92:95], v1, s[48:49] offset:3072 sc1
    s_xor_b32 s48, s96, 24576
    global_load_dwordx4 a[96:99], v1, s[48:49] offset:0 sc1
    global_load_dwordx4 a[100:103], v1, s[48:49] offset:1024 sc1
    global_load_dwordx4 a[104:107], v1, s[48:49] offset:2048 sc1
    global_load_dwordx4 a[108:111], v1, s[48:49] offset:3072 sc1
    s_xor_b32 s48, s96, 28672
    global_load_dwordx4 a[112:115], v1, s[48:49] offset:0 sc1
    global_load_dwordx4 a[116:119], v1, s[48:49] offset:1024 sc1
    global_load_dwordx4 a[120:123], v1, s[48:49] offset:2048 sc1
    global_load_dwordx4 a[124:127], v1, s[48:49] offset:3072 sc1
    s_waitcnt vmcnt(0)
    v_accvgpr_read_b32 v112, a80
    v_accvgpr_read_b32 v113, a84
    v_accvgpr_read_b32 v114, a88
    v_accvgpr_read_b32 v115, a92
    v_max3_u32 v112, v112, v113, v114
    v_max_u32 v112, v112, v115
    v_cmp_eq_u32 vcc, -1, v112
    s_cbranch_vccz L_h5_ok
    s_sub_u32 s74, s74, 1
    s_cbranch_scc0 L_h5_r
    s_mov_b32 s74, 0
    s_branch L_h5_ok
L_h6_r:
    s_xor_b32 s48, s96, 24576
    global_load_dwordx4 a[96:99], v1, s[48:49] offset:0 sc1
    global_load_dwordx4 a[100:103], v1, s[48:49] offset:1024 sc1
    global_load_dwordx4 a[104:107], v1, s[48:49] offset:2048 sc1
    global_load_dwordx4 a[108:111], v1, s[48:49] offset:3072 sc1
    s_xor_b32 s48, s96, 28672
    global_load_dwordx4 a[112:115], v1, s[48:49] offset:0 sc1
    global_load_dwordx4 a[116:119], v1, s[48:49] offset:1024 sc1
    global_load_dwordx4 a[120:123], v1, s[48:49] offset:2048 sc1
    global_load_dwordx4 a[124:127], v1, s[48:49] offset:3072 sc1
    s_waitcnt vmcnt(0)
    v_accvgpr_read_b32 v112, a96
    v_accvgpr_read_b32 v113, a100
    v_accvgpr_read_b32 v114, a104
    v_accvgpr_read_b32 v115, a108
    v_max3_u32 v112, v112, v113, v114
    v_max_u32 v112, v112, v115
    v_cmp_eq_u32 vcc, -1, v112
    s_cbranch_vccz L_h6_ok
    s_sub_u32 s74, s74, 1
    s_cbranch_scc0 L_h6_r
    s_mov_b32 s74, 0
    s_branch L_h6_ok
L_h7_r:
    s_xor_b32 s48, s96, 28672
    global_load_dwordx4 a[112:115], v1, s[48:49] offset:0 sc1
    global_load_dwordx4 a[116:119], v1, s[48:49] offset:1024 sc1
    global_load_dwordx4 a[120:123], v1, s[48:49] offset:2048 sc1
    global_load_dwordx4 a[124:127], v1, s[48:49] offset:3072 sc1
    s_waitcnt vmcnt(0)
    v_accvgpr_read_b32 v112, a112
    v_accvgpr_read_b32 v113, a116
    v_accvgpr_read_b32 v114, a120
    v_accvgpr_read_b32 v115, a124
    v_max3_u32 v112, v112, v113, v114
    v_max_u32 v112, v112, v115
    v_cmp_eq_u32 vcc, -1, v112
    s_cbranch_vccz L_h7_ok
    s_sub_u32 s74, s74, 1
    s_cbranch_scc0 L_h7_r
    s_mov_b32 s74, 0
    s_branch L_h7_ok
L_hh0_r:
    s_add_u32 s50, s24, 0
    global_load_dwordx4 v[16:19], v3, s[50:51] sc1
    global_load_dwordx4 v[20:23], v4, s[50:51] sc1
    global_load_dwordx4 v[24:27], v8, s[50:51] sc1
    global_load_dwordx4 v[28:31], v10, s[50:51] sc1
    s_add_u32 s50, s25, 0
    global_load_dwordx4 v[32:35], v3, s[50:51] sc1
    global_load_dwordx4 v[36:39], v4, s[50:51] sc1
    global_load_dwordx4 v[40:43], v8, s[50:51] sc1
    global_load_dwordx4 v[44:47], v10, s[50:51] sc1
    s_add_u32 s50, s24, 12288
    s_waitcnt vmcnt(0)
    v_max3_u32 v112, v16, v20, v24
    v_max_u32 v112, v112, v28
    v_cmp_eq_u32 vcc, -1, v112
    s_cbranch_vccz L_hh0_ok
    s_sub_u32 s74, s74, 1
    s_cbranch_scc0 L_hh0_r
    s_mov_b32 s74, 0
    s_branch L_hh0_ok
L_hh1_r:
    s_add_u32 s50, s25, 0
    global_load_dwordx4 v[32:35], v3, s[50:51] sc1
    global_load_dwordx4 v[36:39], v4, s[50:51] sc1
    global_load_dwordx4 v[40:43], v8, s[50:51] sc1
    global_load_dwordx4 v[44:47], v10, s[50:51] sc1
    s_add_u32 s50, s24, 4096
    global_load_dwordx4 a[0:3], v3, s[50:51] sc1
    global_load_dwordx4 a[4:7], v4, s[50:51] sc1
    global_load_dwordx4 a[8:11], v8, s[50:51] sc1
    global_load_dwordx4 a[12:15], v10, s[50:51] sc1
    s_add_u32 s50, s25, 12288
    s_waitcnt vmcnt(0)
    v_max3_u32 v112, v32, v36, v40
    v_max_u32 v112, v112, v44
    v_cmp_eq_u32 vcc, -1, v112
    s_cbranch_vccz L_hh1_ok
    s_sub_u32 s74, s74, 1
    s_cbranch_scc0 L_hh1_r
    s_mov_b32 s74, 0
    s_branch L_hh1_ok
L_hh2_r:
    s_add_u32 s50, s24, 4096
    global_load_dwordx4 a[0:3], v3, s[50:51] sc1
    global_load_dwordx4 a[4:7], v4, s[50:51] sc1
    global_load_dwordx4 a[8:11], v8, s[50:51] sc1
    global_load_dwordx4 a[12:15], v10, s[50:51] sc1
    s_add_u32 s50, s25, 4096
    global_load_dwordx4 a[16:19], v3, s[50:51] sc1
    global_load_dwordx4 a[20:23], v4, s[50:51] sc1
    global_load_dwordx4 a[24:27], v8, s[50:51] sc1
    global_load_dwordx4 a[28:31], v10, s[50:51] sc1
    s_add_u32 s50, s25, 12288
    s_waitcnt vmcnt(0)
    v_accvgpr_read_b32 v112, a0
    v_accvgpr_read_b32 v113, a4
    v_accvgpr_read_b32 v114, a8
    v_accvgpr_read_b32 v115, a12
    v_max3_u32 v112, v112, v113, v114
    v_max_u32 v112, v112, v115
    v_cmp_eq_u32 vcc, -1, v112
    s_cbranch_vccz L_hh2_ok
    s_sub_u32 s74, s74, 1
    s_cbranch_scc0 L_hh2_r
    s_mov_b32 s74, 0
    s_branch L_hh2_ok
L_hh3_r:
    s_add_u32 s50, s25, 4096
    global_load_dwordx4 a[16:19], v3, s[50:51] sc1
    global_load_dwordx4 a[20:23], v4, s[50:51] sc1
    global_load_dwordx4 a[24:27], v8, s[50:51] sc1
    global_load_dwordx4 a[28:31], v10, s[50:51] sc1
    s_add_u32 s50, s24, 8192
    global_load_dwordx4 a[32:35], v3, s[50:51] sc1
    global_load_dwordx4 a[36:39], v4, s[50:51] sc1
    global_load_dwordx4 a[40:43], v8, s[50:51] sc1
    global_load_dwordx4 a[44:47], v10, s[50:51] sc1
    s_add_u32 s50, s24, 16384
    s_waitcnt vmcnt(0)
    v_accvgpr_read_b32 v112, a16
    v_accvgpr_read_b32 v113, a20
    v_accvgpr_read_b32 v114, a24
    v_accvgpr_read_b32 v115, a28
    v_max3_u32 v112, v112, v113, v114
    v_max_u32 v112, v112, v115
    v_cmp_eq_u32 vcc, -1, v112
    s_cbranch_vccz L_hh3_ok
    s_sub_u32 s74, s74, 1
    s_cbranch_scc0 L_hh3_r
    s_mov_b32 s74, 0
    s_branch L_hh3_ok
L_hh4_r:
    s_add_u32 s50, s24, 8192
    global_load_dwordx4 a[32:35], v3, s[50:51] sc1
    global_load_dwordx4 a[36:39], v4, s[50:51] sc1
    global_load_dwordx4 a[40:43], v8, s[50:51] sc1
    global_load_dwordx4 a[44:47], v10, s[50:51] sc1
    s_add_u32 s50, s25, 8192
    global_load_dwordx4 a[48:51], v3, s[50:51] sc1
    global_load_dwordx4 a[52:55], v4, s[50:51] sc1
    global_load_dwordx4 a[56:59], v8, s[50:51] sc1
    global_load_dwordx4 a[60:63], v10, s[50:51] sc1
    s_add_u32 s50, s25, 16384
    s_waitcnt vmcnt(0)
    v_accvgpr_read_b32 v112, a32
    v_accvgpr_read_b32 v113, a36
    v_accvgpr_read_b32 v114, a40
    v_accvgpr_read_b32 v115, a44
    v_max3_u32 v112, v112, v113, v114
    v_max_u32 v112, v112, v115
    v_cmp_eq_u32 vcc, -1, v112
    s_cbranch_vccz L_hh4_ok
    s_sub_u32 s74, s74, 1
    s_cbranch_scc0 L_hh4_r
    s_mov_b32 s74, 0
    s_branch L_hh4_ok
L_hh5_r:
    s_add_u32 s50, s25, 8192
    global_load_dwordx4 a[48:51], v3, s[50:51] sc1
    global_load_dwordx4 a[52:55], v4, s[50:51] sc1
    global_load_dwordx4 a[56:59], v8, s[50:51] sc1
    global_load_dwordx4 a[60:63], v10, s[50:51] sc1
    s_add_u32 s50, s24, 12288
    global_load_dwordx4 a[64:67], v3, s[50:51] sc1
    global_load_dwordx4 a[68:71], v4, s[50:51] sc1
    global_load_dwordx4 a[72:75], v8, s[50:51] sc1
    global_load_dwordx4 a[76:79], v10, s[50:51] sc1
    s_add_u32 s50, s25, 16384
    s_waitcnt vmcnt(0)
    v_accvgpr_read_b32 v112, a48
    v_accvgpr_read_b32 v113, a52
    v_accvgpr_read_b32 v114, a56
    v_accvgpr_read_b32 v115, a60
    v_max3_u32 v112, v112, v113, v114
    v_max_u32 v112, v112, v115
    v_cmp_eq_u32 vcc, -1, v112
    s_cbranch_vccz L_hh5_ok
    s_sub_u32 s74, s74, 1
    s_cbranch_scc0 L_hh5_r
    s_mov_b32 s74, 0
    s_branch L_hh5_ok
L_hh6_r:
    s_add_u32 s50, s24, 12288
    global_load_dwordx4 a[64:67], v3, s[50:51] sc1
    global_load_dwordx4 a[68:71], v4, s[50:51] sc1
    global_load_dwordx4 a[72:75], v8, s[50:51] sc1
    global_load_dwordx4 a[76:79], v10, s[50:51] sc1
    s_add_u32 s50, s25, 12288
    global_load_dwordx4 a[80:83], v3, s[50:51] sc1
    global_load_dwordx4 a[84:87], v4, s[50:51] sc1
    global_load_dwordx4 a[88:91], v8, s[50:51] sc1
    global_load_dwordx4 a[92:95], v10, s[50:51] sc1
    s_add_u32 s50, s24, 20480
    s_waitcnt vmcnt(0)
    v_accvgpr_read_b32 v112, a64
    v_accvgpr_read_b32 v113, a68
    v_accvgpr_read_b32 v114, a72
    v_accvgpr_read_b32 v115, a76
    v_max3_u32 v112, v112, v113, v114
    v_max_u32 v112, v112, v115
    v_cmp_eq_u32 vcc, -1, v112
    s_cbranch_vccz L_hh6_ok
    s_sub_u32 s74, s74, 1
    s_cbranch_scc0 L_hh6_r
    s_mov_b32 s74, 0
    s_branch L_hh6_ok
L_hh7_r:
    s_add_u32 s50, s25, 12288
    global_load_dwordx4 a[80:83], v3, s[50:51] sc1
    global_load_dwordx4 a[84:87], v4, s[50:51] sc1
    global_load_dwordx4 a[88:91], v8, s[50:51] sc1
    global_load_dwordx4 a[92:95], v10, s[50:51] sc1
    s_add_u32 s50, s24, 16384
    global_load_dwordx4 a[128:131], v3, s[50:51] sc1
    global_load_dwordx4 a[132:135], v4, s[50:51] sc1
    global_load_dwordx4 a[136:139], v8, s[50:51] sc1
    global_load_dwordx4 a[140:143], v10, s[50:51] sc1
    s_add_u32 s50, s25, 20480
    s_waitcnt vmcnt(0)
    v_accvgpr_read_b32 v112, a80
    v_accvgpr_read_b32 v113, a84
    v_accvgpr_read_b32 v114, a88
    v_accvgpr_read_b32 v115, a92
    v_max3_u32 v112, v112, v113, v114
    v_max_u32 v112, v112, v115
    v_cmp_eq_u32 vcc, -1, v112
    s_cbranch_vccz L_hh7_ok
    s_sub_u32 s74, s74, 1
    s_cbranch_scc0 L_hh7_r
    s_mov_b32 s74, 0
    s_branch L_hh7_ok
L_hh8_r:
    s_add_u32 s50, s24, 16384
    global_load_dwordx4 a[128:131], v3, s[50:51] sc1
    global_load_dwordx4 a[132:135], v4, s[50:51] sc1
    global_load_dwordx4 a[136:139], v8, s[50:51] sc1
    global_load_dwordx4 a[140:143], v10, s[50:51] sc1
    s_add_u32 s50, s25, 16384
    global_load_dwordx4 a[144:147], v3, s[50:51] sc1
    global_load_dwordx4 a[148:151], v4, s[50:51] sc1
    global_load_dwordx4 a[152:155], v8, s[50:51] sc1
    global_load_dwordx4 a[156:159], v10, s[50:51] sc1
    s_add_u32 s50, s24, 24576
    s_waitcnt vmcnt(0)
    v_accvgpr_read_b32 v112, a128
    v_accvgpr_read_b32 v113, a132
    v_accvgpr_read_b32 v114, a136
    v_accvgpr_read_b32 v115, a140
    v_max3_u32 v112, v112, v113, v114
    v_max_u32 v112, v112, v115
    v_cmp_eq_u32 vcc, -1, v112
    s_cbranch_vccz L_hh8_ok
    s_sub_u32 s74, s74, 1
    s_cbranch_scc0 L_hh8_r
    s_mov_b32 s74, 0
    s_branch L_hh8_ok
L_hh9_r:
    s_add_u32 s50, s25, 16384
    global_load_dwordx4 a[144:147], v3, s[50:51] sc1
    global_load_dwordx4 a[148:151], v4, s[50:51] sc1
    global_load_dwordx4 a[152:155], v8, s[50:51] sc1
    global_load_dwordx4 a[156:159], v10, s[50:51] sc1
    s_add_u32 s50, s24, 20480
    global_load_dwordx4 a[0:3], v3, s[50:51] sc1
    global_load_dwordx4 a[4:7], v4, s[50:51] sc1
    global_load_dwordx4 a[8:11], v8, s[50:51] sc1
    global_load_dwordx4 a[12:15], v10, s[50:51] sc1
    s_add_u32 s50, s25, 24576
    s_waitcnt vmcnt(0)
    v_accvgpr_read_b32 v112, a144
    v_accvgpr_read_b32 v113, a148
    v_accvgpr_read_b32 v114, a152
    v_accvgpr_read_b32 v115, a156
    v_max3_u32 v112, v112, v113, v114
    v_max_u32 v112, v112, v115
    v_cmp_eq_u32 vcc, -1, v112
    s_cbranch_vccz L_hh9_ok
    s_sub_u32 s74, s74, 1
    s_cbranch_scc0 L_hh9_r
    s_mov_b32 s74, 0
    s_branch L_hh9_ok
L_hh10_r:
    s_add_u32 s50, s24, 20480
    global_load_dwordx4 a[0:3], v3, s[50:51] sc1
    global_load_dwordx4 a[4:7], v4, s[50:51] sc1
    global_load_dwordx4 a[8:11], v8, s[50:51] sc1
    global_load_dwordx4 a[12:15], v10, s[50:51] sc1
    s_add_u32 s50, s25, 20480
    global_load_dwordx4 a[16:19], v3, s[50:51] sc1
    global_load_dwordx4 a[20:23], v4, s[50:51] sc1
    global_load_dwordx4 a[24:27], v8, s[50:51] sc1
    global_load_dwordx4 a[28:31], v10, s[50:51] sc1
    s_add_u32 s50, s25, 24576
    s_waitcnt vmcnt(0)
    v_accvgpr_read_b32 v112, a0
    v_accvgpr_read_b32 v113, a4
    v_accvgpr_read_b32 v114, a8
    v_accvgpr_read_b32 v115, a12
    v_max3_u32 v112, v112, v113, v114
    v_max_u32 v112, v112, v115
    v_cmp_eq_u32 vcc, -1, v112
    s_cbranch_vccz L_hh10_ok
    s_sub_u32 s74, s74, 1
    s_cbranch_scc0 L_hh10_r
    s_mov_b32 s74, 0
    s_branch L_hh10_ok
L_hh11_r:
    s_add_u32 s50, s25, 20480
    global_load_dwordx4 a[16:19], v3, s[50:51] sc1
    global_load_dwordx4 a[20:23], v4, s[50:51] sc1
    global_load_dwordx4 a[24:27], v8, s[50:51] sc1
    global_load_dwordx4 a[28:31], v10, s[50:51] sc1
    s_add_u32 s50, s24, 24576
    global_load_dwordx4 a[32:35], v3, s[50:51] sc1
    global_load_dwordx4 a[36:39], v4, s[50:51] sc1
    global_load_dwordx4 a[40:43], v8, s[50:51] sc1
    global_load_dwordx4 a[44:47], v10, s[50:51] sc1
    s_add_u32 s50, s25, 24576
    s_waitcnt vmcnt(0)
    v_accvgpr_read_b32 v112, a16
    v_accvgpr_read_b32 v113, a20
    v_accvgpr_read_b32 v114, a24
    v_accvgpr_read_b32 v115, a28
    v_max3_u32 v112, v112, v113, v114
    v_max_u32 v112, v112, v115
    v_cmp_eq_u32 vcc, -1, v112
    s_cbranch_vccz L_hh11_ok
    s_sub_u32 s74, s74, 1
    s_cbranch_scc0 L_hh11_r
    s_mov_b32 s74, 0
    s_branch L_hh11_ok
L_hh12_r:
    s_add_u32 s50, s24, 24576
    global_load_dwordx4 a[32:35], v3, s[50:51] sc1
    global_load_dwordx4 a[36:39], v4, s[50:51] sc1
    global_load_dwordx4 a[40:43], v8, s[50:51] sc1
    global_load_dwordx4 a[44:47], v10, s[50:51] sc1
    s_add_u32 s50, s25, 24576
    global_load_dwordx4 a[48:51], v3, s[50:51] sc1
    global_load_dwordx4 a[52:55], v4, s[50:51] sc1
    global_load_dwordx4 a[56:59], v8, s[50:51] sc1
    global_load_dwordx4 a[60:63], v10, s[50:51] sc1
    s_waitcnt vmcnt(0)
    v_accvgpr_read_b32 v112, a32
    v_accvgpr_read_b32 v113, a36
    v_accvgpr_read_b32 v114, a40
    v_accvgpr_read_b32 v115, a44
    v_max3_u32 v112, v112, v113, v114
    v_max_u32 v112, v112, v115
    v_cmp_eq_u32 vcc, -1, v112
    s_cbranch_vccz L_hh12_ok
    s_sub_u32 s74, s74, 1
    s_cbranch_scc0 L_hh12_r
    s_mov_b32 s74, 0
    s_branch L_hh12_ok
L_hh13_r:
    s_add_u32 s50, s25, 24576
    global_load_dwordx4 a[48:51], v3, s[50:51] sc1
    global_load_dwordx4 a[52:55], v4, s[50:51] sc1
    global_load_dwordx4 a[56:59], v8, s[50:51] sc1
    global_load_dwordx4 a[60:63], v10, s[50:51] sc1
    s_waitcnt vmcnt(0)
    v_accvgpr_read_b32 v112, a48
    v_accvgpr_read_b32 v113, a52
    v_accvgpr_read_b32 v114, a56
    v_accvgpr_read_b32 v115, a60
    v_max3_u32 v112, v112, v113, v114
    v_max_u32 v112, v112, v115
    v_cmp_eq_u32 vcc, -1, v112
    s_cbranch_vccz L_hh13_ok
    s_sub_u32 s74, s74, 1
    s_cbranch_scc0 L_hh13_r
    s_mov_b32 s74, 0
    s_branch L_hh13_ok
L_slow:
    s_mov_b64 s[30:31], 0
    s_lshl2_add_u32 s33, s3, 16384
    v_subrev_u32 v11, s33, v5
    s_lshl2_add_u32 s33, s32, s3
    s_lshl_b32 s33, s33, 11
    s_add_u32 s33, s33, 2097152
    v_add_u32 v12, s33, v11
    s_waitcnt vmcnt(0) lgkmcnt(0)
    global_load_dwordx4 a[0:3], v12, s[62:63] sc1
    global_load_dwordx4 a[4:7], v12, s[62:63] offset:1024 sc1
    v_mov_b32 v112, 0xff800000
    v_mov_b32 v113, 0xff800000
    s_add_u32 s40, s62, 1048576
    s_mov_b32 s33, 63
L_slow1:
    global_load_dwordx4 a[8:11], v7, s[40:41] sc1
    s_waitcnt vmcnt(0)
    v_mfma_f32_32x32x16_bf16 v[16:31], a[8:11], a[0:3], 0
    v_mfma_f32_32x32x16_bf16 v[32:47], a[8:11], a[4:7], 0
    s_nop 10
    v_max3_f32 v112, v16, v17, v112
    v_max3_f32 v112, v18, v19, v112
    v_max3_f32 v112, v20, v21, v112
    v_max3_f32 v112, v22, v23, v112
    v_max3_f32 v112, v24, v25, v112
    v_max3_f32 v112, v26, v27, v112
    v_max3_f32 v112, v28, v29, v112
    v_max3_f32 v112, v30, v31, v112
    v_max3_f32 v113, v32, v33, v113
    v_max3_f32 v113, v34, v35, v113
    v_max3_f32 v113, v36, v37, v113
    v_max3_f32 v113, v38, v39, v113
    v_max3_f32 v113, v40, v41, v113
    v_max3_f32 v113, v42, v43, v113
    v_max3_f32 v113, v44, v45, v113
    v_max3_f32 v113, v46, v47, v113
    s_add_u32 s40, s40, 4096
    s_sub_u32 s33, s33, 1
    s_cbranch_scc0 L_slow1
    v_mov_b32 v114, v112
    v_mov_b32 v115, v113
    s_nop 0
    v_permlane32_swap_b32 v112, v114
    v_permlane32_swap_b32 v113, v115
    v_max_f32 v112, v112, v114
    v_max_f32 v113, v113, v115
    v_sub_f32 v80, 0, v112
    v_sub_f32 v96, 0, v113
    v_mov_b32 v48, 0
    v_mov_b32 v64, 0
    v_sub_f32 v81, 0, v112
    v_sub_f32 v97, 0, v113
    v_mov_b32 v49, 0
    v_mov_b32 v65, 0
    v_sub_f32 v82, 0, v112
    v_sub_f32 v98, 0, v113
    v_mov_b32 v50, 0
    v_mov_b32 v66, 0
    v_sub_f32 v83, 0, v112
    v_sub_f32 v99, 0, v113
    v_mov_b32 v51, 0
    v_mov_b32 v67, 0
    v_sub_f32 v84, 0, v112
    v_sub_f32 v100, 0, v113
    v_mov_b32 v52, 0
    v_mov_b32 v68, 0
    v_sub_f32 v85, 0, v112
    v_sub_f32 v101, 0, v113
    v_mov_b32 v53, 0
    v_mov_b32 v69, 0
    v_sub_f32 v86, 0, v112
    v_sub_f32 v102, 0, v113
    v_mov_b32 v54, 0
    v_mov_b32 v70, 0
    v_sub_f32 v87, 0, v112
    v_sub_f32 v103, 0, v113
    v_mov_b32 v55, 0
    v_mov_b32 v71, 0
    v_sub_f32 v88, 0, v112
    v_sub_f32 v104, 0, v113
    v_mov_b32 v56, 0
    v_mov_b32 v72, 0
    v_sub_f32 v89, 0, v112
    v_sub_f32 v105, 0, v113
    v_mov_b32 v57, 0
    v_mov_b32 v73, 0
    v_sub_f32 v90, 0, v112
    v_sub_f32 v106, 0, v113
    v_mov_b32 v58, 0
    v_mov_b32 v74, 0
    v_sub_f32 v91, 0, v112
    v_sub_f32 v107, 0, v113
    v_mov_b32 v59, 0
    v_mov_b32 v75, 0
    v_sub_f32 v92, 0, v112
    v_sub_f32 v108, 0, v113
    v_mov_b32 v60, 0
    v_mov_b32 v76, 0
    v_sub_f32 v93, 0, v112
    v_sub_f32 v109, 0, v113
    v_mov_b32 v61, 0
    v_mov_b32 v77, 0
    v_sub_f32 v94, 0, v112
    v_sub_f32 v110, 0, v113
    v_mov_b32 v62, 0
    v_mov_b32 v78, 0
    v_sub_f32 v95, 0, v112
    v_sub_f32 v111, 0, v113
    v_mov_b32 v63, 0
    v_mov_b32 v79, 0
    s_add_u32 s40, s62, 1048576
    s_mov_b32 s33, 63
L_slow2:
    global_load_dwordx4 a[8:11], v7, s[40:41] sc1
    global_load_dwordx4 a[12:15], v9, s[40:41] offset:1024 sc1
    global_load_dwordx4 a[16:19], v9, s[40:41] offset:2048 sc1
    s_waitcnt vmcnt(0)
    v_mfma_f32_32x32x16_bf16 v[16:31], a[8:11], a[0:3], v[80:95]
    v_mfma_f32_32x32x16_bf16 v[32:47], a[8:11], a[4:7], v[96:111]
    s_nop 10
    v_exp_f32 v16, v16
    v_exp_f32 v17, v17
    v_exp_f32 v18, v18
    v_exp_f32 v19, v19
    v_exp_f32 v20, v20
    v_exp_f32 v21, v21
    v_exp_f32 v22, v22
    v_exp_f32 v23, v23
    v_exp_f32 v24, v24
    v_exp_f32 v25, v25
    v_exp_f32 v26, v26
    v_exp_f32 v27, v27
    v_exp_f32 v28, v28
    v_exp_f32 v29, v29
    v_exp_f32 v30, v30
    v_exp_f32 v31, v31
    v_smfmac_f32_32x32x32_bf16 v[48:63], a[12:15], v[16:23], v1
    s_nop 0
    v_smfmac_f32_32x32x32_bf16 v[48:63], a[16:19], v[24:31], v1
    v_exp_f32 v32, v32
    v_exp_f32 v33, v33
    v_exp_f32 v34, v34
    v_exp_f32 v35, v35
    v_exp_f32 v36, v36
    v_exp_f32 v37, v37
    v_exp_f32 v38, v38
    v_exp_f32 v39, v39
    v_exp_f32 v40, v40
    v_exp_f32 v41, v41
    v_exp_f32 v42, v42
    v_exp_f32 v43, v43
    v_exp_f32 v44, v44
    v_exp_f32 v45, v45
    v_exp_f32 v46, v46
    v_exp_f32 v47, v47
    v_smfmac_f32_32x32x32_bf16 v[64:79], a[12:15], v[32:39], v1
    s_nop 0
    v_smfmac_f32_32x32x32_bf16 v[64:79], a[16:19], v[40:47], v1
    s_nop 7
    s_nop 7
    s_add_u32 s40, s40, 4096
    s_sub_u32 s33, s33, 1
    s_cbranch_scc0 L_slow2
    v_add_u32 v12, s15, v11
    v_rcp_f32 v112, v56
    s_nop 0
    v_mul_f32 v48, v112, v48
    v_mul_f32 v49, v112, v49
    v_mul_f32 v50, v112, v50
    v_mul_f32 v51, v112, v51
    v_mul_f32 v52, v112, v52
    v_mul_f32 v53, v112, v53
    v_mul_f32 v54, v112, v54
    v_mul_f32 v55, v112, v55
    v_cvt_pk_bf16_f32 v48, v48, v49
    v_cvt_pk_bf16_f32 v49, v50, v51
    v_cvt_pk_bf16_f32 v50, v52, v53
    v_cvt_pk_bf16_f32 v51, v54, v55
    ds_write_b128 v12, v[48:51] offset:0
    v_rcp_f32 v112, v72
    s_nop 0
    v_mul_f32 v64, v112, v64
    v_mul_f32 v65, v112, v65
    v_mul_f32 v66, v112, v66
    v_mul_f32 v67, v112, v67
    v_mul_f32 v68, v112, v68
    v_mul_f32 v69, v112, v69
    v_mul_f32 v70, v112, v70
    v_mul_f32 v71, v112, v71
    v_cvt_pk_bf16_f32 v64, v64, v65
    v_cvt_pk_bf16_f32 v65, v66, v67
    v_cvt_pk_bf16_f32 v66, v68, v69
    v_cvt_pk_bf16_f32 v67, v70, v71
    ds_write_b128 v12, v[64:67] offset:1024
    v_mov_b32 v80, 0
    v_mov_b32 v81, 0
    v_mov_b32 v82, 0
    v_mov_b32 v83, 0
    v_mov_b32 v84, 0
    v_mov_b32 v85, 0
    v_mov_b32 v86, 0
    v_mov_b32 v87, 0
    v_mov_b32 v88, 0
    v_mov_b32 v89, 0
    v_mov_b32 v90, 0
    v_mov_b32 v91, 0
    v_mov_b32 v92, 0
    v_mov_b32 v93, 0
    v_mov_b32 v94, 0
    v_mov_b32 v95, 0
    v_mov_b32 v96, 0
    v_mov_b32 v97, 0
    v_mov_b32 v98, 0
    v_mov_b32 v99, 0
    v_mov_b32 v100, 0
    v_mov_b32 v101, 0
    v_mov_b32 v102, 0
    v_mov_b32 v103, 0
    v_mov_b32 v104, 0
    v_mov_b32 v105, 0
    v_mov_b32 v106, 0
    v_mov_b32 v107, 0
    v_mov_b32 v108, 0
    v_mov_b32 v109, 0
    v_mov_b32 v110, 0
    v_mov_b32 v111, 0
    v_subrev_u32 v13, 16384, v6
    s_lshl_b32 s33, s3, 17
    s_add_u32 s33, s33, s62
    s_add_u32 s42, s33, 528384
    s_mov_b32 s33, 3
    s_waitcnt lgkmcnt(0)
    s_barrier
L_slow3:
    ds_read_b128 v[112:115], v13 offset:0
    global_load_dwordx4 a[0:3], v7, s[42:43] offset:-4096 sc1
    global_load_dwordx4 a[4:7], v7, s[42:43] offset:-3072 sc1
    global_load_dwordx4 a[8:11], v7, s[42:43] offset:-2048 sc1
    global_load_dwordx4 a[12:15], v7, s[42:43] offset:-1024 sc1
    global_load_dwordx4 a[16:19], v7, s[42:43] offset:0 sc1
    global_load_dwordx4 a[20:23], v7, s[42:43] offset:1024 sc1
    global_load_dwordx4 a[24:27], v7, s[42:43] offset:2048 sc1
    global_load_dwordx4 a[28:31], v7, s[42:43] offset:3072 sc1
    s_add_u32 s42, s42, 8192
    global_load_dwordx4 a[32:35], v7, s[42:43] offset:-4096 sc1
    global_load_dwordx4 a[36:39], v7, s[42:43] offset:-3072 sc1
    global_load_dwordx4 a[40:43], v7, s[42:43] offset:-2048 sc1
    global_load_dwordx4 a[44:47], v7, s[42:43] offset:-1024 sc1
    global_load_dwordx4 a[48:51], v7, s[42:43] offset:0 sc1
    global_load_dwordx4 a[52:55], v7, s[42:43] offset:1024 sc1
    global_load_dwordx4 a[56:59], v7, s[42:43] offset:2048 sc1
    global_load_dwordx4 a[60:63], v7, s[42:43] offset:3072 sc1
    s_add_u32 s42, s42, 8192
    s_waitcnt vmcnt(0) lgkmcnt(0)
    v_smfmac_f32_16x16x64_bf16 v[80:83], v[112:115], a[0:7], v1 abid:1
    v_smfmac_f32_16x16x64_bf16 v[84:87], v[112:115], a[8:15], v1 abid:1
    v_smfmac_f32_16x16x64_bf16 v[88:91], v[112:115], a[16:23], v1 abid:1
    v_smfmac_f32_16x16x64_bf16 v[92:95], v[112:115], a[24:31], v1 abid:1
    v_smfmac_f32_16x16x64_bf16 v[96:99], v[112:115], a[32:39], v1 abid:1
    v_smfmac_f32_16x16x64_bf16 v[100:103], v[112:115], a[40:47], v1 abid:1
    v_smfmac_f32_16x16x64_bf16 v[104:107], v[112:115], a[48:55], v1 abid:1
    v_smfmac_f32_16x16x64_bf16 v[108:111], v[112:115], a[56:63], v1 abid:1
    s_nop 7
    s_nop 7
    ds_read_b128 v[112:115], v13 offset:1024
    global_load_dwordx4 a[0:3], v7, s[42:43] offset:-4096 sc1
    global_load_dwordx4 a[4:7], v7, s[42:43] offset:-3072 sc1
    global_load_dwordx4 a[8:11], v7, s[42:43] offset:-2048 sc1
    global_load_dwordx4 a[12:15], v7, s[42:43] offset:-1024 sc1
    global_load_dwordx4 a[16:19], v7, s[42:43] offset:0 sc1
    global_load_dwordx4 a[20:23], v7, s[42:43] offset:1024 sc1
    global_load_dwordx4 a[24:27], v7, s[42:43] offset:2048 sc1
    global_load_dwordx4 a[28:31], v7, s[42:43] offset:3072 sc1
    s_add_u32 s42, s42, 8192
    global_load_dwordx4 a[32:35], v7, s[42:43] offset:-4096 sc1
    global_load_dwordx4 a[36:39], v7, s[42:43] offset:-3072 sc1
    global_load_dwordx4 a[40:43], v7, s[42:43] offset:-2048 sc1
    global_load_dwordx4 a[44:47], v7, s[42:43] offset:-1024 sc1
    global_load_dwordx4 a[48:51], v7, s[42:43] offset:0 sc1
    global_load_dwordx4 a[52:55], v7, s[42:43] offset:1024 sc1
    global_load_dwordx4 a[56:59], v7, s[42:43] offset:2048 sc1
    global_load_dwordx4 a[60:63], v7, s[42:43] offset:3072 sc1
    s_add_u32 s42, s42, 8192
    s_waitcnt vmcnt(0) lgkmcnt(0)
    v_smfmac_f32_16x16x64_bf16 v[80:83], v[112:115], a[0:7], v1 abid:1
    v_smfmac_f32_16x16x64_bf16 v[84:87], v[112:115], a[8:15], v1 abid:1
    v_smfmac_f32_16x16x64_bf16 v[88:91], v[112:115], a[16:23], v1 abid:1
    v_smfmac_f32_16x16x64_bf16 v[92:95], v[112:115], a[24:31], v1 abid:1
    v_smfmac_f32_16x16x64_bf16 v[96:99], v[112:115], a[32:39], v1 abid:1
    v_smfmac_f32_16x16x64_bf16 v[100:103], v[112:115], a[40:47], v1 abid:1
    v_smfmac_f32_16x16x64_bf16 v[104:107], v[112:115], a[48:55], v1 abid:1
    v_smfmac_f32_16x16x64_bf16 v[108:111], v[112:115], a[56:63], v1 abid:1
    s_nop 7
    s_nop 7
    v_add_u32 v13, 4096, v13
    s_sub_u32 s33, s33, 1
    s_cbranch_scc0 L_slow3
    global_load_dwordx4 v[48:51], v128, s[36:37] offset:-2048
    global_load_dwordx4 v[52:55], v128, s[36:37] offset:2048
    ds_read_b128 v[56:59], v129 offset:0
    ds_read_b128 v[60:63], v129 offset:16
    ds_read_b128 v[32:35], v129 offset:2048
    ds_read_b128 v[36:39], v129 offset:2064
    ds_read_b128 v[40:43], v129 offset:4096
    ds_read_b128 v[44:47], v129 offset:4112
    s_waitcnt vmcnt(0) lgkmcnt(0)
    v_lshlrev_b32 v16, 16, v48
    v_and_b32 v17, 0xffff0000, v48
    v_lshlrev_b32 v18, 16, v49
    v_and_b32 v19, 0xffff0000, v49
    v_lshlrev_b32 v20, 16, v50
    v_and_b32 v21, 0xffff0000, v50
    v_lshlrev_b32 v22, 16, v51
    v_and_b32 v23, 0xffff0000, v51
    v_lshlrev_b32 v24, 16, v52
    v_and_b32 v25, 0xffff0000, v52
    v_lshlrev_b32 v26, 16, v53
    v_and_b32 v27, 0xffff0000, v53
    v_lshlrev_b32 v28, 16, v54
    v_and_b32 v29, 0xffff0000, v54
    v_lshlrev_b32 v30, 16, v55
    v_and_b32 v31, 0xffff0000, v55
    s_branch L_epi
L_end_adaLN_cond__grouped_kv_mqa__glu_gated_glu__prompt_kernel:
    s_endpgm
L_code_end:
.section .rodata,"a"
.p2align 6
.amdhsa_kernel adaLN_cond__grouped_kv_mqa__glu_gated_glu__prompt_kernel
  .amdhsa_next_free_vgpr 512
  .amdhsa_next_free_sgpr 102
  .amdhsa_accum_offset 256
  .amdhsa_group_segment_fixed_size 0
  .amdhsa_kernarg_size 112
  .amdhsa_user_sgpr_count 2
  .amdhsa_user_sgpr_kernarg_segment_ptr 1
  .amdhsa_system_sgpr_workgroup_id_x 1
.end_amdhsa_kernel
```
